```python
import torch

def _softmax(x, axis=-1):
    return torch.softmax(x, dim=axis)
def _gelu(x):
    return torch.nn.functional.gelu(x, approximate="tanh")
def _silu(x):
    return torch.nn.functional.silu(x)
def _sigmoid(x):
    return torch.sigmoid(x)
def _layernorm(x, axis=-1, eps=1e-5):
    m = x.mean(dim=axis, keepdim=True)
    v = x.var(dim=axis, keepdim=True, unbiased=False)
    return (x - m) / torch.sqrt(v + eps)
def _scatter_add(tgt, idx, src, axis=0):
    return tgt.clone().index_add_(axis, idx, src)
def _segment_sum(src, seg, n):
    out = torch.zeros((n,) + src.shape[1:], dtype=src.dtype)
    return out.index_add_(0, seg, src)
def _pad(x, pw):
    flat = tuple(v for pair in reversed(pw) for v in pair)
    return torch.nn.functional.pad(x, flat)

kernel_name = 'parallel_sum__sliding_local_dilated__moe_arch_mod__prompt'

def setup_inputs():

    _w = (lambda a: (lambda t: t.to(torch.bfloat16) if t.is_floating_point() else t)(torch.as_tensor(a)))
    def _A_setup():
        B, S, D = 1, 2048, 1024
        return {
            "x": _w((lambda *s: torch.randn(*s, dtype=torch.bfloat16) * 0.05)(B, S, D)),
            "wqkv": _w((lambda *s: torch.randn(*s, dtype=torch.bfloat16) * 0.05)(D, 3 * D)),
            "wo": _w((lambda *s: torch.randn(*s, dtype=torch.bfloat16) * 0.05)(D, D)),
        }
    _A_in = _A_setup()

    def _B_setup():
        B, S, D, F, C = 1, 2048, 1024, 3584, 8
        return {
            "x": _w((lambda *s: torch.randn(*s, dtype=torch.bfloat16) * 0.05)(B, S, D)),
            "w_r": _w((lambda *s: torch.randn(*s, dtype=torch.bfloat16) * 0.05)(D)),
            "w_gate": _w((lambda *s: torch.randn(*s, dtype=torch.bfloat16) * 0.05)(D, F)),
            "w_up": _w((lambda *s: torch.randn(*s, dtype=torch.bfloat16) * 0.05)(D, F)),
            "w_down": _w((lambda *s: torch.randn(*s, dtype=torch.bfloat16) * 0.05)(F, D)),
        }
    _B_in = _B_setup()

    return {
        "A_x": _A_in["x"],
        "A_wqkv": _A_in["wqkv"],
        "A_wo": _A_in["wo"],
        "B_x": _B_in["x"],
        "B_w_r": _B_in["w_r"],
        "B_w_gate": _B_in["w_gate"],
        "B_w_up": _B_in["w_up"],
        "B_w_down": _B_in["w_down"],
    }

def reference(A_x, A_wqkv, A_wo, B_x, B_w_r, B_w_gate, B_w_up, B_w_down):
    def _A_ref(x, wqkv, wo):
        B, S, D = x.shape
        H = 32; Dh = D // H
        W, dil = 8, 2
        qkv = (lambda x, *d: x.permute(*d))((x @ wqkv).reshape(B, S, 3, H, Dh), 2, 0, 3, 1, 4)
        q, k, v = qkv[0], qkv[1], qkv[2]
        scale = Dh ** -0.5
        pos = torch.arange(S)
        off = torch.arange(W) * dil
        idx = pos[:, None] - off[None, :]
        mask = idx >= 0
        idx_c = torch.where(mask, idx, 0).reshape(-1)
        kg = k[:, :, idx_c, :].reshape(B, H, S, W, Dh)
        vg = v[:, :, idx_c, :].reshape(B, H, S, W, Dh)
        logits = torch.einsum("bhsd,bhswd->bhsw", q, kg) * scale
        logits = torch.where(mask[None, None, :, :], logits, -1e9)
        attn = _softmax(logits, axis=-1)
        o = torch.einsum("bhsw,bhswd->bhsd", attn, vg)
        return (lambda x, *d: x.permute(*d))(o, 0, 2, 1, 3).reshape(B, S, D) @ wo

    def _B_ref(x, w_r, w_gate, w_up, w_down):
        B, S, D = x.shape
        C = 8
        r = x @ w_r
        idx = torch.argsort(-r, axis=-1)[:, :C]
        idx_e = (lambda x, n, axis: torch.repeat_interleave(x, n, dim=axis))(idx.reshape(B, C, 1), D, axis=2)
        x_sel = (lambda x, i, axis: torch.take_along_dim(x, i, dim=axis))(x, idx_e, axis=1)
        g = _silu(x_sel @ w_gate)
        u = x_sel @ w_up
        y = (g * u) @ w_down
        r_sel = _sigmoid((lambda x, i, axis: torch.take_along_dim(x, i, dim=axis))(r, idx, axis=1))
        y = y * r_sel.reshape(B, C, 1)
        b_off = (torch.arange(B) * S).reshape(B, 1)
        flat_idx = (idx + b_off).reshape(B * C)
        zero = (x * 0.0).reshape(B * S, D)
        upd = _scatter_add(zero, flat_idx, y.reshape(B * C, D), axis=0)
        return x + upd.reshape(B, S, D)

    x = A_x
    xn = _layernorm(x, axis=-1)
    return x + _A_ref(xn, A_wqkv, A_wo) + _B_ref(xn, B_w_r, B_w_gate, B_w_up, B_w_down)
```

```asm
; @launch grid=(256,1,1) block=(512,1,1) lds=161600
.amdgcn_target "amdgcn-amd-amdhsa--gfx950"
.text
.globl parallel_sum__sliding_local_dilated__moe_arch_mod__prompt_kernel
.p2align 8
.type parallel_sum__sliding_local_dilated__moe_arch_mod__prompt_kernel,@function
parallel_sum__sliding_local_dilated__moe_arch_mod__prompt_kernel:
    s_cmp_ge_u32 s2, 256
    s_cbranch_scc1 F_end
    s_load_dwordx4 s[4:7], s[0:1], 0
    s_load_dwordx4 s[72:75], s[0:1], 72
    s_load_dwordx2 s[84:85], s[0:1], 16
    s_load_dwordx2 s[86:87], s[0:1], 64
    v_lshrrev_b32 v1, 6, v0
    v_and_b32 v0, 63, v0
    v_readfirstlane_b32 s3, v1
    s_and_b32 s28, s2, 7
    s_lshr_b32 s29, s2, 3
    s_mov_b32 s39, 0xffff0000
    s_cmp_ge_u32 s29, 24
    s_cbranch_scc1 F_moe
    s_mul_i32 s31, s29, 43
    s_lshr_b32 s31, s31, 8
    s_mul_i32 s30, s31, 6
    s_sub_u32 s30, s29, s30
    s_and_b32 s32, s28, 1
    s_mul_i32 s32, s32, 6
    s_add_u32 s30, s30, s32
    s_lshr_b32 s32, s28, 1
    s_lshl_b32 s32, s32, 2
    s_add_u32 s31, s31, s32
    s_mul_i32 s33, s30, 176
    s_sub_u32 s33, s33, 16
    v_mov_b32 v1, 147456
    s_mov_b32 s56, 0
    s_cmp_lt_u32 s3, 4
    s_cbranch_scc1 F_cons
    s_sub_u32 s3, s3, 4
    s_mul_i32 s45, s3, 12288
    s_cmp_ge_u32 s3, 2
    s_cbranch_scc1 F_lw
    v_lshrrev_b32 v16, 3, v0
    v_lshrrev_b32 v17, 4, v0
    v_and_b32 v18, 7, v0
    v_xor_b32 v17, v17, v18
    v_lshlrev_b32 v17, 4, v17
    v_xor_b32 v18, 64, v17
    s_mul_i32 s36, s3, 96
    s_add_u32 s36, s36, s33
    v_add_u32 v16, s36, v16
    v_add_u32 v19, 0, v16
    v_max_i32 v19, 0, v19
    v_lshl_add_u32 v2, v19, 11, v17
    v_add_u32 v2, 4096, v2
    v_add_u32 v19, 8, v16
    v_max_i32 v19, 0, v19
    v_lshl_add_u32 v3, v19, 11, v18
    v_add_u32 v3, 3072, v3
    v_lshl_add_u32 v4, v16, 11, v17
    v_add_u32 v4, 34816, v4
    v_lshl_add_u32 v5, v16, 11, v18
    v_add_u32 v5, 50176, v5
    v_add_u32 v6, 34816, v4
    v_add_u32 v7, 34816, v5
    v_add_u32 v8, 65536, v4
    v_add_u32 v9, 65536, v5
    v_add_u32 v10, 100352, v4
    v_add_u32 v11, 100352, v5
    v_add_u32 v12, 131072, v4
    v_add_u32 v13, 131072, v5
    s_mov_b32 s42, 128
    s_waitcnt lgkmcnt(0)
    s_sub_u32 s12, s4, 0x1000
    s_subb_u32 s13, s5, 0
    s_mov_b32 s14, 0x401000
    s_mov_b32 s15, 0x20000
    s_branch F_lgo
F_lw:
    s_mov_b32 s36, 6144
    v_lshrrev_b32 v16, 3, v0
    v_and_b32 v17, 6, v16
    v_and_b32 v2, 7, v0
    v_xor_b32 v2, v2, v17
    v_lshlrev_b32 v2, 4, v2
    v_and_b32 v17, 4, v16
    v_add_u32 v16, v16, v17
    v_mul_lo_u32 v16, v16, s36
    v_add_u32 v2, v2, v16
    s_lshl_b32 s36, s31, 7
    s_cmp_eq_u32 s3, 3
    s_cselect_b32 s37, 198656, 0
    s_add_u32 s36, s36, s37
    v_add_u32 v2, s36, v2
    s_cmp_eq_u32 s3, 3
    s_mov_b32 s36, 196608
    s_cselect_b32 s36, -194560, s36
    v_add_u32 v3, 23552, v2
    v_add_u32 v4, 96256, v2
    v_add_u32 v5, 119808, v2
    v_add_u32 v6, s36, v2
    v_add_u32 v10, 2048, v2
    v_add_u32 v7, s36, v3
    v_add_u32 v11, 2048, v3
    v_add_u32 v8, s36, v4
    v_add_u32 v12, 2048, v4
    v_add_u32 v9, s36, v5
    v_add_u32 v13, 2048, v5
    s_mov_b32 s42, 393216
    s_waitcnt lgkmcnt(0)
    s_mov_b32 s12, s6
    s_mov_b32 s13, s7
    s_mov_b32 s14, 0x600000
    s_mov_b32 s15, 0x20000
F_lgo:
    s_mov_b32 s43, 0
    s_mov_b32 s40, s45
    s_add_u32 m0, s40, 0
    s_nop 0
    buffer_load_dwordx4 v2, s[12:15], s43 offen offset:0 lds
    buffer_load_dwordx4 v3, s[12:15], s43 offen offset:1024 lds
    buffer_load_dwordx4 v4, s[12:15], s43 offen offset:2048 lds
    buffer_load_dwordx4 v5, s[12:15], s43 offen offset:3072 lds
    s_add_u32 m0, s40, 4096
    s_nop 0
    buffer_load_dwordx4 v6, s[12:15], s43 offen offset:0 lds
    buffer_load_dwordx4 v7, s[12:15], s43 offen offset:1024 lds
    buffer_load_dwordx4 v8, s[12:15], s43 offen offset:2048 lds
    buffer_load_dwordx4 v9, s[12:15], s43 offen offset:3072 lds
    s_add_u32 m0, s40, 8192
    s_nop 0
    buffer_load_dwordx4 v10, s[12:15], s43 offen offset:0 lds
    buffer_load_dwordx4 v11, s[12:15], s43 offen offset:1024 lds
    buffer_load_dwordx4 v12, s[12:15], s43 offen offset:2048 lds
    buffer_load_dwordx4 v13, s[12:15], s43 offen offset:3072 lds
    s_add_u32 s43, s43, s42
    s_add_u32 s40, s40, 49152
    s_cmp_ge_u32 s40, 147456
    s_cselect_b32 s40, s45, s40
    s_add_u32 m0, s40, 0
    s_nop 0
    buffer_load_dwordx4 v2, s[12:15], s43 offen offset:0 lds
    buffer_load_dwordx4 v3, s[12:15], s43 offen offset:1024 lds
    buffer_load_dwordx4 v4, s[12:15], s43 offen offset:2048 lds
    buffer_load_dwordx4 v5, s[12:15], s43 offen offset:3072 lds
    s_add_u32 m0, s40, 4096
    s_nop 0
    buffer_load_dwordx4 v6, s[12:15], s43 offen offset:0 lds
    buffer_load_dwordx4 v7, s[12:15], s43 offen offset:1024 lds
    buffer_load_dwordx4 v8, s[12:15], s43 offen offset:2048 lds
    buffer_load_dwordx4 v9, s[12:15], s43 offen offset:3072 lds
    s_add_u32 m0, s40, 8192
    s_nop 0
    buffer_load_dwordx4 v10, s[12:15], s43 offen offset:0 lds
    buffer_load_dwordx4 v11, s[12:15], s43 offen offset:1024 lds
    buffer_load_dwordx4 v12, s[12:15], s43 offen offset:2048 lds
    buffer_load_dwordx4 v13, s[12:15], s43 offen offset:3072 lds
    s_add_u32 s43, s43, s42
    s_add_u32 s40, s40, 49152
    s_cmp_ge_u32 s40, 147456
    s_cselect_b32 s40, s45, s40
    s_load_dwordx4 s[64:67], s[0:1], 40
    s_mov_b32 s61, 0
    s_mov_b32 s59, 0
    s_mov_b32 s11, 0x20000
    s_cmp_eq_u32 s3, 1
    s_cbranch_scc1 F_r1
    s_cmp_eq_u32 s3, 2
    s_cbranch_scc1 F_r2
    s_cmp_eq_u32 s3, 3
    s_cbranch_scc1 F_r3
    s_lshl_b32 s36, s29, 14
    s_lshr_b32 s37, s28, 1
    s_lshl_b32 s37, s37, 9
    s_add_u32 s36, s36, s37
    s_add_u32 s36, s36, 1573248
    v_lshl_add_u32 v21, v0, 11, s36
    s_bitcmp1_b32 s28, 1
    s_cselect_b32 s58, 0, 6291456
    s_mov_b64 s[62:63], 0xff
    s_mov_b32 s60, 393216
    s_mov_b32 s8, s6
    s_mov_b32 s9, s7
    s_branch F_rd0
F_r1:
    v_lshrrev_b32 v21, 3, v0
    v_lshlrev_b32 v21, 11, v21
    v_and_b32 v17, 7, v0
    v_lshl_add_u32 v21, v17, 7, v21
    s_and_b32 s36, s28, 4
    s_lshl_b32 s36, s36, 8
    v_add_u32 v21, s36, v21
    s_lshl_b32 s36, s29, 2
    s_and_b32 s37, s28, 3
    s_add_u32 s36, s36, s37
    s_lshl_b32 s36, s36, 14
    v_add_u32 v21, s36, v21
    s_mov_b64 s[62:63], -1
    s_mov_b32 s60, 0x200000
    s_mov_b32 s58, 0x200000
    s_mov_b32 s59, 10
    s_mov_b32 s8, s84
    s_mov_b32 s9, s85
    s_branch F_rd0
F_r2:
    s_add_u32 s37, s28, 3
    s_and_b32 s37, s37, 7
    s_min_u32 s37, s37, 6
    s_mov_b32 s58, 7340032
    s_mul_i32 s38, s28, 7
    s_add_u32 s37, s37, s38
    s_lshl_b32 s37, s37, 7
    s_mul_i32 s38, s29, 315392
    s_add_u32 s37, s37, s38
    s_mov_b32 s38, 7168
    v_mul_lo_u32 v21, v0, s38
    v_add_u32 v21, s37, v21
    s_mov_b32 s62, -1
    s_mov_b32 s63, 0xfff
    s_mov_b32 s60, 7340032
    s_mov_b32 s59, 1
    s_waitcnt lgkmcnt(0)
    s_mov_b32 s8, s64
    s_mov_b32 s9, s65
    s_branch F_rd0
F_r3:
    v_and_b32 v21, 7, v0
    v_lshlrev_b32 v21, 2, v21
    v_add_u32 v21, 128, v21
    s_mov_b64 s[62:63], -1
    s_mov_b32 s60, 0
    s_mov_b32 s58, 0x100
    s_mov_b32 s59, 10
    s_mov_b32 s8, s72
    s_mov_b32 s9, s73
F_rd0:
    s_mov_b32 s41, 0
    s_mov_b32 s44, 0
    v_mov_b32 v28, 0
    s_waitcnt vmcnt(12) lgkmcnt(0)
    s_barrier
    s_add_u32 m0, s40, 0
    s_nop 0
    buffer_load_dwordx4 v2, s[12:15], s43 offen offset:0 lds
    buffer_load_dwordx4 v3, s[12:15], s43 offen offset:1024 lds
    buffer_load_dwordx4 v4, s[12:15], s43 offen offset:2048 lds
    buffer_load_dwordx4 v5, s[12:15], s43 offen offset:3072 lds
    s_add_u32 m0, s40, 4096
    s_nop 0
    buffer_load_dwordx4 v6, s[12:15], s43 offen offset:0 lds
    buffer_load_dwordx4 v7, s[12:15], s43 offen offset:1024 lds
    buffer_load_dwordx4 v8, s[12:15], s43 offen offset:2048 lds
    buffer_load_dwordx4 v9, s[12:15], s43 offen offset:3072 lds
    s_add_u32 m0, s40, 8192
    s_nop 0
    buffer_load_dwordx4 v10, s[12:15], s43 offen offset:0 lds
    buffer_load_dwordx4 v11, s[12:15], s43 offen offset:1024 lds
    buffer_load_dwordx4 v12, s[12:15], s43 offen offset:2048 lds
    buffer_load_dwordx4 v13, s[12:15], s43 offen offset:3072 lds
    s_add_u32 s43, s43, s42
    s_add_u32 s40, s40, 49152
    s_cmp_ge_u32 s40, 147456
    s_cselect_b32 s40, s45, s40
    s_cmp_ge_u32 s44, s59
    s_cselect_b32 s10, s58, 0
    s_cselect_b32 s36, s60, 0
    s_mov_b64 exec, s[62:63]
    buffer_load_dword v28, v21, s[8:11], 0 offen sc1
    s_mov_b64 exec, -1
    v_add_u32 v21, s36, v21
    s_mov_b32 s20, s74
    s_mov_b32 s21, s75
    s_mov_b32 s22, 0x1000000
    s_mov_b32 s23, 0x20000
    s_mov_b32 s24, s72
    s_mov_b32 s25, s73
    s_mov_b32 s26, 0x100
    s_mov_b32 s27, 0x20000
    v_add_u32 v24, s33, v0
    v_add_u32 v24, 0, v24
    v_max_i32 v24, 0, v24
    v_min_i32 v24, 0x7ff, v24
    v_lshlrev_b32 v24, 3, v24
    v_add_u32 v25, s33, v0
    v_add_u32 v25, 64, v25
    v_max_i32 v25, 0, v25
    v_min_i32 v25, 0x7ff, v25
    v_lshlrev_b32 v25, 3, v25
    v_add_u32 v26, s33, v0
    v_add_u32 v26, 128, v26
    v_max_i32 v26, 0, v26
    v_min_i32 v26, 0x7ff, v26
    v_lshlrev_b32 v26, 3, v26
    v_lshrrev_b32 v16, 1, v0
    v_add_u32 v16, s33, v16
    v_add_u32 v36, 0, v16
    v_max_i32 v36, 0, v36
    v_min_i32 v36, 0x7ff, v36
    v_lshlrev_b32 v36, 3, v36
    v_add_u32 v37, 32, v16
    v_max_i32 v37, 0, v37
    v_min_i32 v37, 0x7ff, v37
    v_lshlrev_b32 v37, 3, v37
    v_add_u32 v38, 64, v16
    v_max_i32 v38, 0, v38
    v_min_i32 v38, 0x7ff, v38
    v_lshlrev_b32 v38, 3, v38
    v_add_u32 v39, 96, v16
    v_max_i32 v39, 0, v39
    v_min_i32 v39, 0x7ff, v39
    v_lshlrev_b32 v39, 3, v39
    v_add_u32 v40, 128, v16
    v_max_i32 v40, 0, v40
    v_min_i32 v40, 0x7ff, v40
    v_lshlrev_b32 v40, 3, v40
    v_add_u32 v41, 160, v16
    v_max_i32 v41, 0, v41
    v_min_i32 v41, 0x7ff, v41
    v_lshlrev_b32 v41, 3, v41
    v_and_b32 v27, 7, v0
    v_lshlrev_b32 v27, 2, v27
    s_cmp_lg_u32 s3, 3
    s_cselect_b32 s41, 1, 0
    s_mov_b32 s16, s6
    s_mov_b32 s17, s7
    s_mov_b32 s18, 0x600000
    s_mov_b32 s19, 0x20000
    s_lshl_b32 s36, s29, 1
    s_and_b32 s37, s28, 1
    s_add_u32 s36, s36, s37
    s_lshl_b32 s36, s36, 15
    s_lshr_b32 s37, s28, 1
    s_lshl_b32 s37, s37, 9
    s_add_u32 s36, s36, s37
    s_add_u32 s36, s36, 3014656
    v_lshrrev_b32 v22, 2, v0
    v_lshlrev_b32 v22, 11, v22
    v_and_b32 v17, 3, v0
    v_lshl_add_u32 v22, v17, 7, v22
    v_add_u32 v22, s36, v22
    s_cmp_eq_u32 s3, 1
    s_cselect_b32 s68, 4, -1
    s_cmp_lg_u32 s3, 2
    s_cbranch_scc1 F_nup
    s_mov_b32 s68, 7
    s_mov_b32 s16, s66
    s_mov_b32 s17, s67
    s_mov_b32 s18, s58
    v_mov_b32 v22, v21
F_nup:
    s_waitcnt vmcnt(13)
F_ll:
    s_barrier
    s_add_u32 m0, s40, 0
    s_nop 0
    buffer_load_dwordx4 v2, s[12:15], s43 offen offset:0 lds
    buffer_load_dwordx4 v3, s[12:15], s43 offen offset:1024 lds
    buffer_load_dwordx4 v4, s[12:15], s43 offen offset:2048 lds
    buffer_load_dwordx4 v5, s[12:15], s43 offen offset:3072 lds
    s_add_u32 m0, s40, 4096
    s_nop 0
    buffer_load_dwordx4 v6, s[12:15], s43 offen offset:0 lds
    buffer_load_dwordx4 v7, s[12:15], s43 offen offset:1024 lds
    buffer_load_dwordx4 v8, s[12:15], s43 offen offset:2048 lds
    buffer_load_dwordx4 v9, s[12:15], s43 offen offset:3072 lds
    s_add_u32 m0, s40, 8192
    s_nop 0
    buffer_load_dwordx4 v10, s[12:15], s43 offen offset:0 lds
    buffer_load_dwordx4 v11, s[12:15], s43 offen offset:1024 lds
    buffer_load_dwordx4 v12, s[12:15], s43 offen offset:2048 lds
    buffer_load_dwordx4 v13, s[12:15], s43 offen offset:3072 lds
    s_add_u32 s43, s43, s42
    s_add_u32 s40, s40, 49152
    s_cmp_ge_u32 s40, 147456
    s_cselect_b32 s40, s45, s40
    s_add_u32 s44, s44, 1
    s_cmp_lg_u32 s41, 0
    s_cbranch_scc1 F_lsd
    v_cmp_ne_u32 vcc, 0, v28
    s_nop 0
    s_cmp_eq_u64 vcc, -1
    s_cbranch_scc0 F_lsd
    s_mov_b32 s46, 0x4000
    s_mov_b32 s47, 0x4004
    s_mov_b32 m0, 148992
    s_nop 0
    buffer_load_dword v24, s[20:23], s46 offen sc1 lds
    s_mov_b32 m0, 149760
    s_nop 0
    buffer_load_dword v24, s[20:23], s47 offen sc1 lds
    s_mov_b32 m0, 149248
    s_nop 0
    buffer_load_dword v25, s[20:23], s46 offen sc1 lds
    s_mov_b32 m0, 150016
    s_nop 0
    buffer_load_dword v25, s[20:23], s47 offen sc1 lds
    s_mov_b32 m0, 149504
    s_nop 0
    buffer_load_dword v26, s[20:23], s46 offen sc1 lds
    s_mov_b32 m0, 150272
    s_nop 0
    buffer_load_dword v26, s[20:23], s47 offen sc1 lds
    s_mov_b32 m0, 150528
    s_nop 0
    buffer_load_dword v36, s[20:23], s46 offen sc1 lds
    s_mov_b32 m0, 150784
    s_nop 0
    buffer_load_dword v37, s[20:23], s46 offen sc1 lds
    s_mov_b32 m0, 151040
    s_nop 0
    buffer_load_dword v38, s[20:23], s46 offen sc1 lds
    s_mov_b32 m0, 151296
    s_nop 0
    buffer_load_dword v39, s[20:23], s46 offen sc1 lds
    s_mov_b32 m0, 151552
    s_nop 0
    buffer_load_dword v40, s[20:23], s46 offen sc1 lds
    s_mov_b32 m0, 151808
    s_nop 0
    buffer_load_dword v41, s[20:23], s46 offen sc1 lds
    s_mov_b32 m0, 147712
    s_mov_b32 s46, 128
    buffer_load_dword v27, s[24:27], s46 offen sc1 lds
    s_mov_b32 s41, 1
    s_mov_b32 s58, 0
    s_waitcnt vmcnt(26)
    s_branch F_lnx
F_lsd:
    s_cmp_lg_u32 s44, s68
    s_cbranch_scc1 F_lsd2
    s_mov_b64 exec, s[62:63]
    buffer_load_dword v20, v22, s[16:19], 0 offen
    s_mov_b64 exec, -1
    s_waitcnt vmcnt(14)
    s_branch F_lnx
F_lsd2:
    s_cmp_ge_u32 s44, s59
    s_cselect_b32 s10, s58, 0
    s_cselect_b32 s36, s60, 0
    s_mov_b64 exec, s[62:63]
    buffer_load_dword v28, v21, s[8:11], 0 offen sc1
    s_mov_b64 exec, -1
    v_add_u32 v21, s36, v21
    s_waitcnt vmcnt(14)
F_lnx:
    s_cmp_lt_u32 s44, 13
    s_cbranch_scc1 F_ll
    s_and_b32 s30, s28, 1
    s_lshl_b32 s30, s30, 3
    s_and_b32 s31, s28, 2
    s_lshl_b32 s31, s31, 1
    s_add_u32 s30, s30, s31
    s_lshr_b32 s31, s29, 3
    s_add_u32 s30, s30, s31
    s_and_b32 s34, s29, 7
    s_add_u32 s32, s28, 3
    s_and_b32 s32, s32, 7
    s_cmp_eq_u32 s29, 27
    s_cselect_b32 s34, s32, s34
    s_add_u32 s32, s32, 24
    s_cmp_eq_u32 s29, s32
    s_cselect_b32 s34, 3, s34
    s_and_b32 s32, s28, 4
    s_lshl_b32 s32, s32, 1
    s_add_u32 s32, s32, s34
    s_mov_b32 s36, 2048
    v_lshrrev_b32 v14, 3, v0
    v_and_b32 v15, 6, v14
    v_and_b32 v220, 7, v0
    v_xor_b32 v220, v220, v15
    v_lshlrev_b32 v220, 4, v220
    v_mul_lo_u32 v14, v14, s36
    v_add_u32 v220, v220, v14
    s_lshl_b32 s36, s32, 7
    v_add_u32 v220, s36, v220
    v_add_u32 v221, 15360, v220
    v_add_u32 v222, 30720, v220
    v_add_u32 v223, 46080, v220
    s_mov_b32 s12, s84
    s_mov_b32 s13, s85
    s_mov_b32 s14, 0x200000
    s_mov_b32 s15, 0x20000
    s_barrier
    s_mul_i32 s49, s3, 12288
    s_lshl_b32 s38, s49, 4
    s_add_u32 s49, s49, 49152
    s_add_u32 s38, s38, 0
    s_add_u32 m0, s49, 0
    s_nop 0
    buffer_load_dwordx4 v220, s[12:15], s38 offen offset:0 lds
    buffer_load_dwordx4 v221, s[12:15], s38 offen offset:1024 lds
    buffer_load_dwordx4 v222, s[12:15], s38 offen offset:2048 lds
    buffer_load_dwordx4 v223, s[12:15], s38 offen offset:3072 lds
    s_add_u32 m0, s49, 4096
    s_add_u32 s38, s38, 0x10000
    buffer_load_dwordx4 v220, s[12:15], s38 offen offset:0 lds
    buffer_load_dwordx4 v221, s[12:15], s38 offen offset:1024 lds
    buffer_load_dwordx4 v222, s[12:15], s38 offen offset:2048 lds
    buffer_load_dwordx4 v223, s[12:15], s38 offen offset:3072 lds
    s_add_u32 m0, s49, 8192
    s_add_u32 s38, s38, 0x10000
    buffer_load_dwordx4 v220, s[12:15], s38 offen offset:0 lds
    buffer_load_dwordx4 v221, s[12:15], s38 offen offset:1024 lds
    buffer_load_dwordx4 v222, s[12:15], s38 offen offset:2048 lds
    buffer_load_dwordx4 v223, s[12:15], s38 offen offset:3072 lds
    s_waitcnt vmcnt(12)
    s_barrier
    s_mul_i32 s49, s3, 12288
    s_lshl_b32 s38, s49, 4
    s_add_u32 s49, s49, 98304
    s_add_u32 s38, s38, 786432
    s_add_u32 m0, s49, 0
    s_nop 0
    buffer_load_dwordx4 v220, s[12:15], s38 offen offset:0 lds
    buffer_load_dwordx4 v221, s[12:15], s38 offen offset:1024 lds
    buffer_load_dwordx4 v222, s[12:15], s38 offen offset:2048 lds
    buffer_load_dwordx4 v223, s[12:15], s38 offen offset:3072 lds
    s_add_u32 m0, s49, 4096
    s_add_u32 s38, s38, 0x10000
    buffer_load_dwordx4 v220, s[12:15], s38 offen offset:0 lds
    buffer_load_dwordx4 v221, s[12:15], s38 offen offset:1024 lds
    buffer_load_dwordx4 v222, s[12:15], s38 offen offset:2048 lds
    buffer_load_dwordx4 v223, s[12:15], s38 offen offset:3072 lds
    s_add_u32 m0, s49, 8192
    s_add_u32 s38, s38, 0x10000
    buffer_load_dwordx4 v220, s[12:15], s38 offen offset:0 lds
    buffer_load_dwordx4 v221, s[12:15], s38 offen offset:1024 lds
    buffer_load_dwordx4 v222, s[12:15], s38 offen offset:2048 lds
    buffer_load_dwordx4 v223, s[12:15], s38 offen offset:3072 lds
    s_barrier
    s_cmp_lg_u32 s41, 0
    s_cbranch_scc1 F_p2g
    s_mov_b32 s47, 0
F_pl_1:
    buffer_load_dword v28, v27, s[24:27], 0 offen offset:128 sc1
    s_waitcnt vmcnt(0)
F_pc_2:
    v_cmp_ne_u32 vcc, 0, v28
    s_nop 0
    s_cmp_eq_u64 vcc, -1
    s_cbranch_scc1 F_pd_3
    s_add_u32 s47, s47, 1
    s_cmp_lt_u32 s47, 0x8000
    s_cbranch_scc0 F_pd_3
    s_sleep 8
    s_branch F_pl_1
F_pd_3:
    s_mov_b32 s46, 0x4000
    s_mov_b32 s47, 0x4004
    s_mov_b32 m0, 148992
    s_nop 0
    buffer_load_dword v24, s[20:23], s46 offen sc1 lds
    s_mov_b32 m0, 149760
    s_nop 0
    buffer_load_dword v24, s[20:23], s47 offen sc1 lds
    s_mov_b32 m0, 149248
    s_nop 0
    buffer_load_dword v25, s[20:23], s46 offen sc1 lds
    s_mov_b32 m0, 150016
    s_nop 0
    buffer_load_dword v25, s[20:23], s47 offen sc1 lds
    s_mov_b32 m0, 149504
    s_nop 0
    buffer_load_dword v26, s[20:23], s46 offen sc1 lds
    s_mov_b32 m0, 150272
    s_nop 0
    buffer_load_dword v26, s[20:23], s47 offen sc1 lds
    s_mov_b32 m0, 150528
    s_nop 0
    buffer_load_dword v36, s[20:23], s46 offen sc1 lds
    s_mov_b32 m0, 150784
    s_nop 0
    buffer_load_dword v37, s[20:23], s46 offen sc1 lds
    s_mov_b32 m0, 151040
    s_nop 0
    buffer_load_dword v38, s[20:23], s46 offen sc1 lds
    s_mov_b32 m0, 151296
    s_nop 0
    buffer_load_dword v39, s[20:23], s46 offen sc1 lds
    s_mov_b32 m0, 151552
    s_nop 0
    buffer_load_dword v40, s[20:23], s46 offen sc1 lds
    s_mov_b32 m0, 151808
    s_nop 0
    buffer_load_dword v41, s[20:23], s46 offen sc1 lds
    v_or_b32 v28, 0x800, v28
    v_add_u32 v16, v27, v1
    s_waitcnt vmcnt(0)
    ds_write_b32 v16, v28 offset:256
F_p2g:
    s_mov_b32 s59, 0
    s_branch F_p2c
F_p2:
    s_and_b32 s30, s28, 1
    s_lshl_b32 s30, s30, 3
    s_and_b32 s31, s28, 2
    s_lshl_b32 s31, s31, 1
    s_add_u32 s30, s30, s31
    s_lshr_b32 s31, s29, 3
    s_add_u32 s30, s30, s31
    s_and_b32 s34, s29, 7
    s_add_u32 s32, s28, 3
    s_and_b32 s32, s32, 7
    s_cmp_eq_u32 s29, 27
    s_cselect_b32 s34, s32, s34
    s_add_u32 s32, s32, 24
    s_cmp_eq_u32 s29, s32
    s_cselect_b32 s34, 3, s34
    s_and_b32 s32, s28, 4
    s_lshl_b32 s32, s32, 1
    s_add_u32 s32, s32, s34
    s_sub_u32 s3, s3, 4
    s_mov_b32 s36, 2048
    v_lshrrev_b32 v14, 3, v0
    v_and_b32 v15, 6, v14
    v_and_b32 v220, 7, v0
    v_xor_b32 v220, v220, v15
    v_lshlrev_b32 v220, 4, v220
    v_mul_lo_u32 v14, v14, s36
    v_add_u32 v220, v220, v14
    s_lshl_b32 s36, s32, 7
    v_add_u32 v220, s36, v220
    v_add_u32 v221, 15360, v220
    v_add_u32 v222, 30720, v220
    v_add_u32 v223, 46080, v220
    s_mov_b32 s12, s84
    s_mov_b32 s13, s85
    s_mov_b32 s14, 0x200000
    s_mov_b32 s15, 0x20000
F_p2c:
    s_mov_b32 s8, s4
    s_mov_b32 s9, s5
    s_mov_b32 s10, 0x400000
    s_mov_b32 s11, 0x20000
    s_mov_b32 s16, s86
    s_mov_b32 s17, s87
    s_mov_b32 s18, 0x400000
    s_mov_b32 s19, 0x20000
    s_mov_b32 s20, s74
    s_mov_b32 s21, s75
    s_mov_b32 s22, 0x1000000
    s_mov_b32 s23, 0x20000
    s_lshl_b32 s35, s30, 7
    s_lshl_b32 s36, s3, 5
    s_add_u32 s35, s35, s36
    v_and_b32 v14, 15, v0
    v_add_u32 v14, s35, v14
    v_lshlrev_b32 v7, 3, v14
    v_add_u32 v7, 0x4000, v7
    v_lshlrev_b32 v6, 11, v14
    v_bfe_u32 v15, v0, 4, 1
    v_lshl_add_u32 v6, v15, 5, v6
    v_lshrrev_b32 v15, 5, v0
    v_lshl_add_u32 v6, v15, 4, v6
    s_lshl_b32 s36, s32, 7
    v_add_u32 v6, s36, v6
    s_lshl_b32 s36, s35, 11
    s_add_u32 s36, s36, 0x100000
    v_lshl_add_u32 v4, v0, 4, s36
    v_add_u32 v5, 0x8000, v4
    s_mov_b32 s37, 0x8000
    s_branch F_sp_4_e
F_sp_4:
    s_sleep 2
F_sp_4_e:
    ds_read_b32 v8, v1 offset:256
    s_waitcnt lgkmcnt(0)
    v_readfirstlane_b32 s49, v8
    s_nop 0
    s_cmp_lg_u32 s49, 0
    s_cbranch_scc0 F_sp_4
    buffer_load_dwordx2 v[216:217], v7, s[20:23], 0 offen offset:0 sc1
    buffer_load_dwordx4 v[200:203], v6, s[8:11], 0 offen offset:0
    buffer_load_dwordx4 v[204:207], v6, s[8:11], 0 offen offset:64
    buffer_load_dwordx2 v[218:219], v7, s[20:23], 0 offen offset:128 sc1
    buffer_load_dwordx4 v[208:211], v6, s[8:11], s37 offen offset:0
    buffer_load_dwordx4 v[212:215], v6, s[8:11], s37 offen offset:64
    s_branch F_sp_5_e
F_sp_5:
    s_sleep 1
F_sp_5_e:
    ds_read_b32 v8, v1 offset:44
    s_waitcnt lgkmcnt(0)
    v_readfirstlane_b32 s49, v8
    s_nop 0
    s_cmp_lg_u32 s49, 0
    s_cbranch_scc0 F_sp_5
    s_branch F_sp_6_e
F_sp_6:
    s_sleep 1
F_sp_6_e:
    ds_read_b32 v8, v1 offset:52
    s_waitcnt lgkmcnt(0)
    v_readfirstlane_b32 s49, v8
    s_nop 0
    s_cmp_lg_u32 s49, 0
    s_cbranch_scc0 F_sp_6
    s_mul_i32 s49, s3, 8192
    s_lshl_b32 s38, s49, 4
    s_add_u32 s49, s49, 16384
    s_add_u32 s38, s38, 1572864
    s_add_u32 m0, s49, 0
    s_nop 0
    buffer_load_dwordx4 v220, s[12:15], s38 offen offset:0 lds
    buffer_load_dwordx4 v221, s[12:15], s38 offen offset:1024 lds
    buffer_load_dwordx4 v222, s[12:15], s38 offen offset:2048 lds
    buffer_load_dwordx4 v223, s[12:15], s38 offen offset:3072 lds
    s_add_u32 m0, s49, 4096
    s_add_u32 s38, s38, 0x10000
    buffer_load_dwordx4 v220, s[12:15], s38 offen offset:0 lds
    buffer_load_dwordx4 v221, s[12:15], s38 offen offset:1024 lds
    buffer_load_dwordx4 v222, s[12:15], s38 offen offset:2048 lds
    buffer_load_dwordx4 v223, s[12:15], s38 offen offset:3072 lds
    s_waitcnt vmcnt(8)
    s_branch F_p2e
F_p2d:
    s_mul_i32 s49, s3, 12288
    s_lshl_b32 s38, s49, 4
    s_add_u32 s49, s49, 49152
    s_add_u32 s38, s38, 0
    s_add_u32 m0, s49, 0
    s_nop 0
    buffer_load_dwordx4 v220, s[12:15], s38 offen offset:0 lds
    buffer_load_dwordx4 v221, s[12:15], s38 offen offset:1024 lds
    buffer_load_dwordx4 v222, s[12:15], s38 offen offset:2048 lds
    buffer_load_dwordx4 v223, s[12:15], s38 offen offset:3072 lds
    s_add_u32 m0, s49, 4096
    s_add_u32 s38, s38, 0x10000
    buffer_load_dwordx4 v220, s[12:15], s38 offen offset:0 lds
    buffer_load_dwordx4 v221, s[12:15], s38 offen offset:1024 lds
    buffer_load_dwordx4 v222, s[12:15], s38 offen offset:2048 lds
    buffer_load_dwordx4 v223, s[12:15], s38 offen offset:3072 lds
    s_add_u32 m0, s49, 8192
    s_add_u32 s38, s38, 0x10000
    buffer_load_dwordx4 v220, s[12:15], s38 offen offset:0 lds
    buffer_load_dwordx4 v221, s[12:15], s38 offen offset:1024 lds
    buffer_load_dwordx4 v222, s[12:15], s38 offen offset:2048 lds
    buffer_load_dwordx4 v223, s[12:15], s38 offen offset:3072 lds
    s_waitcnt vmcnt(16)
F_p2e:
    ds_read_b128 v[24:27], v1 offset:256
    ds_read_b128 v[28:31], v1 offset:272
    v_mov_b32 v22, v217
    v_mov_b32 v23, v217
    v_mov_b32 v217, v216
    v_permlane16_swap_b32 v200, v202
    v_permlane16_swap_b32 v201, v203
    v_permlane16_swap_b32 v204, v206
    v_permlane16_swap_b32 v205, v207
    v_lshlrev_b32 v224, 16, v200
    v_and_b32 v225, s39, v200
    v_lshlrev_b32 v226, 16, v201
    v_and_b32 v227, s39, v201
    v_pk_add_f32 v[16:17], v[224:225], v[216:217] neg_lo:[0,1] neg_hi:[0,1]
    v_pk_add_f32 v[18:19], v[226:227], v[216:217] neg_lo:[0,1] neg_hi:[0,1]
    v_cvt_pk_bf16_f32 v20, v16, v17
    v_cvt_pk_bf16_f32 v21, v18, v19
    v_lshlrev_b32 v16, 16, v20
    v_and_b32 v17, s39, v20
    v_lshlrev_b32 v18, 16, v21
    v_and_b32 v19, s39, v21
    v_pk_mul_f32 v[16:17], v[16:17], v[22:23]
    v_pk_mul_f32 v[18:19], v[18:19], v[22:23]
    v_cvt_pk_bf16_f32 v20, v16, v17
    v_cvt_pk_bf16_f32 v21, v18, v19
    v_lshlrev_b32 v16, 16, v20
    v_and_b32 v17, s39, v20
    v_lshlrev_b32 v18, 16, v21
    v_and_b32 v19, s39, v21
    v_pk_add_f32 v[224:225], v[224:225], v[16:17]
    v_pk_add_f32 v[226:227], v[226:227], v[18:19]
    v_lshlrev_b32 v228, 16, v202
    v_and_b32 v229, s39, v202
    v_lshlrev_b32 v230, 16, v203
    v_and_b32 v231, s39, v203
    v_pk_add_f32 v[16:17], v[228:229], v[216:217] neg_lo:[0,1] neg_hi:[0,1]
    v_pk_add_f32 v[18:19], v[230:231], v[216:217] neg_lo:[0,1] neg_hi:[0,1]
    v_cvt_pk_bf16_f32 v20, v16, v17
    v_cvt_pk_bf16_f32 v21, v18, v19
    v_lshlrev_b32 v16, 16, v20
    v_and_b32 v17, s39, v20
    v_lshlrev_b32 v18, 16, v21
    v_and_b32 v19, s39, v21
    v_pk_mul_f32 v[16:17], v[16:17], v[22:23]
    v_pk_mul_f32 v[18:19], v[18:19], v[22:23]
    v_cvt_pk_bf16_f32 v20, v16, v17
    v_cvt_pk_bf16_f32 v21, v18, v19
    v_lshlrev_b32 v16, 16, v20
    v_and_b32 v17, s39, v20
    v_lshlrev_b32 v18, 16, v21
    v_and_b32 v19, s39, v21
    v_pk_add_f32 v[228:229], v[228:229], v[16:17]
    v_pk_add_f32 v[230:231], v[230:231], v[18:19]
    v_lshlrev_b32 v232, 16, v204
    v_and_b32 v233, s39, v204
    v_lshlrev_b32 v234, 16, v205
    v_and_b32 v235, s39, v205
    v_pk_add_f32 v[16:17], v[232:233], v[216:217] neg_lo:[0,1] neg_hi:[0,1]
    v_pk_add_f32 v[18:19], v[234:235], v[216:217] neg_lo:[0,1] neg_hi:[0,1]
    v_cvt_pk_bf16_f32 v20, v16, v17
    v_cvt_pk_bf16_f32 v21, v18, v19
    v_lshlrev_b32 v16, 16, v20
    v_and_b32 v17, s39, v20
    v_lshlrev_b32 v18, 16, v21
    v_and_b32 v19, s39, v21
    v_pk_mul_f32 v[16:17], v[16:17], v[22:23]
    v_pk_mul_f32 v[18:19], v[18:19], v[22:23]
    v_cvt_pk_bf16_f32 v20, v16, v17
    v_cvt_pk_bf16_f32 v21, v18, v19
    v_lshlrev_b32 v16, 16, v20
    v_and_b32 v17, s39, v20
    v_lshlrev_b32 v18, 16, v21
    v_and_b32 v19, s39, v21
    v_pk_add_f32 v[232:233], v[232:233], v[16:17]
    v_pk_add_f32 v[234:235], v[234:235], v[18:19]
    v_lshlrev_b32 v236, 16, v206
    v_and_b32 v237, s39, v206
    v_lshlrev_b32 v238, 16, v207
    v_and_b32 v239, s39, v207
    v_pk_add_f32 v[16:17], v[236:237], v[216:217] neg_lo:[0,1] neg_hi:[0,1]
    v_pk_add_f32 v[18:19], v[238:239], v[216:217] neg_lo:[0,1] neg_hi:[0,1]
    v_cvt_pk_bf16_f32 v20, v16, v17
    v_cvt_pk_bf16_f32 v21, v18, v19
    v_lshlrev_b32 v16, 16, v20
    v_and_b32 v17, s39, v20
    v_lshlrev_b32 v18, 16, v21
    v_and_b32 v19, s39, v21
    v_pk_mul_f32 v[16:17], v[16:17], v[22:23]
    v_pk_mul_f32 v[18:19], v[18:19], v[22:23]
    v_cvt_pk_bf16_f32 v20, v16, v17
    v_cvt_pk_bf16_f32 v21, v18, v19
    v_lshlrev_b32 v16, 16, v20
    v_and_b32 v17, s39, v20
    v_lshlrev_b32 v18, 16, v21
    v_and_b32 v19, s39, v21
    v_pk_add_f32 v[236:237], v[236:237], v[16:17]
    v_pk_add_f32 v[238:239], v[238:239], v[18:19]
    s_cmp_lg_u32 s59, 1
    s_cbranch_scc1 F_nl3
    s_waitcnt vmcnt(12)
    s_barrier
    s_mul_i32 s49, s3, 12288
    s_lshl_b32 s38, s49, 4
    s_add_u32 s49, s49, 98304
    s_add_u32 s38, s38, 786432
    s_add_u32 m0, s49, 0
    s_nop 0
    buffer_load_dwordx4 v220, s[12:15], s38 offen offset:0 lds
    buffer_load_dwordx4 v221, s[12:15], s38 offen offset:1024 lds
    buffer_load_dwordx4 v222, s[12:15], s38 offen offset:2048 lds
    buffer_load_dwordx4 v223, s[12:15], s38 offen offset:3072 lds
    s_add_u32 m0, s49, 4096
    s_add_u32 s38, s38, 0x10000
    buffer_load_dwordx4 v220, s[12:15], s38 offen offset:0 lds
    buffer_load_dwordx4 v221, s[12:15], s38 offen offset:1024 lds
    buffer_load_dwordx4 v222, s[12:15], s38 offen offset:2048 lds
    buffer_load_dwordx4 v223, s[12:15], s38 offen offset:3072 lds
    s_add_u32 m0, s49, 8192
    s_add_u32 s38, s38, 0x10000
    buffer_load_dwordx4 v220, s[12:15], s38 offen offset:0 lds
    buffer_load_dwordx4 v221, s[12:15], s38 offen offset:1024 lds
    buffer_load_dwordx4 v222, s[12:15], s38 offen offset:2048 lds
    buffer_load_dwordx4 v223, s[12:15], s38 offen offset:3072 lds
F_nl3:
    v_mov_b32 v22, v219
    v_mov_b32 v23, v219
    v_mov_b32 v219, v218
    v_permlane16_swap_b32 v208, v210
    v_permlane16_swap_b32 v209, v211
    v_permlane16_swap_b32 v212, v214
    v_permlane16_swap_b32 v213, v215
    v_lshlrev_b32 v240, 16, v208
    v_and_b32 v241, s39, v208
    v_lshlrev_b32 v242, 16, v209
    v_and_b32 v243, s39, v209
    v_pk_add_f32 v[16:17], v[240:241], v[218:219] neg_lo:[0,1] neg_hi:[0,1]
    v_pk_add_f32 v[18:19], v[242:243], v[218:219] neg_lo:[0,1] neg_hi:[0,1]
    v_cvt_pk_bf16_f32 v20, v16, v17
    v_cvt_pk_bf16_f32 v21, v18, v19
    v_lshlrev_b32 v16, 16, v20
    v_and_b32 v17, s39, v20
    v_lshlrev_b32 v18, 16, v21
    v_and_b32 v19, s39, v21
    v_pk_mul_f32 v[16:17], v[16:17], v[22:23]
    v_pk_mul_f32 v[18:19], v[18:19], v[22:23]
    v_cvt_pk_bf16_f32 v20, v16, v17
    v_cvt_pk_bf16_f32 v21, v18, v19
    v_lshlrev_b32 v16, 16, v20
    v_and_b32 v17, s39, v20
    v_lshlrev_b32 v18, 16, v21
    v_and_b32 v19, s39, v21
    v_pk_add_f32 v[240:241], v[240:241], v[16:17]
    v_pk_add_f32 v[242:243], v[242:243], v[18:19]
    v_lshlrev_b32 v244, 16, v210
    v_and_b32 v245, s39, v210
    v_lshlrev_b32 v246, 16, v211
    v_and_b32 v247, s39, v211
    v_pk_add_f32 v[16:17], v[244:245], v[218:219] neg_lo:[0,1] neg_hi:[0,1]
    v_pk_add_f32 v[18:19], v[246:247], v[218:219] neg_lo:[0,1] neg_hi:[0,1]
    v_cvt_pk_bf16_f32 v20, v16, v17
    v_cvt_pk_bf16_f32 v21, v18, v19
    v_lshlrev_b32 v16, 16, v20
    v_and_b32 v17, s39, v20
    v_lshlrev_b32 v18, 16, v21
    v_and_b32 v19, s39, v21
    v_pk_mul_f32 v[16:17], v[16:17], v[22:23]
    v_pk_mul_f32 v[18:19], v[18:19], v[22:23]
    v_cvt_pk_bf16_f32 v20, v16, v17
    v_cvt_pk_bf16_f32 v21, v18, v19
    v_lshlrev_b32 v16, 16, v20
    v_and_b32 v17, s39, v20
    v_lshlrev_b32 v18, 16, v21
    v_and_b32 v19, s39, v21
    v_pk_add_f32 v[244:245], v[244:245], v[16:17]
    v_pk_add_f32 v[246:247], v[246:247], v[18:19]
    v_lshlrev_b32 v248, 16, v212
    v_and_b32 v249, s39, v212
    v_lshlrev_b32 v250, 16, v213
    v_and_b32 v251, s39, v213
    v_pk_add_f32 v[16:17], v[248:249], v[218:219] neg_lo:[0,1] neg_hi:[0,1]
    v_pk_add_f32 v[18:19], v[250:251], v[218:219] neg_lo:[0,1] neg_hi:[0,1]
    v_cvt_pk_bf16_f32 v20, v16, v17
    v_cvt_pk_bf16_f32 v21, v18, v19
    v_lshlrev_b32 v16, 16, v20
    v_and_b32 v17, s39, v20
    v_lshlrev_b32 v18, 16, v21
    v_and_b32 v19, s39, v21
    v_pk_mul_f32 v[16:17], v[16:17], v[22:23]
    v_pk_mul_f32 v[18:19], v[18:19], v[22:23]
    v_cvt_pk_bf16_f32 v20, v16, v17
    v_cvt_pk_bf16_f32 v21, v18, v19
    v_lshlrev_b32 v16, 16, v20
    v_and_b32 v17, s39, v20
    v_lshlrev_b32 v18, 16, v21
    v_and_b32 v19, s39, v21
    v_pk_add_f32 v[248:249], v[248:249], v[16:17]
    v_pk_add_f32 v[250:251], v[250:251], v[18:19]
    v_lshlrev_b32 v252, 16, v214
    v_and_b32 v253, s39, v214
    v_lshlrev_b32 v254, 16, v215
    v_and_b32 v255, s39, v215
    v_pk_add_f32 v[16:17], v[252:253], v[218:219] neg_lo:[0,1] neg_hi:[0,1]
    v_pk_add_f32 v[18:19], v[254:255], v[218:219] neg_lo:[0,1] neg_hi:[0,1]
    v_cvt_pk_bf16_f32 v20, v16, v17
    v_cvt_pk_bf16_f32 v21, v18, v19
    v_lshlrev_b32 v16, 16, v20
    v_and_b32 v17, s39, v20
    v_lshlrev_b32 v18, 16, v21
    v_and_b32 v19, s39, v21
    v_pk_mul_f32 v[16:17], v[16:17], v[22:23]
    v_pk_mul_f32 v[18:19], v[18:19], v[22:23]
    v_cvt_pk_bf16_f32 v20, v16, v17
    v_cvt_pk_bf16_f32 v21, v18, v19
    v_lshlrev_b32 v16, 16, v20
    v_and_b32 v17, s39, v20
    v_lshlrev_b32 v18, 16, v21
    v_and_b32 v19, s39, v21
    v_pk_add_f32 v[252:253], v[252:253], v[16:17]
    v_pk_add_f32 v[254:255], v[254:255], v[18:19]
    s_cmp_lg_u32 s59, 1
    s_cbranch_scc1 F_nl4
    s_mul_i32 s49, s3, 8192
    s_lshl_b32 s38, s49, 4
    s_add_u32 s49, s49, 16384
    s_add_u32 s38, s38, 1572864
    s_add_u32 m0, s49, 0
    s_nop 0
    buffer_load_dwordx4 v220, s[12:15], s38 offen offset:0 lds
    buffer_load_dwordx4 v221, s[12:15], s38 offen offset:1024 lds
    buffer_load_dwordx4 v222, s[12:15], s38 offen offset:2048 lds
    buffer_load_dwordx4 v223, s[12:15], s38 offen offset:3072 lds
    s_add_u32 m0, s49, 4096
    s_add_u32 s38, s38, 0x10000
    buffer_load_dwordx4 v220, s[12:15], s38 offen offset:0 lds
    buffer_load_dwordx4 v221, s[12:15], s38 offen offset:1024 lds
    buffer_load_dwordx4 v222, s[12:15], s38 offen offset:2048 lds
    buffer_load_dwordx4 v223, s[12:15], s38 offen offset:3072 lds
F_nl4:
    s_waitcnt lgkmcnt(0)
    v_readfirstlane_b32 s40, v24
    v_readfirstlane_b32 s41, v25
    v_readfirstlane_b32 s42, v26
    v_readfirstlane_b32 s43, v27
    v_readfirstlane_b32 s44, v28
    v_readfirstlane_b32 s45, v29
    v_readfirstlane_b32 s46, v30
    v_readfirstlane_b32 s47, v31
    v_bfe_u32 v14, v0, 2, 3
    v_lshrrev_b32 v15, 1, v14
    v_xor_b32 v15, 0, v15
    v_lshlrev_b32 v60, 5, v15
    v_lshl_add_u32 v60, v14, 7, v60
    v_and_b32 v14, 3, v0
    v_lshl_add_u32 v60, v14, 3, v60
    v_lshrrev_b32 v14, 5, v0
    v_lshl_add_u32 v60, v14, 10, v60
    v_add_u32 v60, 0x4000, v60
    v_bfe_u32 v14, v0, 2, 3
    v_lshrrev_b32 v15, 1, v14
    v_xor_b32 v15, 1, v15
    v_lshlrev_b32 v61, 5, v15
    v_lshl_add_u32 v61, v14, 7, v61
    v_and_b32 v14, 3, v0
    v_lshl_add_u32 v61, v14, 3, v61
    v_lshrrev_b32 v14, 5, v0
    v_lshl_add_u32 v61, v14, 10, v61
    v_add_u32 v61, 0x4000, v61
    v_bfe_u32 v14, v0, 2, 3
    v_lshrrev_b32 v15, 1, v14
    v_xor_b32 v15, 2, v15
    v_lshlrev_b32 v62, 5, v15
    v_lshl_add_u32 v62, v14, 7, v62
    v_and_b32 v14, 3, v0
    v_lshl_add_u32 v62, v14, 3, v62
    v_lshrrev_b32 v14, 5, v0
    v_lshl_add_u32 v62, v14, 10, v62
    v_add_u32 v62, 0x4000, v62
    v_bfe_u32 v14, v0, 2, 3
    v_lshrrev_b32 v15, 1, v14
    v_xor_b32 v15, 3, v15
    v_lshlrev_b32 v63, 5, v15
    v_lshl_add_u32 v63, v14, 7, v63
    v_and_b32 v14, 3, v0
    v_lshl_add_u32 v63, v14, 3, v63
    v_lshrrev_b32 v14, 5, v0
    v_lshl_add_u32 v63, v14, 10, v63
    v_add_u32 v63, 0x4000, v63
    v_mov_b32 v22, 2048
    v_mov_b32 v23, 2048
    s_mov_b32 s48, 0
    v_and_b32 v14, 15, v0
    v_add_u32 v14, s35, v14
    v_add_u32 v15, 16, v14
    s_and_b32 s49, s40, 0x7ff
    s_sub_u32 s49, 2047, s49
    s_sub_u32 s50, s49, s35
    s_cmp_lt_u32 s50, 32
    s_cselect_b32 s48, 1, s48
    v_mov_b32 v16, 0
    v_cmp_eq_u32 vcc, s49, v14
    v_cmp_eq_u32 s[52:53], s49, v15
    s_nop 0
    v_cndmask_b32 v22, v22, v16, vcc
    v_cndmask_b32 v23, v23, v16, s[52:53]
    s_and_b32 s49, s41, 0x7ff
    s_sub_u32 s49, 2047, s49
    s_sub_u32 s50, s49, s35
    s_cmp_lt_u32 s50, 32
    s_cselect_b32 s48, 1, s48
    v_mov_b32 v16, 256
    v_cmp_eq_u32 vcc, s49, v14
    v_cmp_eq_u32 s[52:53], s49, v15
    s_nop 0
    v_cndmask_b32 v22, v22, v16, vcc
    v_cndmask_b32 v23, v23, v16, s[52:53]
    s_and_b32 s49, s42, 0x7ff
    s_sub_u32 s49, 2047, s49
    s_sub_u32 s50, s49, s35
    s_cmp_lt_u32 s50, 32
    s_cselect_b32 s48, 1, s48
    v_mov_b32 v16, 512
    v_cmp_eq_u32 vcc, s49, v14
    v_cmp_eq_u32 s[52:53], s49, v15
    s_nop 0
    v_cndmask_b32 v22, v22, v16, vcc
    v_cndmask_b32 v23, v23, v16, s[52:53]
    s_and_b32 s49, s43, 0x7ff
    s_sub_u32 s49, 2047, s49
    s_sub_u32 s50, s49, s35
    s_cmp_lt_u32 s50, 32
    s_cselect_b32 s48, 1, s48
    v_mov_b32 v16, 768
    v_cmp_eq_u32 vcc, s49, v14
    v_cmp_eq_u32 s[52:53], s49, v15
    s_nop 0
    v_cndmask_b32 v22, v22, v16, vcc
    v_cndmask_b32 v23, v23, v16, s[52:53]
    s_and_b32 s49, s44, 0x7ff
    s_sub_u32 s49, 2047, s49
    s_sub_u32 s50, s49, s35
    s_cmp_lt_u32 s50, 32
    s_cselect_b32 s48, 1, s48
    v_mov_b32 v16, 1024
    v_cmp_eq_u32 vcc, s49, v14
    v_cmp_eq_u32 s[52:53], s49, v15
    s_nop 0
    v_cndmask_b32 v22, v22, v16, vcc
    v_cndmask_b32 v23, v23, v16, s[52:53]
    s_and_b32 s49, s45, 0x7ff
    s_sub_u32 s49, 2047, s49
    s_sub_u32 s50, s49, s35
    s_cmp_lt_u32 s50, 32
    s_cselect_b32 s48, 1, s48
    v_mov_b32 v16, 1280
    v_cmp_eq_u32 vcc, s49, v14
    v_cmp_eq_u32 s[52:53], s49, v15
    s_nop 0
    v_cndmask_b32 v22, v22, v16, vcc
    v_cndmask_b32 v23, v23, v16, s[52:53]
    s_and_b32 s49, s46, 0x7ff
    s_sub_u32 s49, 2047, s49
    s_sub_u32 s50, s49, s35
    s_cmp_lt_u32 s50, 32
    s_cselect_b32 s48, 1, s48
    v_mov_b32 v16, 1536
    v_cmp_eq_u32 vcc, s49, v14
    v_cmp_eq_u32 s[52:53], s49, v15
    s_nop 0
    v_cndmask_b32 v22, v22, v16, vcc
    v_cndmask_b32 v23, v23, v16, s[52:53]
    s_and_b32 s49, s47, 0x7ff
    s_sub_u32 s49, 2047, s49
    s_sub_u32 s50, s49, s35
    s_cmp_lt_u32 s50, 32
    s_cselect_b32 s48, 1, s48
    v_mov_b32 v16, 1792
    v_cmp_eq_u32 vcc, s49, v14
    v_cmp_eq_u32 s[52:53], s49, v15
    s_nop 0
    v_cndmask_b32 v22, v22, v16, vcc
    v_cndmask_b32 v23, v23, v16, s[52:53]
    v_lshrrev_b32 v16, 4, v0
    v_lshlrev_b32 v16, 4, v16
    v_add_u32 v16, 157184, v16
    v_add_u32 v22, v22, v16
    v_add_u32 v23, v23, v16
    s_cmp_lg_u32 s59, 2
    s_cbranch_scc1 F_nl2
    s_barrier
    s_mul_i32 s49, s3, 12288
    s_lshl_b32 s38, s49, 4
    s_add_u32 s49, s49, 49152
    s_add_u32 s38, s38, 0
    s_add_u32 m0, s49, 0
    s_nop 0
    buffer_load_dwordx4 v220, s[12:15], s38 offen offset:0 lds
    buffer_load_dwordx4 v221, s[12:15], s38 offen offset:1024 lds
    buffer_load_dwordx4 v222, s[12:15], s38 offen offset:2048 lds
    buffer_load_dwordx4 v223, s[12:15], s38 offen offset:3072 lds
    s_add_u32 m0, s49, 4096
    s_add_u32 s38, s38, 0x10000
    buffer_load_dwordx4 v220, s[12:15], s38 offen offset:0 lds
    buffer_load_dwordx4 v221, s[12:15], s38 offen offset:1024 lds
    buffer_load_dwordx4 v222, s[12:15], s38 offen offset:2048 lds
    buffer_load_dwordx4 v223, s[12:15], s38 offen offset:3072 lds
    s_add_u32 m0, s49, 8192
    s_add_u32 s38, s38, 0x10000
    buffer_load_dwordx4 v220, s[12:15], s38 offen offset:0 lds
    buffer_load_dwordx4 v221, s[12:15], s38 offen offset:1024 lds
    buffer_load_dwordx4 v222, s[12:15], s38 offen offset:2048 lds
    buffer_load_dwordx4 v223, s[12:15], s38 offen offset:3072 lds
    s_mul_i32 s49, s3, 12288
    s_lshl_b32 s38, s49, 4
    s_add_u32 s49, s49, 98304
    s_add_u32 s38, s38, 786432
    s_add_u32 m0, s49, 0
    s_nop 0
    buffer_load_dwordx4 v220, s[12:15], s38 offen offset:0 lds
    buffer_load_dwordx4 v221, s[12:15], s38 offen offset:1024 lds
    buffer_load_dwordx4 v222, s[12:15], s38 offen offset:2048 lds
    buffer_load_dwordx4 v223, s[12:15], s38 offen offset:3072 lds
    s_add_u32 m0, s49, 4096
    s_add_u32 s38, s38, 0x10000
    buffer_load_dwordx4 v220, s[12:15], s38 offen offset:0 lds
    buffer_load_dwordx4 v221, s[12:15], s38 offen offset:1024 lds
    buffer_load_dwordx4 v222, s[12:15], s38 offen offset:2048 lds
    buffer_load_dwordx4 v223, s[12:15], s38 offen offset:3072 lds
    s_add_u32 m0, s49, 8192
    s_add_u32 s38, s38, 0x10000
    buffer_load_dwordx4 v220, s[12:15], s38 offen offset:0 lds
    buffer_load_dwordx4 v221, s[12:15], s38 offen offset:1024 lds
    buffer_load_dwordx4 v222, s[12:15], s38 offen offset:2048 lds
    buffer_load_dwordx4 v223, s[12:15], s38 offen offset:3072 lds
F_nl2:
    v_mov_b32 v16, 1
    s_mov_b64 exec, 1
    s_waitcnt vmcnt(0)
    ds_add_u32 v1, v16 offset:24
    s_mov_b64 exec, -1
    s_mov_b32 s54, 0
    s_mov_b32 s55, 0
    s_lshl_b32 s34, s34, 1
    s_mov_b32 s57, 0
    s_lshl_b32 s49, s30, 3
    s_mul_i32 s50, s49, 187
    s_lshr_b32 s50, s50, 11
    s_lshr_b32 s51, s35, 4
    s_mul_i32 s52, s51, 187
    s_lshr_b32 s52, s52, 11
    s_cmp_eq_u32 s50, s52
    s_cselect_b32 s57, 0, 0xffff
    s_add_u32 s49, s49, 7
    s_mul_i32 s50, s49, 187
    s_lshr_b32 s50, s50, 11
    s_add_u32 s51, s51, 1
    s_mul_i32 s52, s51, 187
    s_lshr_b32 s52, s52, 11
    s_cmp_eq_u32 s50, s52
    s_cselect_b32 s50, 0, s39
    s_or_b32 s57, s57, s50
F_sa_7:
    s_andn2_b32 s49, s54, s55
    s_cbranch_scc1 F_sb_8
    ds_read_b32 v8, v1 offset:28
    s_waitcnt lgkmcnt(0)
    v_readfirstlane_b32 s54, v8
    s_nop 0
    s_or_b32 s54, s54, s57
    s_lshr_b32 s50, s54, 16
    s_and_b32 s54, s54, s50
    s_lshr_b32 s50, s54, 1
    s_and_b32 s54, s54, s50
    s_and_b32 s54, s54, 0x5555
    s_branch F_sa_7
F_sb_8:
    s_lshl_b32 s50, s49, 16
    s_or_b32 s49, s49, s50
    s_lshr_b32 s49, s49, s34
    s_ff1_i32_b32 s49, s49
    s_add_u32 s49, s49, s34
    s_and_b32 s49, s49, 15
    s_bitset1_b32 s55, s49
    s_lshl_b32 s38, s49, 11
    s_add_u32 s49, s49, 4
    s_and_b32 s49, s49, 15
    s_lshl_b32 s64, s49, 13
F_sc_9:
    buffer_load_dwordx4 v[96:99], v4, s[20:23], s38 offen offset:0 sc1
    buffer_load_dwordx4 v[100:103], v5, s[20:23], s38 offen offset:0 sc1
    buffer_load_dwordx4 v[104:107], v4, s[20:23], s38 offen offset:1024 sc1
    buffer_load_dwordx4 v[108:111], v5, s[20:23], s38 offen offset:1024 sc1
    buffer_load_dwordx4 v[112:115], v4, s[20:23], s38 offen offset:2048 sc1
    buffer_load_dwordx4 v[116:119], v5, s[20:23], s38 offen offset:2048 sc1
    buffer_load_dwordx4 v[120:123], v4, s[20:23], s38 offen offset:3072 sc1
    buffer_load_dwordx4 v[124:127], v5, s[20:23], s38 offen offset:3072 sc1
F_sa_10:
    s_andn2_b32 s49, s54, s55
    s_cbranch_scc1 F_sb_11
    ds_read_b32 v8, v1 offset:28
    s_waitcnt lgkmcnt(0)
    v_readfirstlane_b32 s54, v8
    s_nop 0
    s_or_b32 s54, s54, s57
    s_lshr_b32 s50, s54, 16
    s_and_b32 s54, s54, s50
    s_lshr_b32 s50, s54, 1
    s_and_b32 s54, s54, s50
    s_and_b32 s54, s54, 0x5555
    s_branch F_sa_10
F_sb_11:
    s_lshl_b32 s50, s49, 16
    s_or_b32 s49, s49, s50
    s_lshr_b32 s49, s49, s34
    s_ff1_i32_b32 s49, s49
    s_add_u32 s49, s49, s34
    s_and_b32 s49, s49, 15
    s_bitset1_b32 s55, s49
    s_lshl_b32 s38, s49, 11
    s_add_u32 s49, s49, 4
    s_and_b32 s49, s49, 15
    s_lshl_b32 s65, s49, 13
F_sc_12:
    buffer_load_dwordx4 v[128:131], v4, s[20:23], s38 offen offset:0 sc1
    buffer_load_dwordx4 v[132:135], v5, s[20:23], s38 offen offset:0 sc1
    buffer_load_dwordx4 v[136:139], v4, s[20:23], s38 offen offset:1024 sc1
    buffer_load_dwordx4 v[140:143], v5, s[20:23], s38 offen offset:1024 sc1
    buffer_load_dwordx4 v[144:147], v4, s[20:23], s38 offen offset:2048 sc1
    buffer_load_dwordx4 v[148:151], v5, s[20:23], s38 offen offset:2048 sc1
    buffer_load_dwordx4 v[152:155], v4, s[20:23], s38 offen offset:3072 sc1
    buffer_load_dwordx4 v[156:159], v5, s[20:23], s38 offen offset:3072 sc1
    v_add_u32 v10, s64, v60
    v_add_u32 v11, s64, v61
    v_add_u32 v12, s64, v62
    v_add_u32 v13, s64, v63
F_sp_13:
    ds_read_b32 v8, v1 offset:24
    s_waitcnt lgkmcnt(0)
    v_readfirstlane_b32 s49, v8
    s_nop 0
    s_cmp_ge_u32 s49, 4
    s_cbranch_scc0 F_sp_13
    ds_read_b64_tr_b16 v[40:41], v10 offset:0
    ds_read_b64_tr_b16 v[42:43], v10 offset:2048
    ds_read_b64_tr_b16 v[44:45], v11 offset:0
    ds_read_b64_tr_b16 v[46:47], v11 offset:2048
    ds_read_b64_tr_b16 v[48:49], v12 offset:0
    ds_read_b64_tr_b16 v[50:51], v12 offset:2048
    ds_read_b64_tr_b16 v[52:53], v13 offset:0
    ds_read_b64_tr_b16 v[54:55], v13 offset:2048
    s_waitcnt lgkmcnt(4)
    ds_read_b64_tr_b16 v[64:65], v10 offset:4096
    ds_read_b64_tr_b16 v[66:67], v10 offset:6144
    ds_read_b64_tr_b16 v[68:69], v11 offset:4096
    ds_read_b64_tr_b16 v[70:71], v11 offset:6144
    ds_read_b64_tr_b16 v[72:73], v12 offset:4096
    ds_read_b64_tr_b16 v[74:75], v12 offset:6144
    ds_read_b64_tr_b16 v[76:77], v13 offset:4096
    ds_read_b64_tr_b16 v[78:79], v13 offset:6144
    v_mov_b32 v9, 1
F_sa_14:
    s_andn2_b32 s49, s54, s55
    s_cbranch_scc0 F_ss_15
    s_lshl_b32 s50, s49, 16
    s_or_b32 s49, s49, s50
    s_lshr_b32 s49, s49, s34
    s_ff1_i32_b32 s49, s49
    s_add_u32 s49, s49, s34
    s_and_b32 s49, s49, 15
    s_bitset1_b32 s55, s49
    s_lshl_b32 s36, s49, 11
    s_add_u32 s49, s49, 4
    s_and_b32 s49, s49, 15
    s_lshl_b32 s66, s49, 13
    s_waitcnt vmcnt(14)
    s_waitcnt lgkmcnt(8)
    v_mfma_f32_16x16x32_bf16 v[224:227], v[40:43], v[96:99], v[224:227]
    ds_read_b64_tr_b16 v[80:81], v10 offset:8192
    v_mfma_f32_16x16x32_bf16 v[240:243], v[40:43], v[100:103], v[240:243]
    ds_read_b64_tr_b16 v[82:83], v10 offset:10240
    v_mfma_f32_16x16x32_bf16 v[228:231], v[44:47], v[96:99], v[228:231]
    ds_read_b64_tr_b16 v[84:85], v11 offset:8192
    buffer_load_dwordx4 v[160:163], v4, s[20:23], s36 offen offset:0 sc1
    v_mfma_f32_16x16x32_bf16 v[244:247], v[44:47], v[100:103], v[244:247]
    ds_read_b64_tr_b16 v[86:87], v11 offset:10240
    v_mfma_f32_16x16x32_bf16 v[232:235], v[48:51], v[96:99], v[232:235]
    ds_read_b64_tr_b16 v[88:89], v12 offset:8192
    v_mfma_f32_16x16x32_bf16 v[248:251], v[48:51], v[100:103], v[248:251]
    ds_read_b64_tr_b16 v[90:91], v12 offset:10240
    v_mfma_f32_16x16x32_bf16 v[236:239], v[52:55], v[96:99], v[236:239]
    ds_read_b64_tr_b16 v[92:93], v13 offset:8192
    buffer_load_dwordx4 v[164:167], v5, s[20:23], s36 offen offset:0 sc1
    v_mfma_f32_16x16x32_bf16 v[252:255], v[52:55], v[100:103], v[252:255]
    ds_read_b64_tr_b16 v[94:95], v13 offset:10240
    s_waitcnt vmcnt(14)
    s_waitcnt lgkmcnt(8)
    v_mfma_f32_16x16x32_bf16 v[224:227], v[64:67], v[104:107], v[224:227]
    ds_read_b64_tr_b16 v[40:41], v10 offset:12288
    v_mfma_f32_16x16x32_bf16 v[240:243], v[64:67], v[108:111], v[240:243]
    ds_read_b64_tr_b16 v[42:43], v10 offset:14336
    v_add_u32 v10, s65, v60
    v_mfma_f32_16x16x32_bf16 v[228:231], v[68:71], v[104:107], v[228:231]
    ds_read_b64_tr_b16 v[44:45], v11 offset:12288
    buffer_load_dwordx4 v[168:171], v4, s[20:23], s36 offen offset:1024 sc1
    v_mfma_f32_16x16x32_bf16 v[244:247], v[68:71], v[108:111], v[244:247]
    ds_read_b64_tr_b16 v[46:47], v11 offset:14336
    v_add_u32 v11, s65, v61
    v_mfma_f32_16x16x32_bf16 v[232:235], v[72:75], v[104:107], v[232:235]
    ds_read_b64_tr_b16 v[48:49], v12 offset:12288
    v_mfma_f32_16x16x32_bf16 v[248:251], v[72:75], v[108:111], v[248:251]
    ds_read_b64_tr_b16 v[50:51], v12 offset:14336
    v_add_u32 v12, s65, v62
    v_mfma_f32_16x16x32_bf16 v[236:239], v[76:79], v[104:107], v[236:239]
    ds_read_b64_tr_b16 v[52:53], v13 offset:12288
    buffer_load_dwordx4 v[172:175], v5, s[20:23], s36 offen offset:1024 sc1
    v_mfma_f32_16x16x32_bf16 v[252:255], v[76:79], v[108:111], v[252:255]
    ds_read_b64_tr_b16 v[54:55], v13 offset:14336
    v_add_u32 v13, s65, v63
    s_waitcnt vmcnt(14)
    s_waitcnt lgkmcnt(8)
    v_mfma_f32_16x16x32_bf16 v[224:227], v[80:83], v[112:115], v[224:227]
    ds_read_b64_tr_b16 v[64:65], v10 offset:0
    v_mfma_f32_16x16x32_bf16 v[240:243], v[80:83], v[116:119], v[240:243]
    ds_read_b64_tr_b16 v[66:67], v10 offset:2048
    v_mfma_f32_16x16x32_bf16 v[228:231], v[84:87], v[112:115], v[228:231]
    ds_read_b64_tr_b16 v[68:69], v11 offset:0
    buffer_load_dwordx4 v[176:179], v4, s[20:23], s36 offen offset:2048 sc1
    v_mfma_f32_16x16x32_bf16 v[244:247], v[84:87], v[116:119], v[244:247]
    ds_read_b64_tr_b16 v[70:71], v11 offset:2048
    v_mfma_f32_16x16x32_bf16 v[232:235], v[88:91], v[112:115], v[232:235]
    ds_read_b64_tr_b16 v[72:73], v12 offset:0
    v_mfma_f32_16x16x32_bf16 v[248:251], v[88:91], v[116:119], v[248:251]
    ds_read_b64_tr_b16 v[74:75], v12 offset:2048
    v_mfma_f32_16x16x32_bf16 v[236:239], v[92:95], v[112:115], v[236:239]
    ds_read_b64_tr_b16 v[76:77], v13 offset:0
    buffer_load_dwordx4 v[180:183], v5, s[20:23], s36 offen offset:2048 sc1
    v_mfma_f32_16x16x32_bf16 v[252:255], v[92:95], v[116:119], v[252:255]
    ds_read_b64_tr_b16 v[78:79], v13 offset:2048
    s_waitcnt vmcnt(14)
    s_waitcnt lgkmcnt(8)
    v_mfma_f32_16x16x32_bf16 v[224:227], v[40:43], v[120:123], v[224:227]
    ds_read_b64_tr_b16 v[80:81], v10 offset:4096
F_sa_16:
    s_andn2_b32 s49, s54, s55
    s_cbranch_scc0 F_ss_17
    v_mfma_f32_16x16x32_bf16 v[240:243], v[40:43], v[124:127], v[240:243]
    ds_read_b64_tr_b16 v[82:83], v10 offset:6144
    s_lshl_b32 s50, s49, 16
    s_or_b32 s49, s49, s50
    v_mfma_f32_16x16x32_bf16 v[228:231], v[44:47], v[120:123], v[228:231]
    ds_read_b64_tr_b16 v[84:85], v11 offset:4096
    buffer_load_dwordx4 v[184:187], v4, s[20:23], s36 offen offset:3072 sc1
    v_mfma_f32_16x16x32_bf16 v[244:247], v[44:47], v[124:127], v[244:247]
    ds_read_b64_tr_b16 v[86:87], v11 offset:6144
    s_lshr_b32 s49, s49, s34
    s_ff1_i32_b32 s49, s49
    v_mfma_f32_16x16x32_bf16 v[232:235], v[48:51], v[120:123], v[232:235]
    ds_read_b64_tr_b16 v[88:89], v12 offset:4096
    s_add_u32 s49, s49, s34
    s_and_b32 s49, s49, 15
    v_mfma_f32_16x16x32_bf16 v[248:251], v[48:51], v[124:127], v[248:251]
    ds_read_b64_tr_b16 v[90:91], v12 offset:6144
    s_bitset1_b32 s55, s49
    s_lshl_b32 s38, s49, 11
    v_mfma_f32_16x16x32_bf16 v[236:239], v[52:55], v[120:123], v[236:239]
    ds_read_b64_tr_b16 v[92:93], v13 offset:4096
    buffer_load_dwordx4 v[188:191], v5, s[20:23], s36 offen offset:3072 sc1
    v_mfma_f32_16x16x32_bf16 v[252:255], v[52:55], v[124:127], v[252:255]
    ds_read_b64_tr_b16 v[94:95], v13 offset:6144
    s_add_u32 s49, s49, 4
    s_and_b32 s49, s49, 15
    s_lshl_b32 s67, s49, 13
    s_waitcnt vmcnt(14)
    s_waitcnt lgkmcnt(8)
    v_mfma_f32_16x16x32_bf16 v[224:227], v[64:67], v[128:131], v[224:227]
    ds_read_b64_tr_b16 v[40:41], v10 offset:8192
    v_mfma_f32_16x16x32_bf16 v[240:243], v[64:67], v[132:135], v[240:243]
    ds_read_b64_tr_b16 v[42:43], v10 offset:10240
    v_mfma_f32_16x16x32_bf16 v[228:231], v[68:71], v[128:131], v[228:231]
    ds_read_b64_tr_b16 v[44:45], v11 offset:8192
    buffer_load_dwordx4 v[192:195], v4, s[20:23], s38 offen offset:0 sc1
    v_mfma_f32_16x16x32_bf16 v[244:247], v[68:71], v[132:135], v[244:247]
    ds_read_b64_tr_b16 v[46:47], v11 offset:10240
    v_mfma_f32_16x16x32_bf16 v[232:235], v[72:75], v[128:131], v[232:235]
    ds_read_b64_tr_b16 v[48:49], v12 offset:8192
    v_mfma_f32_16x16x32_bf16 v[248:251], v[72:75], v[132:135], v[248:251]
    ds_read_b64_tr_b16 v[50:51], v12 offset:10240
    v_mfma_f32_16x16x32_bf16 v[236:239], v[76:79], v[128:131], v[236:239]
    ds_read_b64_tr_b16 v[52:53], v13 offset:8192
    buffer_load_dwordx4 v[196:199], v5, s[20:23], s38 offen offset:0 sc1
    v_mfma_f32_16x16x32_bf16 v[252:255], v[76:79], v[132:135], v[252:255]
    ds_read_b64_tr_b16 v[54:55], v13 offset:10240
    s_waitcnt vmcnt(14)
    s_waitcnt lgkmcnt(8)
    v_mfma_f32_16x16x32_bf16 v[224:227], v[80:83], v[136:139], v[224:227]
    ds_read_b64_tr_b16 v[64:65], v10 offset:12288
    v_mfma_f32_16x16x32_bf16 v[240:243], v[80:83], v[140:143], v[240:243]
    ds_read_b64_tr_b16 v[66:67], v10 offset:14336
    v_add_u32 v10, s66, v60
    v_mfma_f32_16x16x32_bf16 v[228:231], v[84:87], v[136:139], v[228:231]
    ds_read_b64_tr_b16 v[68:69], v11 offset:12288
    buffer_load_dwordx4 v[200:203], v4, s[20:23], s38 offen offset:1024 sc1
    v_mfma_f32_16x16x32_bf16 v[244:247], v[84:87], v[140:143], v[244:247]
    ds_read_b64_tr_b16 v[70:71], v11 offset:14336
    v_add_u32 v11, s66, v61
    v_mfma_f32_16x16x32_bf16 v[232:235], v[88:91], v[136:139], v[232:235]
    ds_read_b64_tr_b16 v[72:73], v12 offset:12288
    v_mfma_f32_16x16x32_bf16 v[248:251], v[88:91], v[140:143], v[248:251]
    ds_read_b64_tr_b16 v[74:75], v12 offset:14336
    v_add_u32 v12, s66, v62
    v_mfma_f32_16x16x32_bf16 v[236:239], v[92:95], v[136:139], v[236:239]
    ds_read_b64_tr_b16 v[76:77], v13 offset:12288
    buffer_load_dwordx4 v[204:207], v5, s[20:23], s38 offen offset:1024 sc1
    v_mfma_f32_16x16x32_bf16 v[252:255], v[92:95], v[140:143], v[252:255]
    ds_read_b64_tr_b16 v[78:79], v13 offset:14336
    v_add_u32 v13, s66, v63
    s_waitcnt vmcnt(14)
    s_waitcnt lgkmcnt(8)
    v_mfma_f32_16x16x32_bf16 v[224:227], v[40:43], v[144:147], v[224:227]
    ds_read_b64_tr_b16 v[80:81], v10 offset:0
    v_mfma_f32_16x16x32_bf16 v[240:243], v[40:43], v[148:151], v[240:243]
    ds_read_b64_tr_b16 v[82:83], v10 offset:2048
    v_mfma_f32_16x16x32_bf16 v[228:231], v[44:47], v[144:147], v[228:231]
    ds_read_b64_tr_b16 v[84:85], v11 offset:0
    buffer_load_dwordx4 v[208:211], v4, s[20:23], s38 offen offset:2048 sc1
    s_mov_b64 exec, 1
    ds_add_u32 v1, v9 offset:0
    s_mov_b64 exec, -1
    v_mfma_f32_16x16x32_bf16 v[244:247], v[44:47], v[148:151], v[244:247]
    ds_read_b64_tr_b16 v[86:87], v11 offset:2048
    v_mfma_f32_16x16x32_bf16 v[232:235], v[48:51], v[144:147], v[232:235]
    ds_read_b64_tr_b16 v[88:89], v12 offset:0
    v_mfma_f32_16x16x32_bf16 v[248:251], v[48:51], v[148:151], v[248:251]
    ds_read_b64_tr_b16 v[90:91], v12 offset:2048
    v_mfma_f32_16x16x32_bf16 v[236:239], v[52:55], v[144:147], v[236:239]
    ds_read_b64_tr_b16 v[92:93], v13 offset:0
    buffer_load_dwordx4 v[212:215], v5, s[20:23], s38 offen offset:2048 sc1
    v_mfma_f32_16x16x32_bf16 v[252:255], v[52:55], v[148:151], v[252:255]
    ds_read_b64_tr_b16 v[94:95], v13 offset:2048
    s_waitcnt vmcnt(14)
    s_waitcnt lgkmcnt(9)
    v_mfma_f32_16x16x32_bf16 v[224:227], v[64:67], v[152:155], v[224:227]
    ds_read_b64_tr_b16 v[40:41], v10 offset:4096
F_sa_18:
    s_andn2_b32 s49, s54, s55
    s_cbranch_scc0 F_ss_19
    v_mfma_f32_16x16x32_bf16 v[240:243], v[64:67], v[156:159], v[240:243]
    ds_read_b64_tr_b16 v[42:43], v10 offset:6144
    s_lshl_b32 s50, s49, 16
    s_or_b32 s49, s49, s50
    v_mfma_f32_16x16x32_bf16 v[228:231], v[68:71], v[152:155], v[228:231]
    ds_read_b64_tr_b16 v[44:45], v11 offset:4096
    buffer_load_dwordx4 v[216:219], v4, s[20:23], s38 offen offset:3072 sc1
    v_mfma_f32_16x16x32_bf16 v[244:247], v[68:71], v[156:159], v[244:247]
    ds_read_b64_tr_b16 v[46:47], v11 offset:6144
    s_lshr_b32 s49, s49, s34
    s_ff1_i32_b32 s49, s49
    v_mfma_f32_16x16x32_bf16 v[232:235], v[72:75], v[152:155], v[232:235]
    ds_read_b64_tr_b16 v[48:49], v12 offset:4096
    s_add_u32 s49, s49, s34
    s_and_b32 s49, s49, 15
    v_mfma_f32_16x16x32_bf16 v[248:251], v[72:75], v[156:159], v[248:251]
    ds_read_b64_tr_b16 v[50:51], v12 offset:6144
    s_bitset1_b32 s55, s49
    s_lshl_b32 s36, s49, 11
    v_mfma_f32_16x16x32_bf16 v[236:239], v[76:79], v[152:155], v[236:239]
    ds_read_b64_tr_b16 v[52:53], v13 offset:4096
    buffer_load_dwordx4 v[220:223], v5, s[20:23], s38 offen offset:3072 sc1
    v_mfma_f32_16x16x32_bf16 v[252:255], v[76:79], v[156:159], v[252:255]
    ds_read_b64_tr_b16 v[54:55], v13 offset:6144
    s_add_u32 s49, s49, 4
    s_and_b32 s49, s49, 15
    s_lshl_b32 s68, s49, 13
    s_waitcnt vmcnt(14)
    s_waitcnt lgkmcnt(8)
    v_mfma_f32_16x16x32_bf16 v[224:227], v[80:83], v[160:163], v[224:227]
    ds_read_b64_tr_b16 v[64:65], v10 offset:8192
    v_mfma_f32_16x16x32_bf16 v[240:243], v[80:83], v[164:167], v[240:243]
    ds_read_b64_tr_b16 v[66:67], v10 offset:10240
    v_mfma_f32_16x16x32_bf16 v[228:231], v[84:87], v[160:163], v[228:231]
    ds_read_b64_tr_b16 v[68:69], v11 offset:8192
    buffer_load_dwordx4 v[96:99], v4, s[20:23], s36 offen offset:0 sc1
    v_mfma_f32_16x16x32_bf16 v[244:247], v[84:87], v[164:167], v[244:247]
    ds_read_b64_tr_b16 v[70:71], v11 offset:10240
    v_mfma_f32_16x16x32_bf16 v[232:235], v[88:91], v[160:163], v[232:235]
    ds_read_b64_tr_b16 v[72:73], v12 offset:8192
    v_mfma_f32_16x16x32_bf16 v[248:251], v[88:91], v[164:167], v[248:251]
    ds_read_b64_tr_b16 v[74:75], v12 offset:10240
    v_mfma_f32_16x16x32_bf16 v[236:239], v[92:95], v[160:163], v[236:239]
    ds_read_b64_tr_b16 v[76:77], v13 offset:8192
    buffer_load_dwordx4 v[100:103], v5, s[20:23], s36 offen offset:0 sc1
    v_mfma_f32_16x16x32_bf16 v[252:255], v[92:95], v[164:167], v[252:255]
    ds_read_b64_tr_b16 v[78:79], v13 offset:10240
    s_waitcnt vmcnt(14)
    s_waitcnt lgkmcnt(8)
    v_mfma_f32_16x16x32_bf16 v[224:227], v[40:43], v[168:171], v[224:227]
    ds_read_b64_tr_b16 v[80:81], v10 offset:12288
    v_mfma_f32_16x16x32_bf16 v[240:243], v[40:43], v[172:175], v[240:243]
    ds_read_b64_tr_b16 v[82:83], v10 offset:14336
    v_add_u32 v10, s67, v60
    v_mfma_f32_16x16x32_bf16 v[228:231], v[44:47], v[168:171], v[228:231]
    ds_read_b64_tr_b16 v[84:85], v11 offset:12288
    buffer_load_dwordx4 v[104:107], v4, s[20:23], s36 offen offset:1024 sc1
    v_mfma_f32_16x16x32_bf16 v[244:247], v[44:47], v[172:175], v[244:247]
    ds_read_b64_tr_b16 v[86:87], v11 offset:14336
    v_add_u32 v11, s67, v61
    v_mfma_f32_16x16x32_bf16 v[232:235], v[48:51], v[168:171], v[232:235]
    ds_read_b64_tr_b16 v[88:89], v12 offset:12288
    v_mfma_f32_16x16x32_bf16 v[248:251], v[48:51], v[172:175], v[248:251]
    ds_read_b64_tr_b16 v[90:91], v12 offset:14336
    v_add_u32 v12, s67, v62
    v_mfma_f32_16x16x32_bf16 v[236:239], v[52:55], v[168:171], v[236:239]
    ds_read_b64_tr_b16 v[92:93], v13 offset:12288
    buffer_load_dwordx4 v[108:111], v5, s[20:23], s36 offen offset:1024 sc1
    v_mfma_f32_16x16x32_bf16 v[252:255], v[52:55], v[172:175], v[252:255]
    ds_read_b64_tr_b16 v[94:95], v13 offset:14336
    v_add_u32 v13, s67, v63
    s_waitcnt vmcnt(14)
    s_waitcnt lgkmcnt(8)
    v_mfma_f32_16x16x32_bf16 v[224:227], v[64:67], v[176:179], v[224:227]
    ds_read_b64_tr_b16 v[40:41], v10 offset:0
    v_mfma_f32_16x16x32_bf16 v[240:243], v[64:67], v[180:183], v[240:243]
    ds_read_b64_tr_b16 v[42:43], v10 offset:2048
    v_mfma_f32_16x16x32_bf16 v[228:231], v[68:71], v[176:179], v[228:231]
    ds_read_b64_tr_b16 v[44:45], v11 offset:0
    buffer_load_dwordx4 v[112:115], v4, s[20:23], s36 offen offset:2048 sc1
    v_mfma_f32_16x16x32_bf16 v[244:247], v[68:71], v[180:183], v[244:247]
    ds_read_b64_tr_b16 v[46:47], v11 offset:2048
    v_mfma_f32_16x16x32_bf16 v[232:235], v[72:75], v[176:179], v[232:235]
    ds_read_b64_tr_b16 v[48:49], v12 offset:0
    v_mfma_f32_16x16x32_bf16 v[248:251], v[72:75], v[180:183], v[248:251]
    ds_read_b64_tr_b16 v[50:51], v12 offset:2048
    v_mfma_f32_16x16x32_bf16 v[236:239], v[76:79], v[176:179], v[236:239]
    ds_read_b64_tr_b16 v[52:53], v13 offset:0
    buffer_load_dwordx4 v[116:119], v5, s[20:23], s36 offen offset:2048 sc1
    v_mfma_f32_16x16x32_bf16 v[252:255], v[76:79], v[180:183], v[252:255]
    ds_read_b64_tr_b16 v[54:55], v13 offset:2048
    s_waitcnt vmcnt(14)
    s_waitcnt lgkmcnt(8)
    v_mfma_f32_16x16x32_bf16 v[224:227], v[80:83], v[184:187], v[224:227]
    ds_read_b64_tr_b16 v[64:65], v10 offset:4096
F_sa_20:
    s_andn2_b32 s49, s54, s55
    s_cbranch_scc0 F_ss_21
    v_mfma_f32_16x16x32_bf16 v[240:243], v[80:83], v[188:191], v[240:243]
    ds_read_b64_tr_b16 v[66:67], v10 offset:6144
    s_lshl_b32 s50, s49, 16
    s_or_b32 s49, s49, s50
    v_mfma_f32_16x16x32_bf16 v[228:231], v[84:87], v[184:187], v[228:231]
    ds_read_b64_tr_b16 v[68:69], v11 offset:4096
    buffer_load_dwordx4 v[120:123], v4, s[20:23], s36 offen offset:3072 sc1
    v_mfma_f32_16x16x32_bf16 v[244:247], v[84:87], v[188:191], v[244:247]
    ds_read_b64_tr_b16 v[70:71], v11 offset:6144
    s_lshr_b32 s49, s49, s34
    s_ff1_i32_b32 s49, s49
    v_mfma_f32_16x16x32_bf16 v[232:235], v[88:91], v[184:187], v[232:235]
    ds_read_b64_tr_b16 v[72:73], v12 offset:4096
    s_add_u32 s49, s49, s34
    s_and_b32 s49, s49, 15
    v_mfma_f32_16x16x32_bf16 v[248:251], v[88:91], v[188:191], v[248:251]
    ds_read_b64_tr_b16 v[74:75], v12 offset:6144
    s_bitset1_b32 s55, s49
    s_lshl_b32 s38, s49, 11
    v_mfma_f32_16x16x32_bf16 v[236:239], v[92:95], v[184:187], v[236:239]
    ds_read_b64_tr_b16 v[76:77], v13 offset:4096
    buffer_load_dwordx4 v[124:127], v5, s[20:23], s36 offen offset:3072 sc1
    v_mfma_f32_16x16x32_bf16 v[252:255], v[92:95], v[188:191], v[252:255]
    ds_read_b64_tr_b16 v[78:79], v13 offset:6144
    s_add_u32 s49, s49, 4
    s_and_b32 s49, s49, 15
    s_lshl_b32 s69, s49, 13
    s_waitcnt vmcnt(14)
    s_waitcnt lgkmcnt(8)
    v_mfma_f32_16x16x32_bf16 v[224:227], v[40:43], v[192:195], v[224:227]
    ds_read_b64_tr_b16 v[80:81], v10 offset:8192
    v_mfma_f32_16x16x32_bf16 v[240:243], v[40:43], v[196:199], v[240:243]
    ds_read_b64_tr_b16 v[82:83], v10 offset:10240
    v_mfma_f32_16x16x32_bf16 v[228:231], v[44:47], v[192:195], v[228:231]
    ds_read_b64_tr_b16 v[84:85], v11 offset:8192
    buffer_load_dwordx4 v[128:131], v4, s[20:23], s38 offen offset:0 sc1
    v_mfma_f32_16x16x32_bf16 v[244:247], v[44:47], v[196:199], v[244:247]
    ds_read_b64_tr_b16 v[86:87], v11 offset:10240
    v_mfma_f32_16x16x32_bf16 v[232:235], v[48:51], v[192:195], v[232:235]
    ds_read_b64_tr_b16 v[88:89], v12 offset:8192
    v_mfma_f32_16x16x32_bf16 v[248:251], v[48:51], v[196:199], v[248:251]
    ds_read_b64_tr_b16 v[90:91], v12 offset:10240
    v_mfma_f32_16x16x32_bf16 v[236:239], v[52:55], v[192:195], v[236:239]
    ds_read_b64_tr_b16 v[92:93], v13 offset:8192
    buffer_load_dwordx4 v[132:135], v5, s[20:23], s38 offen offset:0 sc1
    v_mfma_f32_16x16x32_bf16 v[252:255], v[52:55], v[196:199], v[252:255]
    ds_read_b64_tr_b16 v[94:95], v13 offset:10240
    s_waitcnt vmcnt(14)
    s_waitcnt lgkmcnt(8)
    v_mfma_f32_16x16x32_bf16 v[224:227], v[64:67], v[200:203], v[224:227]
    ds_read_b64_tr_b16 v[40:41], v10 offset:12288
    v_mfma_f32_16x16x32_bf16 v[240:243], v[64:67], v[204:207], v[240:243]
    ds_read_b64_tr_b16 v[42:43], v10 offset:14336
    v_add_u32 v10, s68, v60
    v_mfma_f32_16x16x32_bf16 v[228:231], v[68:71], v[200:203], v[228:231]
    ds_read_b64_tr_b16 v[44:45], v11 offset:12288
    buffer_load_dwordx4 v[136:139], v4, s[20:23], s38 offen offset:1024 sc1
    v_mfma_f32_16x16x32_bf16 v[244:247], v[68:71], v[204:207], v[244:247]
    ds_read_b64_tr_b16 v[46:47], v11 offset:14336
    v_add_u32 v11, s68, v61
    v_mfma_f32_16x16x32_bf16 v[232:235], v[72:75], v[200:203], v[232:235]
    ds_read_b64_tr_b16 v[48:49], v12 offset:12288
    v_mfma_f32_16x16x32_bf16 v[248:251], v[72:75], v[204:207], v[248:251]
    ds_read_b64_tr_b16 v[50:51], v12 offset:14336
    v_add_u32 v12, s68, v62
    v_mfma_f32_16x16x32_bf16 v[236:239], v[76:79], v[200:203], v[236:239]
    ds_read_b64_tr_b16 v[52:53], v13 offset:12288
    buffer_load_dwordx4 v[140:143], v5, s[20:23], s38 offen offset:1024 sc1
    v_mfma_f32_16x16x32_bf16 v[252:255], v[76:79], v[204:207], v[252:255]
    ds_read_b64_tr_b16 v[54:55], v13 offset:14336
    v_add_u32 v13, s68, v63
    s_waitcnt vmcnt(14)
    s_waitcnt lgkmcnt(8)
    v_mfma_f32_16x16x32_bf16 v[224:227], v[80:83], v[208:211], v[224:227]
    ds_read_b64_tr_b16 v[64:65], v10 offset:0
    v_mfma_f32_16x16x32_bf16 v[240:243], v[80:83], v[212:215], v[240:243]
    ds_read_b64_tr_b16 v[66:67], v10 offset:2048
    v_mfma_f32_16x16x32_bf16 v[228:231], v[84:87], v[208:211], v[228:231]
    ds_read_b64_tr_b16 v[68:69], v11 offset:0
    buffer_load_dwordx4 v[144:147], v4, s[20:23], s38 offen offset:2048 sc1
    s_mov_b64 exec, 1
    ds_add_u32 v1, v9 offset:0
    s_mov_b64 exec, -1
    v_mfma_f32_16x16x32_bf16 v[244:247], v[84:87], v[212:215], v[244:247]
    ds_read_b64_tr_b16 v[70:71], v11 offset:2048
    v_mfma_f32_16x16x32_bf16 v[232:235], v[88:91], v[208:211], v[232:235]
    ds_read_b64_tr_b16 v[72:73], v12 offset:0
    v_mfma_f32_16x16x32_bf16 v[248:251], v[88:91], v[212:215], v[248:251]
    ds_read_b64_tr_b16 v[74:75], v12 offset:2048
    v_mfma_f32_16x16x32_bf16 v[236:239], v[92:95], v[208:211], v[236:239]
    ds_read_b64_tr_b16 v[76:77], v13 offset:0
    buffer_load_dwordx4 v[148:151], v5, s[20:23], s38 offen offset:2048 sc1
    v_mfma_f32_16x16x32_bf16 v[252:255], v[92:95], v[212:215], v[252:255]
    ds_read_b64_tr_b16 v[78:79], v13 offset:2048
    s_waitcnt vmcnt(14)
    s_waitcnt lgkmcnt(9)
    v_mfma_f32_16x16x32_bf16 v[224:227], v[40:43], v[216:219], v[224:227]
    ds_read_b64_tr_b16 v[80:81], v10 offset:4096
F_sa_22:
    s_andn2_b32 s49, s54, s55
    s_cbranch_scc0 F_ss_23
    v_mfma_f32_16x16x32_bf16 v[240:243], v[40:43], v[220:223], v[240:243]
    ds_read_b64_tr_b16 v[82:83], v10 offset:6144
    s_lshl_b32 s50, s49, 16
    s_or_b32 s49, s49, s50
    v_mfma_f32_16x16x32_bf16 v[228:231], v[44:47], v[216:219], v[228:231]
    ds_read_b64_tr_b16 v[84:85], v11 offset:4096
    buffer_load_dwordx4 v[152:155], v4, s[20:23], s38 offen offset:3072 sc1
    v_mfma_f32_16x16x32_bf16 v[244:247], v[44:47], v[220:223], v[244:247]
    ds_read_b64_tr_b16 v[86:87], v11 offset:6144
    s_lshr_b32 s49, s49, s34
    s_ff1_i32_b32 s49, s49
    v_mfma_f32_16x16x32_bf16 v[232:235], v[48:51], v[216:219], v[232:235]
    ds_read_b64_tr_b16 v[88:89], v12 offset:4096
    s_add_u32 s49, s49, s34
    s_and_b32 s49, s49, 15
    v_mfma_f32_16x16x32_bf16 v[248:251], v[48:51], v[220:223], v[248:251]
    ds_read_b64_tr_b16 v[90:91], v12 offset:6144
    s_bitset1_b32 s55, s49
    s_lshl_b32 s36, s49, 11
    v_mfma_f32_16x16x32_bf16 v[236:239], v[52:55], v[216:219], v[236:239]
    ds_read_b64_tr_b16 v[92:93], v13 offset:4096
    buffer_load_dwordx4 v[156:159], v5, s[20:23], s38 offen offset:3072 sc1
    v_mfma_f32_16x16x32_bf16 v[252:255], v[52:55], v[220:223], v[252:255]
    ds_read_b64_tr_b16 v[94:95], v13 offset:6144
    s_add_u32 s49, s49, 4
    s_and_b32 s49, s49, 15
    s_lshl_b32 s70, s49, 13
    s_waitcnt vmcnt(14)
    s_waitcnt lgkmcnt(8)
    v_mfma_f32_16x16x32_bf16 v[224:227], v[64:67], v[96:99], v[224:227]
    ds_read_b64_tr_b16 v[40:41], v10 offset:8192
    v_mfma_f32_16x16x32_bf16 v[240:243], v[64:67], v[100:103], v[240:243]
    ds_read_b64_tr_b16 v[42:43], v10 offset:10240
    v_mfma_f32_16x16x32_bf16 v[228:231], v[68:71], v[96:99], v[228:231]
    ds_read_b64_tr_b16 v[44:45], v11 offset:8192
    buffer_load_dwordx4 v[160:163], v4, s[20:23], s36 offen offset:0 sc1
    v_mfma_f32_16x16x32_bf16 v[244:247], v[68:71], v[100:103], v[244:247]
    ds_read_b64_tr_b16 v[46:47], v11 offset:10240
    v_mfma_f32_16x16x32_bf16 v[232:235], v[72:75], v[96:99], v[232:235]
    ds_read_b64_tr_b16 v[48:49], v12 offset:8192
    v_mfma_f32_16x16x32_bf16 v[248:251], v[72:75], v[100:103], v[248:251]
    ds_read_b64_tr_b16 v[50:51], v12 offset:10240
    v_mfma_f32_16x16x32_bf16 v[236:239], v[76:79], v[96:99], v[236:239]
    ds_read_b64_tr_b16 v[52:53], v13 offset:8192
    buffer_load_dwordx4 v[164:167], v5, s[20:23], s36 offen offset:0 sc1
    v_mfma_f32_16x16x32_bf16 v[252:255], v[76:79], v[100:103], v[252:255]
    ds_read_b64_tr_b16 v[54:55], v13 offset:10240
    s_waitcnt vmcnt(14)
    s_waitcnt lgkmcnt(8)
    v_mfma_f32_16x16x32_bf16 v[224:227], v[80:83], v[104:107], v[224:227]
    ds_read_b64_tr_b16 v[64:65], v10 offset:12288
    v_mfma_f32_16x16x32_bf16 v[240:243], v[80:83], v[108:111], v[240:243]
    ds_read_b64_tr_b16 v[66:67], v10 offset:14336
    v_add_u32 v10, s69, v60
    v_mfma_f32_16x16x32_bf16 v[228:231], v[84:87], v[104:107], v[228:231]
    ds_read_b64_tr_b16 v[68:69], v11 offset:12288
    buffer_load_dwordx4 v[168:171], v4, s[20:23], s36 offen offset:1024 sc1
    v_mfma_f32_16x16x32_bf16 v[244:247], v[84:87], v[108:111], v[244:247]
    ds_read_b64_tr_b16 v[70:71], v11 offset:14336
    v_add_u32 v11, s69, v61
    v_mfma_f32_16x16x32_bf16 v[232:235], v[88:91], v[104:107], v[232:235]
    ds_read_b64_tr_b16 v[72:73], v12 offset:12288
    v_mfma_f32_16x16x32_bf16 v[248:251], v[88:91], v[108:111], v[248:251]
    ds_read_b64_tr_b16 v[74:75], v12 offset:14336
    v_add_u32 v12, s69, v62
    v_mfma_f32_16x16x32_bf16 v[236:239], v[92:95], v[104:107], v[236:239]
    ds_read_b64_tr_b16 v[76:77], v13 offset:12288
    buffer_load_dwordx4 v[172:175], v5, s[20:23], s36 offen offset:1024 sc1
    v_mfma_f32_16x16x32_bf16 v[252:255], v[92:95], v[108:111], v[252:255]
    ds_read_b64_tr_b16 v[78:79], v13 offset:14336
    v_add_u32 v13, s69, v63
    s_waitcnt vmcnt(14)
    s_waitcnt lgkmcnt(8)
    v_mfma_f32_16x16x32_bf16 v[224:227], v[40:43], v[112:115], v[224:227]
    ds_read_b64_tr_b16 v[80:81], v10 offset:0
    v_mfma_f32_16x16x32_bf16 v[240:243], v[40:43], v[116:119], v[240:243]
    ds_read_b64_tr_b16 v[82:83], v10 offset:2048
    v_mfma_f32_16x16x32_bf16 v[228:231], v[44:47], v[112:115], v[228:231]
    ds_read_b64_tr_b16 v[84:85], v11 offset:0
    buffer_load_dwordx4 v[176:179], v4, s[20:23], s36 offen offset:2048 sc1
    v_mfma_f32_16x16x32_bf16 v[244:247], v[44:47], v[116:119], v[244:247]
    ds_read_b64_tr_b16 v[86:87], v11 offset:2048
    v_mfma_f32_16x16x32_bf16 v[232:235], v[48:51], v[112:115], v[232:235]
    ds_read_b64_tr_b16 v[88:89], v12 offset:0
    v_mfma_f32_16x16x32_bf16 v[248:251], v[48:51], v[116:119], v[248:251]
    ds_read_b64_tr_b16 v[90:91], v12 offset:2048
    v_mfma_f32_16x16x32_bf16 v[236:239], v[52:55], v[112:115], v[236:239]
    ds_read_b64_tr_b16 v[92:93], v13 offset:0
    buffer_load_dwordx4 v[180:183], v5, s[20:23], s36 offen offset:2048 sc1
    v_mfma_f32_16x16x32_bf16 v[252:255], v[52:55], v[116:119], v[252:255]
    ds_read_b64_tr_b16 v[94:95], v13 offset:2048
    s_waitcnt vmcnt(14)
    s_waitcnt lgkmcnt(8)
    v_mfma_f32_16x16x32_bf16 v[224:227], v[64:67], v[120:123], v[224:227]
    ds_read_b64_tr_b16 v[40:41], v10 offset:4096
F_sa_24:
    s_andn2_b32 s49, s54, s55
    s_cbranch_scc0 F_ss_25
    v_mfma_f32_16x16x32_bf16 v[240:243], v[64:67], v[124:127], v[240:243]
    ds_read_b64_tr_b16 v[42:43], v10 offset:6144
    s_lshl_b32 s50, s49, 16
    s_or_b32 s49, s49, s50
    v_mfma_f32_16x16x32_bf16 v[228:231], v[68:71], v[120:123], v[228:231]
    ds_read_b64_tr_b16 v[44:45], v11 offset:4096
    buffer_load_dwordx4 v[184:187], v4, s[20:23], s36 offen offset:3072 sc1
    v_mfma_f32_16x16x32_bf16 v[244:247], v[68:71], v[124:127], v[244:247]
    ds_read_b64_tr_b16 v[46:47], v11 offset:6144
    s_lshr_b32 s49, s49, s34
    s_ff1_i32_b32 s49, s49
    v_mfma_f32_16x16x32_bf16 v[232:235], v[72:75], v[120:123], v[232:235]
    ds_read_b64_tr_b16 v[48:49], v12 offset:4096
    s_add_u32 s49, s49, s34
    s_and_b32 s49, s49, 15
    v_mfma_f32_16x16x32_bf16 v[248:251], v[72:75], v[124:127], v[248:251]
    ds_read_b64_tr_b16 v[50:51], v12 offset:6144
    s_bitset1_b32 s55, s49
    s_lshl_b32 s38, s49, 11
    v_mfma_f32_16x16x32_bf16 v[236:239], v[76:79], v[120:123], v[236:239]
    ds_read_b64_tr_b16 v[52:53], v13 offset:4096
    buffer_load_dwordx4 v[188:191], v5, s[20:23], s36 offen offset:3072 sc1
    v_mfma_f32_16x16x32_bf16 v[252:255], v[76:79], v[124:127], v[252:255]
    ds_read_b64_tr_b16 v[54:55], v13 offset:6144
    s_add_u32 s49, s49, 4
    s_and_b32 s49, s49, 15
    s_lshl_b32 s71, s49, 13
    s_waitcnt vmcnt(14)
    s_waitcnt lgkmcnt(8)
    v_mfma_f32_16x16x32_bf16 v[224:227], v[80:83], v[128:131], v[224:227]
    ds_read_b64_tr_b16 v[64:65], v10 offset:8192
    v_mfma_f32_16x16x32_bf16 v[240:243], v[80:83], v[132:135], v[240:243]
    ds_read_b64_tr_b16 v[66:67], v10 offset:10240
    v_mfma_f32_16x16x32_bf16 v[228:231], v[84:87], v[128:131], v[228:231]
    ds_read_b64_tr_b16 v[68:69], v11 offset:8192
    buffer_load_dwordx4 v[192:195], v4, s[20:23], s38 offen offset:0 sc1
    v_mfma_f32_16x16x32_bf16 v[244:247], v[84:87], v[132:135], v[244:247]
    ds_read_b64_tr_b16 v[70:71], v11 offset:10240
    v_mfma_f32_16x16x32_bf16 v[232:235], v[88:91], v[128:131], v[232:235]
    ds_read_b64_tr_b16 v[72:73], v12 offset:8192
    v_mfma_f32_16x16x32_bf16 v[248:251], v[88:91], v[132:135], v[248:251]
    ds_read_b64_tr_b16 v[74:75], v12 offset:10240
    v_mfma_f32_16x16x32_bf16 v[236:239], v[92:95], v[128:131], v[236:239]
    ds_read_b64_tr_b16 v[76:77], v13 offset:8192
    buffer_load_dwordx4 v[196:199], v5, s[20:23], s38 offen offset:0 sc1
    v_mfma_f32_16x16x32_bf16 v[252:255], v[92:95], v[132:135], v[252:255]
    ds_read_b64_tr_b16 v[78:79], v13 offset:10240
    s_waitcnt vmcnt(14)
    s_waitcnt lgkmcnt(8)
    v_mfma_f32_16x16x32_bf16 v[224:227], v[40:43], v[136:139], v[224:227]
    ds_read_b64_tr_b16 v[80:81], v10 offset:12288
    v_mfma_f32_16x16x32_bf16 v[240:243], v[40:43], v[140:143], v[240:243]
    ds_read_b64_tr_b16 v[82:83], v10 offset:14336
    v_add_u32 v10, s70, v60
    v_mfma_f32_16x16x32_bf16 v[228:231], v[44:47], v[136:139], v[228:231]
    ds_read_b64_tr_b16 v[84:85], v11 offset:12288
    buffer_load_dwordx4 v[200:203], v4, s[20:23], s38 offen offset:1024 sc1
    v_mfma_f32_16x16x32_bf16 v[244:247], v[44:47], v[140:143], v[244:247]
    ds_read_b64_tr_b16 v[86:87], v11 offset:14336
    v_add_u32 v11, s70, v61
    v_mfma_f32_16x16x32_bf16 v[232:235], v[48:51], v[136:139], v[232:235]
    ds_read_b64_tr_b16 v[88:89], v12 offset:12288
    v_mfma_f32_16x16x32_bf16 v[248:251], v[48:51], v[140:143], v[248:251]
    ds_read_b64_tr_b16 v[90:91], v12 offset:14336
    v_add_u32 v12, s70, v62
    v_mfma_f32_16x16x32_bf16 v[236:239], v[52:55], v[136:139], v[236:239]
    ds_read_b64_tr_b16 v[92:93], v13 offset:12288
    buffer_load_dwordx4 v[204:207], v5, s[20:23], s38 offen offset:1024 sc1
    v_mfma_f32_16x16x32_bf16 v[252:255], v[52:55], v[140:143], v[252:255]
    ds_read_b64_tr_b16 v[94:95], v13 offset:14336
    v_add_u32 v13, s70, v63
    s_waitcnt vmcnt(14)
    s_waitcnt lgkmcnt(8)
    v_mfma_f32_16x16x32_bf16 v[224:227], v[64:67], v[144:147], v[224:227]
    ds_read_b64_tr_b16 v[40:41], v10 offset:0
    v_mfma_f32_16x16x32_bf16 v[240:243], v[64:67], v[148:151], v[240:243]
    ds_read_b64_tr_b16 v[42:43], v10 offset:2048
    v_mfma_f32_16x16x32_bf16 v[228:231], v[68:71], v[144:147], v[228:231]
    ds_read_b64_tr_b16 v[44:45], v11 offset:0
    buffer_load_dwordx4 v[208:211], v4, s[20:23], s38 offen offset:2048 sc1
    v_mfma_f32_16x16x32_bf16 v[244:247], v[68:71], v[148:151], v[244:247]
    ds_read_b64_tr_b16 v[46:47], v11 offset:2048
    v_mfma_f32_16x16x32_bf16 v[232:235], v[72:75], v[144:147], v[232:235]
    ds_read_b64_tr_b16 v[48:49], v12 offset:0
    v_mfma_f32_16x16x32_bf16 v[248:251], v[72:75], v[148:151], v[248:251]
    ds_read_b64_tr_b16 v[50:51], v12 offset:2048
    v_mfma_f32_16x16x32_bf16 v[236:239], v[76:79], v[144:147], v[236:239]
    ds_read_b64_tr_b16 v[52:53], v13 offset:0
    buffer_load_dwordx4 v[212:215], v5, s[20:23], s38 offen offset:2048 sc1
    v_mfma_f32_16x16x32_bf16 v[252:255], v[76:79], v[148:151], v[252:255]
    ds_read_b64_tr_b16 v[54:55], v13 offset:2048
    s_waitcnt vmcnt(14)
    s_waitcnt lgkmcnt(8)
    v_mfma_f32_16x16x32_bf16 v[224:227], v[80:83], v[152:155], v[224:227]
    ds_read_b64_tr_b16 v[64:65], v10 offset:4096
    v_mfma_f32_16x16x32_bf16 v[240:243], v[80:83], v[156:159], v[240:243]
    ds_read_b64_tr_b16 v[66:67], v10 offset:6144
    v_mfma_f32_16x16x32_bf16 v[228:231], v[84:87], v[152:155], v[228:231]
    ds_read_b64_tr_b16 v[68:69], v11 offset:4096
    buffer_load_dwordx4 v[216:219], v4, s[20:23], s38 offen offset:3072 sc1
    v_mfma_f32_16x16x32_bf16 v[244:247], v[84:87], v[156:159], v[244:247]
    ds_read_b64_tr_b16 v[70:71], v11 offset:6144
    v_mfma_f32_16x16x32_bf16 v[232:235], v[88:91], v[152:155], v[232:235]
    ds_read_b64_tr_b16 v[72:73], v12 offset:4096
    v_mfma_f32_16x16x32_bf16 v[248:251], v[88:91], v[156:159], v[248:251]
    ds_read_b64_tr_b16 v[74:75], v12 offset:6144
    v_mfma_f32_16x16x32_bf16 v[236:239], v[92:95], v[152:155], v[236:239]
    ds_read_b64_tr_b16 v[76:77], v13 offset:4096
    buffer_load_dwordx4 v[220:223], v5, s[20:23], s38 offen offset:3072 sc1
    v_mfma_f32_16x16x32_bf16 v[252:255], v[92:95], v[156:159], v[252:255]
    ds_read_b64_tr_b16 v[78:79], v13 offset:6144
    s_waitcnt vmcnt(14)
    s_waitcnt lgkmcnt(8)
    v_mfma_f32_16x16x32_bf16 v[224:227], v[40:43], v[160:163], v[224:227]
    ds_read_b64_tr_b16 v[80:81], v10 offset:8192
    v_mfma_f32_16x16x32_bf16 v[240:243], v[40:43], v[164:167], v[240:243]
    ds_read_b64_tr_b16 v[82:83], v10 offset:10240
    v_mfma_f32_16x16x32_bf16 v[228:231], v[44:47], v[160:163], v[228:231]
    ds_read_b64_tr_b16 v[84:85], v11 offset:8192
    v_mfma_f32_16x16x32_bf16 v[244:247], v[44:47], v[164:167], v[244:247]
    ds_read_b64_tr_b16 v[86:87], v11 offset:10240
    v_mfma_f32_16x16x32_bf16 v[232:235], v[48:51], v[160:163], v[232:235]
    ds_read_b64_tr_b16 v[88:89], v12 offset:8192
    v_mfma_f32_16x16x32_bf16 v[248:251], v[48:51], v[164:167], v[248:251]
    ds_read_b64_tr_b16 v[90:91], v12 offset:10240
    v_mfma_f32_16x16x32_bf16 v[236:239], v[52:55], v[160:163], v[236:239]
    ds_read_b64_tr_b16 v[92:93], v13 offset:8192
    v_mfma_f32_16x16x32_bf16 v[252:255], v[52:55], v[164:167], v[252:255]
    ds_read_b64_tr_b16 v[94:95], v13 offset:10240
    s_waitcnt vmcnt(12)
    s_waitcnt lgkmcnt(8)
    v_mfma_f32_16x16x32_bf16 v[224:227], v[64:67], v[168:171], v[224:227]
    ds_read_b64_tr_b16 v[40:41], v10 offset:12288
    v_mfma_f32_16x16x32_bf16 v[240:243], v[64:67], v[172:175], v[240:243]
    ds_read_b64_tr_b16 v[42:43], v10 offset:14336
    v_add_u32 v10, s71, v60
    v_mfma_f32_16x16x32_bf16 v[228:231], v[68:71], v[168:171], v[228:231]
    ds_read_b64_tr_b16 v[44:45], v11 offset:12288
    v_mfma_f32_16x16x32_bf16 v[244:247], v[68:71], v[172:175], v[244:247]
    ds_read_b64_tr_b16 v[46:47], v11 offset:14336
    v_add_u32 v11, s71, v61
    v_mfma_f32_16x16x32_bf16 v[232:235], v[72:75], v[168:171], v[232:235]
    ds_read_b64_tr_b16 v[48:49], v12 offset:12288
    v_mfma_f32_16x16x32_bf16 v[248:251], v[72:75], v[172:175], v[248:251]
    ds_read_b64_tr_b16 v[50:51], v12 offset:14336
    v_add_u32 v12, s71, v62
    v_mfma_f32_16x16x32_bf16 v[236:239], v[76:79], v[168:171], v[236:239]
    ds_read_b64_tr_b16 v[52:53], v13 offset:12288
    v_mfma_f32_16x16x32_bf16 v[252:255], v[76:79], v[172:175], v[252:255]
    ds_read_b64_tr_b16 v[54:55], v13 offset:14336
    v_add_u32 v13, s71, v63
    s_waitcnt vmcnt(10)
    s_waitcnt lgkmcnt(8)
    v_mfma_f32_16x16x32_bf16 v[224:227], v[80:83], v[176:179], v[224:227]
    ds_read_b64_tr_b16 v[64:65], v10 offset:0
    v_mfma_f32_16x16x32_bf16 v[240:243], v[80:83], v[180:183], v[240:243]
    ds_read_b64_tr_b16 v[66:67], v10 offset:2048
    v_mfma_f32_16x16x32_bf16 v[228:231], v[84:87], v[176:179], v[228:231]
    ds_read_b64_tr_b16 v[68:69], v11 offset:0
    v_mfma_f32_16x16x32_bf16 v[244:247], v[84:87], v[180:183], v[244:247]
    ds_read_b64_tr_b16 v[70:71], v11 offset:2048
    v_mfma_f32_16x16x32_bf16 v[232:235], v[88:91], v[176:179], v[232:235]
    ds_read_b64_tr_b16 v[72:73], v12 offset:0
    v_mfma_f32_16x16x32_bf16 v[248:251], v[88:91], v[180:183], v[248:251]
    ds_read_b64_tr_b16 v[74:75], v12 offset:2048
    v_mfma_f32_16x16x32_bf16 v[236:239], v[92:95], v[176:179], v[236:239]
    ds_read_b64_tr_b16 v[76:77], v13 offset:0
    v_mfma_f32_16x16x32_bf16 v[252:255], v[92:95], v[180:183], v[252:255]
    ds_read_b64_tr_b16 v[78:79], v13 offset:2048
    s_waitcnt vmcnt(8)
    s_waitcnt lgkmcnt(8)
    v_mfma_f32_16x16x32_bf16 v[224:227], v[40:43], v[184:187], v[224:227]
    ds_read_b64_tr_b16 v[80:81], v10 offset:4096
    v_mfma_f32_16x16x32_bf16 v[240:243], v[40:43], v[188:191], v[240:243]
    ds_read_b64_tr_b16 v[82:83], v10 offset:6144
    v_mfma_f32_16x16x32_bf16 v[228:231], v[44:47], v[184:187], v[228:231]
    ds_read_b64_tr_b16 v[84:85], v11 offset:4096
    v_mfma_f32_16x16x32_bf16 v[244:247], v[44:47], v[188:191], v[244:247]
    ds_read_b64_tr_b16 v[86:87], v11 offset:6144
    v_mfma_f32_16x16x32_bf16 v[232:235], v[48:51], v[184:187], v[232:235]
    ds_read_b64_tr_b16 v[88:89], v12 offset:4096
    v_mfma_f32_16x16x32_bf16 v[248:251], v[48:51], v[188:191], v[248:251]
    ds_read_b64_tr_b16 v[90:91], v12 offset:6144
    v_mfma_f32_16x16x32_bf16 v[236:239], v[52:55], v[184:187], v[236:239]
    ds_read_b64_tr_b16 v[92:93], v13 offset:4096
    v_mfma_f32_16x16x32_bf16 v[252:255], v[52:55], v[188:191], v[252:255]
    ds_read_b64_tr_b16 v[94:95], v13 offset:6144
    s_waitcnt vmcnt(6)
    s_waitcnt lgkmcnt(8)
    v_mfma_f32_16x16x32_bf16 v[224:227], v[64:67], v[192:195], v[224:227]
    ds_read_b64_tr_b16 v[40:41], v10 offset:8192
    v_mfma_f32_16x16x32_bf16 v[240:243], v[64:67], v[196:199], v[240:243]
    ds_read_b64_tr_b16 v[42:43], v10 offset:10240
    v_mfma_f32_16x16x32_bf16 v[228:231], v[68:71], v[192:195], v[228:231]
    ds_read_b64_tr_b16 v[44:45], v11 offset:8192
    v_mfma_f32_16x16x32_bf16 v[244:247], v[68:71], v[196:199], v[244:247]
    ds_read_b64_tr_b16 v[46:47], v11 offset:10240
    v_mfma_f32_16x16x32_bf16 v[232:235], v[72:75], v[192:195], v[232:235]
    ds_read_b64_tr_b16 v[48:49], v12 offset:8192
    v_mfma_f32_16x16x32_bf16 v[248:251], v[72:75], v[196:199], v[248:251]
    ds_read_b64_tr_b16 v[50:51], v12 offset:10240
    v_mfma_f32_16x16x32_bf16 v[236:239], v[76:79], v[192:195], v[236:239]
    ds_read_b64_tr_b16 v[52:53], v13 offset:8192
    v_mfma_f32_16x16x32_bf16 v[252:255], v[76:79], v[196:199], v[252:255]
    ds_read_b64_tr_b16 v[54:55], v13 offset:10240
    s_waitcnt vmcnt(4)
    s_waitcnt lgkmcnt(8)
    v_mfma_f32_16x16x32_bf16 v[224:227], v[80:83], v[200:203], v[224:227]
    ds_read_b64_tr_b16 v[64:65], v10 offset:12288
    ds_read_b32 v8, v1 offset:32
    v_mfma_f32_16x16x32_bf16 v[240:243], v[80:83], v[204:207], v[240:243]
    ds_read_b64_tr_b16 v[66:67], v10 offset:14336
    v_mfma_f32_16x16x32_bf16 v[228:231], v[84:87], v[200:203], v[228:231]
    ds_read_b64_tr_b16 v[68:69], v11 offset:12288
    v_mfma_f32_16x16x32_bf16 v[244:247], v[84:87], v[204:207], v[244:247]
    ds_read_b64_tr_b16 v[70:71], v11 offset:14336
    v_mfma_f32_16x16x32_bf16 v[232:235], v[88:91], v[200:203], v[232:235]
    ds_read_b64_tr_b16 v[72:73], v12 offset:12288
    v_mfma_f32_16x16x32_bf16 v[248:251], v[88:91], v[204:207], v[248:251]
    ds_read_b64_tr_b16 v[74:75], v12 offset:14336
    v_mfma_f32_16x16x32_bf16 v[236:239], v[92:95], v[200:203], v[236:239]
    ds_read_b64_tr_b16 v[76:77], v13 offset:12288
    v_mfma_f32_16x16x32_bf16 v[252:255], v[92:95], v[204:207], v[252:255]
    ds_read_b64_tr_b16 v[78:79], v13 offset:14336
    s_waitcnt vmcnt(2)
    s_waitcnt lgkmcnt(9)
    v_mfma_f32_16x16x32_bf16 v[224:227], v[40:43], v[208:211], v[224:227]
    v_mfma_f32_16x16x32_bf16 v[240:243], v[40:43], v[212:215], v[240:243]
    s_waitcnt lgkmcnt(7)
    v_readfirstlane_b32 s49, v8
    v_mfma_f32_16x16x32_bf16 v[228:231], v[44:47], v[208:211], v[228:231]
    v_mfma_f32_16x16x32_bf16 v[244:247], v[44:47], v[212:215], v[244:247]
    s_mul_i32 s49, s49, s48
    s_cmp_ge_u32 s49, 3
    v_mfma_f32_16x16x32_bf16 v[232:235], v[48:51], v[208:211], v[232:235]
    s_cbranch_scc0 F_upn
    ds_read_b128 v[96:99], v22 offset:0
    ds_read_b128 v[100:103], v22 offset:64
    ds_read_b128 v[104:107], v22 offset:128
    ds_read_b128 v[108:111], v22 offset:192
    ds_read_b128 v[112:115], v23 offset:0
    ds_read_b128 v[116:119], v23 offset:64
    ds_read_b128 v[120:123], v23 offset:128
    ds_read_b128 v[124:127], v23 offset:192
    s_lshl_b32 s48, s48, 1
F_upn:
    v_mfma_f32_16x16x32_bf16 v[248:251], v[48:51], v[212:215], v[248:251]
    v_mfma_f32_16x16x32_bf16 v[236:239], v[52:55], v[208:211], v[236:239]
    v_mfma_f32_16x16x32_bf16 v[252:255], v[52:55], v[212:215], v[252:255]
    s_waitcnt vmcnt(0)
    s_waitcnt lgkmcnt(0)
    v_mfma_f32_16x16x32_bf16 v[224:227], v[64:67], v[216:219], v[224:227]
    v_mfma_f32_16x16x32_bf16 v[240:243], v[64:67], v[220:223], v[240:243]
    v_mfma_f32_16x16x32_bf16 v[228:231], v[68:71], v[216:219], v[228:231]
    v_mfma_f32_16x16x32_bf16 v[244:247], v[68:71], v[220:223], v[244:247]
    v_mfma_f32_16x16x32_bf16 v[232:235], v[72:75], v[216:219], v[232:235]
    v_mfma_f32_16x16x32_bf16 v[248:251], v[72:75], v[220:223], v[248:251]
    v_mfma_f32_16x16x32_bf16 v[236:239], v[76:79], v[216:219], v[236:239]
    v_mfma_f32_16x16x32_bf16 v[252:255], v[76:79], v[220:223], v[252:255]
    s_cmp_eq_u32 s48, 0
    s_cbranch_scc1 F_noupd
    s_cmp_eq_u32 s48, 2
    s_cbranch_scc1 F_upr
F_sp_26:
    ds_read_b32 v8, v1 offset:32
    s_waitcnt lgkmcnt(0)
    v_readfirstlane_b32 s49, v8
    s_nop 0
    s_cmp_ge_u32 s49, 3
    s_cbranch_scc0 F_sp_26
    ds_read_b128 v[96:99], v22 offset:0
    ds_read_b128 v[100:103], v22 offset:64
    ds_read_b128 v[104:107], v22 offset:128
    ds_read_b128 v[108:111], v22 offset:192
    ds_read_b128 v[112:115], v23 offset:0
    ds_read_b128 v[116:119], v23 offset:64
    ds_read_b128 v[120:123], v23 offset:128
    ds_read_b128 v[124:127], v23 offset:192
F_upr:
    s_nop 7
    s_waitcnt lgkmcnt(0)
    v_pk_add_f32 v[224:225], v[224:225], v[96:97]
    v_pk_add_f32 v[226:227], v[226:227], v[98:99]
    v_pk_add_f32 v[228:229], v[228:229], v[100:101]
    v_pk_add_f32 v[230:231], v[230:231], v[102:103]
    v_pk_add_f32 v[232:233], v[232:233], v[104:105]
    v_pk_add_f32 v[234:235], v[234:235], v[106:107]
    v_pk_add_f32 v[236:237], v[236:237], v[108:109]
    v_pk_add_f32 v[238:239], v[238:239], v[110:111]
    v_pk_add_f32 v[240:241], v[240:241], v[112:113]
    v_pk_add_f32 v[242:243], v[242:243], v[114:115]
    v_pk_add_f32 v[244:245], v[244:245], v[116:117]
    v_pk_add_f32 v[246:247], v[246:247], v[118:119]
    v_pk_add_f32 v[248:249], v[248:249], v[120:121]
    v_pk_add_f32 v[250:251], v[250:251], v[122:123]
    v_pk_add_f32 v[252:253], v[252:253], v[124:125]
    v_pk_add_f32 v[254:255], v[254:255], v[126:127]
F_noupd:
    s_nop 7
    v_cvt_pk_bf16_f32 v200, v224, v225
    v_cvt_pk_bf16_f32 v201, v226, v227
    v_cvt_pk_bf16_f32 v202, v228, v229
    v_cvt_pk_bf16_f32 v203, v230, v231
    v_cvt_pk_bf16_f32 v204, v232, v233
    v_cvt_pk_bf16_f32 v205, v234, v235
    v_cvt_pk_bf16_f32 v206, v236, v237
    v_cvt_pk_bf16_f32 v207, v238, v239
    v_cvt_pk_bf16_f32 v208, v240, v241
    v_cvt_pk_bf16_f32 v209, v242, v243
    v_cvt_pk_bf16_f32 v210, v244, v245
    v_cvt_pk_bf16_f32 v211, v246, v247
    v_cvt_pk_bf16_f32 v212, v248, v249
    v_cvt_pk_bf16_f32 v213, v250, v251
    v_cvt_pk_bf16_f32 v214, v252, v253
    v_cvt_pk_bf16_f32 v215, v254, v255
    v_permlane16_swap_b32 v200, v202
    v_permlane16_swap_b32 v201, v203
    buffer_store_dwordx4 v[200:203], v6, s[16:19], 0 offen offset:0 sc1
    v_permlane16_swap_b32 v204, v206
    v_permlane16_swap_b32 v205, v207
    buffer_store_dwordx4 v[204:207], v6, s[16:19], 0 offen offset:64 sc1
    v_permlane16_swap_b32 v208, v210
    v_permlane16_swap_b32 v209, v211
    buffer_store_dwordx4 v[208:211], v6, s[16:19], s37 offen offset:0 sc1
    v_permlane16_swap_b32 v212, v214
    v_permlane16_swap_b32 v213, v215
    buffer_store_dwordx4 v[212:215], v6, s[16:19], s37 offen offset:64 sc1
    s_endpgm
F_ss_15:
    ds_read_b32 v8, v1 offset:28
    s_waitcnt lgkmcnt(0)
    v_readfirstlane_b32 s54, v8
    s_nop 0
    s_or_b32 s54, s54, s57
    s_lshr_b32 s50, s54, 16
    s_and_b32 s54, s54, s50
    s_lshr_b32 s50, s54, 1
    s_and_b32 s54, s54, s50
    s_and_b32 s54, s54, 0x5555
    s_branch F_sa_14
F_ss_17:
    ds_read_b32 v8, v1 offset:28
    s_waitcnt lgkmcnt(0)
    v_readfirstlane_b32 s54, v8
    s_nop 0
    s_or_b32 s54, s54, s57
    s_lshr_b32 s50, s54, 16
    s_and_b32 s54, s54, s50
    s_lshr_b32 s50, s54, 1
    s_and_b32 s54, s54, s50
    s_and_b32 s54, s54, 0x5555
    s_branch F_sa_16
F_ss_19:
    ds_read_b32 v8, v1 offset:28
    s_waitcnt lgkmcnt(0)
    v_readfirstlane_b32 s54, v8
    s_nop 0
    s_or_b32 s54, s54, s57
    s_lshr_b32 s50, s54, 16
    s_and_b32 s54, s54, s50
    s_lshr_b32 s50, s54, 1
    s_and_b32 s54, s54, s50
    s_and_b32 s54, s54, 0x5555
    s_branch F_sa_18
F_ss_21:
    ds_read_b32 v8, v1 offset:28
    s_waitcnt lgkmcnt(0)
    v_readfirstlane_b32 s54, v8
    s_nop 0
    s_or_b32 s54, s54, s57
    s_lshr_b32 s50, s54, 16
    s_and_b32 s54, s54, s50
    s_lshr_b32 s50, s54, 1
    s_and_b32 s54, s54, s50
    s_and_b32 s54, s54, 0x5555
    s_branch F_sa_20
F_ss_23:
    ds_read_b32 v8, v1 offset:28
    s_waitcnt lgkmcnt(0)
    v_readfirstlane_b32 s54, v8
    s_nop 0
    s_or_b32 s54, s54, s57
    s_lshr_b32 s50, s54, 16
    s_and_b32 s54, s54, s50
    s_lshr_b32 s50, s54, 1
    s_and_b32 s54, s54, s50
    s_and_b32 s54, s54, 0x5555
    s_branch F_sa_22
F_ss_25:
    ds_read_b32 v8, v1 offset:28
    s_waitcnt lgkmcnt(0)
    v_readfirstlane_b32 s54, v8
    s_nop 0
    s_or_b32 s54, s54, s57
    s_lshr_b32 s50, s54, 16
    s_and_b32 s54, s54, s50
    s_lshr_b32 s50, s54, 1
    s_and_b32 s54, s54, s50
    s_and_b32 s54, s54, 0x5555
    s_branch F_sa_24
F_cons:
    v_lshl_add_u32 v2, v0, 2, v1
    v_mov_b32 v3, 0x3f803f80
    v_cmp_gt_u32 vcc, 16, v0
    v_mov_b32 v4, 0
    s_nop 0
    v_cndmask_b32 v3, v3, 0, vcc
    ds_write_b32 v2, v3
    ds_write_b32 v2, v4 offset:256
    ds_write_b32 v2, v4 offset:11776
    s_and_b32 s40, s3, 1
    s_lshr_b32 s41, s3, 1
    s_waitcnt lgkmcnt(0)
    s_mov_b32 s64, 0
    s_mov_b32 s20, s74
    s_mov_b32 s21, s75
    s_mov_b32 s22, 0x1000000
    s_mov_b32 s23, 0x20000
    v_and_b32 v38, 15, v0
    v_lshrrev_b32 v39, 4, v0
    v_lshrrev_b32 v34, 1, v38
    v_xor_b32 v34, v39, v34
    v_lshlrev_b32 v34, 4, v34
    v_lshl_add_u32 v2, v38, 7, v34
    s_mul_i32 s42, s41, 12288
    v_add_u32 v2, s42, v2
    v_xor_b32 v3, 64, v2
    v_or_b32 v34, s41, v38
    v_cmp_eq_u32 vcc, 0, v34
    v_mov_b32 v35, 147520
    s_nop 0
    v_cndmask_b32 v4, v2, v35, vcc
    v_cndmask_b32 v5, v3, v35, vcc
    v_cndmask_b32 v8, 1, 0, vcc
    s_lshl_b32 s42, s40, 9
    s_add_u32 s42, s42, 152064
    v_lshl_add_u32 v28, v39, 4, s42
    v_lshl_add_u32 v29, v38, 2, s42
    v_lshlrev_b32 v36, 4, v0
    v_add_u32 v36, 159488, v36
    v_cndmask_b32 v13, v36, v28, vcc
    v_or_b32 v34, s41, v39
    v_cmp_eq_u32 vcc, 0, v34
    s_lshl_b32 s43, s40, 3
    v_add_u32 v31, s43, v1
    v_cndmask_b32 v14, v36, v29, vcc
    v_or_b32 v34, s41, v0
    v_cmp_eq_u32 vcc, 0, v34
    v_mov_b32 v16, 1
    s_nop 0
    v_cndmask_b32 v15, v36, v31, vcc
    s_lshl_b32 s42, s40, 11
    s_add_u32 s42, s42, 153088
    v_lshl_add_u32 v19, v0, 4, s42
    s_cmp_eq_u32 s41, 0
    s_cselect_b64 vcc, -1, 0
    v_cndmask_b32 v32, v36, v19, vcc
    s_mul_i32 s42, s41, 96
    v_add_u32 v34, s42, v38
    v_lshlrev_b32 v17, 3, v34
    v_add_u32 v17, 150528, v17
    v_lshlrev_b32 v30, 2, v34
    v_add_u32 v30, 149760, v30
    v_lshlrev_b32 v18, 2, v39
    v_add_u32 v18, s42, v18
    v_lshlrev_b32 v18, 2, v18
    v_add_u32 v18, 148992, v18
    v_and_b32 v34, 1, v38
    v_lshl_add_u32 v35, v39, 2, v34
    v_add_u32 v36, 2, v35
    v_cmp_eq_u32 s[50:51], 1, v34
    v_cmp_le_u32 s[52:53], v35, v38
    v_cmp_le_u32 s[54:55], v36, v38
    s_lshl_b32 s42, s42, 2
    s_add_u32 s42, s42, 149760
    v_lshl_add_u32 v35, v35, 2, s42
    v_lshl_add_u32 v36, v36, 2, s42
    v_subrev_u32 v34, 64, v35
    v_subrev_u32 v37, 64, v36
    v_cndmask_b32 v26, v34, v35, s[52:53]
    v_cndmask_b32 v27, v37, v36, s[54:55]
    v_mov_b32 v34, 0x0c0c0504
    v_mov_b32 v35, 0x05040c0c
    v_cndmask_b32 v34, v34, v35, s[50:51]
    v_mov_b32 v35, 0x0c0c0706
    v_mov_b32 v36, 0x07060c0c
    v_cndmask_b32 v35, v35, v36, s[50:51]
    v_mov_b32 v36, 0x0c0c0c0c
    v_cndmask_b32 v20, v34, v36, s[52:53]
    v_cndmask_b32 v21, v35, v36, s[54:55]
    v_cndmask_b32 v22, v36, v34, s[52:53]
    v_cndmask_b32 v23, v36, v35, s[54:55]
    s_or_b32 s42, s30, s41
    s_cmp_eq_u32 s42, 0
    s_cselect_b64 s[56:57], -1, 0
    s_andn2_b64 s[58:59], s[56:57], s[54:55]
    s_andn2_b64 s[56:57], s[56:57], s[52:53]
    v_mov_b32 v24, 0xf149f2ca
    s_mov_b32 s61, 0x3e8293ee
    s_mul_i32 s42, s30, 11
    s_mul_i32 s43, s41, 6
    s_add_u32 s42, s42, s43
    s_lshl_b32 s42, s42, 15
    s_lshl_b32 s43, s31, 1
    s_add_u32 s43, s43, s40
    s_lshl_b32 s43, s43, 10
    s_add_u32 s42, s42, s43
    s_add_u32 s42, s42, 0xf8000
    v_lshl_add_u32 v25, v0, 4, s42
    s_lshl_b32 s42, s30, 11
    s_lshl_b32 s43, s31, 7
    s_add_u32 s42, s42, s43
    s_add_u32 s42, s42, 0x10000
    v_mov_b32 v33, s42
    s_mov_b32 s66, 32768
    s_mov_b32 s67, 65536
    s_mov_b32 s68, 98304
    s_mov_b32 s69, 131072
    s_mov_b32 s70, 163840
    s_lshl_b32 s42, s40, 1
    s_add_u32 s43, s42, 1
    v_bfe_u32 v34, v0, 2, 3
    v_lshrrev_b32 v35, 1, v34
    v_xor_b32 v35, s42, v35
    v_lshlrev_b32 v6, 5, v35
    v_lshl_add_u32 v6, v34, 7, v6
    v_and_b32 v34, 3, v0
    v_lshl_add_u32 v6, v34, 3, v6
    v_lshrrev_b32 v34, 5, v0
    v_lshl_add_u32 v6, v34, 11, v6
    v_bfe_u32 v34, v0, 2, 3
    v_lshrrev_b32 v35, 1, v34
    v_xor_b32 v35, s43, v35
    v_lshlrev_b32 v7, 5, v35
    v_lshl_add_u32 v7, v34, 7, v7
    v_and_b32 v34, 3, v0
    v_lshl_add_u32 v7, v34, 3, v7
    v_lshrrev_b32 v34, 5, v0
    v_lshl_add_u32 v7, v34, 11, v7
    s_mov_b32 s44, 0
    s_mov_b32 s45, 0
    s_mov_b32 s62, 49152
    s_mov_b32 s63, -98304
    s_setprio 2
    v_mov_b64 v[112:113], 0
    v_mov_b64 v[114:115], 0
    v_mov_b64 v[116:117], 0
    v_mov_b64 v[118:119], 0
    v_mov_b64 v[120:121], 0
    v_mov_b64 v[122:123], 0
    v_mov_b64 v[124:125], 0
    v_mov_b64 v[126:127], 0
    v_mov_b64 v[128:129], 0
    v_mov_b64 v[130:131], 0
    v_mov_b64 v[132:133], 0
    v_mov_b64 v[134:135], 0
    v_mov_b64 v[136:137], 0
    v_mov_b64 v[138:139], 0
    v_mov_b64 v[140:141], 0
    v_mov_b64 v[142:143], 0
    v_mov_b64 v[144:145], 0
    v_mov_b64 v[146:147], 0
    v_mov_b64 v[148:149], 0
    v_mov_b64 v[150:151], 0
    v_mov_b64 v[152:153], 0
    v_mov_b64 v[154:155], 0
    v_mov_b64 v[156:157], 0
    v_mov_b64 v[158:159], 0
    v_mov_b64 v[160:161], 0
    v_mov_b64 v[162:163], 0
    v_mov_b64 v[164:165], 0
    v_mov_b64 v[166:167], 0
    v_mov_b64 v[168:169], 0
    v_mov_b64 v[170:171], 0
    v_mov_b64 v[172:173], 0
    v_mov_b64 v[174:175], 0
    v_mov_b64 v[176:177], 0
    v_mov_b64 v[178:179], 0
    v_mov_b64 v[180:181], 0
    v_mov_b64 v[182:183], 0
    v_mov_b64 v[184:185], 0
    v_mov_b64 v[186:187], 0
    v_mov_b64 v[188:189], 0
    v_mov_b64 v[190:191], 0
    v_mov_b64 v[192:193], 0
    v_mov_b64 v[194:195], 0
    v_mov_b64 v[196:197], 0
    v_mov_b64 v[198:199], 0
    v_mov_b64 v[200:201], 0
    v_mov_b64 v[202:203], 0
    v_mov_b64 v[204:205], 0
    v_mov_b64 v[206:207], 0
    v_mov_b64 v[208:209], 0
    v_mov_b64 v[210:211], 0
    v_mov_b64 v[212:213], 0
    v_mov_b64 v[214:215], 0
    v_mov_b64 v[216:217], 0
    v_mov_b64 v[218:219], 0
    v_mov_b64 v[220:221], 0
    v_mov_b64 v[222:223], 0
    v_mov_b64 v[224:225], 0
    v_mov_b64 v[226:227], 0
    v_mov_b64 v[228:229], 0
    v_mov_b64 v[230:231], 0
    v_mov_b64 v[232:233], 0
    v_mov_b64 v[234:235], 0
    v_mov_b64 v[236:237], 0
    v_mov_b64 v[238:239], 0
    v_mov_b64 v[240:241], 0
    v_mov_b64 v[242:243], 0
    v_mov_b64 v[244:245], 0
    v_mov_b64 v[246:247], 0
    v_mov_b64 v[248:249], 0
    v_mov_b64 v[250:251], 0
    v_mov_b64 v[252:253], 0
    v_mov_b64 v[254:255], 0
    s_barrier
    ds_read_b64_tr_b16 v[40:41], v6 offset:24576
    ds_read_b64_tr_b16 v[42:43], v6 offset:25600
    ds_read_b64_tr_b16 v[44:45], v6 offset:28672
    ds_read_b64_tr_b16 v[46:47], v6 offset:29696
    ds_read_b128 v[64:67], v4 offset:0
    ds_read_b128 v[68:71], v5 offset:0
    ds_read_b64_tr_b16 v[48:49], v7 offset:24576
    ds_read_b128 v[72:75], v2 offset:2048
    ds_read_b128 v[76:79], v3 offset:2048
    ds_read_b64_tr_b16 v[50:51], v7 offset:25600
    ds_read_b128 v[80:83], v2 offset:4096
    ds_read_b128 v[84:87], v3 offset:4096
    ds_read_b64_tr_b16 v[52:53], v7 offset:28672
    s_waitcnt lgkmcnt(6)
    ds_read_b128 v[88:91], v2 offset:6144
    ds_read_b128 v[92:95], v3 offset:6144
    ds_read_b64_tr_b16 v[54:55], v7 offset:29696
    ds_read_b128 v[96:99], v2 offset:8192
    ds_read_b128 v[100:103], v3 offset:8192
    ds_read_b128 v[104:107], v2 offset:10240
    ds_read_b128 v[108:111], v3 offset:10240
    s_branch F_loop
F_sp2:
    ds_read_b32 v12, v1 offset:256
    s_waitcnt lgkmcnt(0)
    v_cmp_ne_u32 vcc, 0, v12
    s_nop 0
    s_cmp_eq_u64 vcc, 0
    s_cbranch_scc0 F_ok2
    s_branch F_sp2
F_sp3:
    ds_read_b32 v12, v31 offset:40
    s_waitcnt lgkmcnt(0)
    v_cmp_ne_u32 vcc, 0, v12
    s_nop 0
    s_cmp_eq_u64 vcc, 0
    s_cbranch_scc0 F_ok3
    s_branch F_sp3
F_sp4:
    ds_read_b32 v12, v31 offset:44
    s_waitcnt lgkmcnt(0)
    v_cmp_ne_u32 vcc, 0, v12
    s_nop 0
    s_cmp_eq_u64 vcc, 0
    s_cbranch_scc0 F_ok4
    s_branch F_sp4
F_loop:
    s_waitcnt lgkmcnt(14)
    v_mfma_f32_16x16x32_bf16 v[112:115], v[40:43], v[64:67], v[112:115]
    s_cmp_eq_u32 s45, 2
    s_cselect_b32 s47, s63, s62
    v_mfma_f32_16x16x32_bf16 v[112:115], v[44:47], v[68:71], v[112:115]
    ds_read_b64_tr_b16 v[56:57], v6 offset:32768
    s_waitcnt lgkmcnt(12)
    v_mfma_f32_16x16x32_bf16 v[136:139], v[40:43], v[72:75], v[136:139]
    s_cselect_b32 s45, -1, s45
    s_add_u32 s45, s45, 1
    v_mfma_f32_16x16x32_bf16 v[136:139], v[44:47], v[76:79], v[136:139]
    ds_read_b64_tr_b16 v[58:59], v6 offset:33792
    s_waitcnt lgkmcnt(10)
    v_mfma_f32_16x16x32_bf16 v[160:163], v[40:43], v[80:83], v[160:163]
    v_mfma_f32_16x16x32_bf16 v[160:163], v[44:47], v[84:87], v[160:163]
    ds_read_b64_tr_b16 v[60:61], v6 offset:36864
    s_waitcnt lgkmcnt(8)
    v_mfma_f32_16x16x32_bf16 v[184:187], v[40:43], v[88:91], v[184:187]
    v_mfma_f32_16x16x32_bf16 v[184:187], v[44:47], v[92:95], v[184:187]
    ds_read_b64_tr_b16 v[62:63], v6 offset:37888
    s_waitcnt lgkmcnt(6)
    v_mfma_f32_16x16x32_bf16 v[208:211], v[40:43], v[96:99], v[208:211]
    v_mfma_f32_16x16x32_bf16 v[208:211], v[44:47], v[100:103], v[208:211]
    s_waitcnt lgkmcnt(4)
    v_mfma_f32_16x16x32_bf16 v[232:235], v[40:43], v[104:107], v[232:235]
    v_mfma_f32_16x16x32_bf16 v[232:235], v[44:47], v[108:111], v[232:235]
    v_mfma_f32_16x16x32_bf16 v[116:119], v[48:51], v[64:67], v[116:119]
    s_add_u32 s44, s44, 1
    v_add_u32 v2, s47, v2
    v_mfma_f32_16x16x32_bf16 v[116:119], v[52:55], v[68:71], v[116:119]
    ds_read_b64_tr_b16 v[40:41], v7 offset:32768
    v_mfma_f32_16x16x32_bf16 v[140:143], v[48:51], v[72:75], v[140:143]
    v_mad_i32_i24 v4, v8, s47, v4
    v_mfma_f32_16x16x32_bf16 v[140:143], v[52:55], v[76:79], v[140:143]
    ds_read_b64_tr_b16 v[42:43], v7 offset:33792
    v_mfma_f32_16x16x32_bf16 v[164:167], v[48:51], v[80:83], v[164:167]
    v_add_u32 v3, s47, v3
    v_mfma_f32_16x16x32_bf16 v[164:167], v[52:55], v[84:87], v[164:167]
    ds_read_b64_tr_b16 v[44:45], v7 offset:36864
    v_mfma_f32_16x16x32_bf16 v[188:191], v[48:51], v[88:91], v[188:191]
    v_mad_i32_i24 v5, v8, s47, v5
    v_mfma_f32_16x16x32_bf16 v[188:191], v[52:55], v[92:95], v[188:191]
    ds_read_b64_tr_b16 v[46:47], v7 offset:37888
    v_mfma_f32_16x16x32_bf16 v[212:215], v[48:51], v[96:99], v[212:215]
    v_mfma_f32_16x16x32_bf16 v[212:215], v[52:55], v[100:103], v[212:215]
    v_mfma_f32_16x16x32_bf16 v[236:239], v[48:51], v[104:107], v[236:239]
    v_mfma_f32_16x16x32_bf16 v[236:239], v[52:55], v[108:111], v[236:239]
    s_waitcnt lgkmcnt(4)
    v_mfma_f32_16x16x32_bf16 v[120:123], v[56:59], v[64:67], v[120:123]
    v_mfma_f32_16x16x32_bf16 v[120:123], v[60:63], v[68:71], v[120:123]
    ds_read_b64_tr_b16 v[48:49], v6 offset:40960
    v_mfma_f32_16x16x32_bf16 v[144:147], v[56:59], v[72:75], v[144:147]
    v_mfma_f32_16x16x32_bf16 v[144:147], v[60:63], v[76:79], v[144:147]
    ds_read_b64_tr_b16 v[50:51], v6 offset:41984
    v_mfma_f32_16x16x32_bf16 v[168:171], v[56:59], v[80:83], v[168:171]
    v_mfma_f32_16x16x32_bf16 v[168:171], v[60:63], v[84:87], v[168:171]
    ds_read_b64_tr_b16 v[52:53], v6 offset:45056
    v_mfma_f32_16x16x32_bf16 v[192:195], v[56:59], v[88:91], v[192:195]
    v_mfma_f32_16x16x32_bf16 v[192:195], v[60:63], v[92:95], v[192:195]
    ds_read_b64_tr_b16 v[54:55], v6 offset:46080
    v_mfma_f32_16x16x32_bf16 v[216:219], v[56:59], v[96:99], v[216:219]
    v_mfma_f32_16x16x32_bf16 v[216:219], v[60:63], v[100:103], v[216:219]
    v_mfma_f32_16x16x32_bf16 v[240:243], v[56:59], v[104:107], v[240:243]
    ds_read_b32 v12, v1 offset:256
    v_mfma_f32_16x16x32_bf16 v[240:243], v[60:63], v[108:111], v[240:243]
    s_waitcnt lgkmcnt(5)
    v_mfma_f32_16x16x32_bf16 v[124:127], v[40:43], v[64:67], v[124:127]
    v_mfma_f32_16x16x32_bf16 v[124:127], v[44:47], v[68:71], v[124:127]
    ds_read_b64_tr_b16 v[56:57], v7 offset:40960
    v_mfma_f32_16x16x32_bf16 v[148:151], v[40:43], v[72:75], v[148:151]
    v_mfma_f32_16x16x32_bf16 v[148:151], v[44:47], v[76:79], v[148:151]
    ds_read_b64_tr_b16 v[58:59], v7 offset:41984
    v_mfma_f32_16x16x32_bf16 v[172:175], v[40:43], v[80:83], v[172:175]
    v_mfma_f32_16x16x32_bf16 v[172:175], v[44:47], v[84:87], v[172:175]
    ds_read_b64_tr_b16 v[60:61], v7 offset:45056
    v_mfma_f32_16x16x32_bf16 v[196:199], v[40:43], v[88:91], v[196:199]
    v_mfma_f32_16x16x32_bf16 v[196:199], v[44:47], v[92:95], v[196:199]
    ds_read_b64_tr_b16 v[62:63], v7 offset:46080
    v_mfma_f32_16x16x32_bf16 v[220:223], v[40:43], v[96:99], v[220:223]
    v_add_u32 v6, s47, v6
    v_add_u32 v7, s47, v7
    v_mfma_f32_16x16x32_bf16 v[220:223], v[44:47], v[100:103], v[220:223]
    v_mfma_f32_16x16x32_bf16 v[244:247], v[40:43], v[104:107], v[244:247]
    s_cmp_eq_u32 s44, 16
    v_mfma_f32_16x16x32_bf16 v[244:247], v[44:47], v[108:111], v[244:247]
    s_cbranch_scc1 F_last
    s_waitcnt lgkmcnt(5)
    v_mfma_f32_16x16x32_bf16 v[128:131], v[64:67], v[48:51], v[128:131]
    v_mfma_f32_16x16x32_bf16 v[128:131], v[68:71], v[52:55], v[128:131]
    v_mfma_f32_16x16x32_bf16 v[152:155], v[72:75], v[48:51], v[152:155]
    s_waitcnt lgkmcnt(0)
    s_barrier
    v_mfma_f32_16x16x32_bf16 v[152:155], v[76:79], v[52:55], v[152:155]
    ds_read_b64_tr_b16 v[40:41], v6 offset:24576
    v_mfma_f32_16x16x32_bf16 v[176:179], v[80:83], v[48:51], v[176:179]
    v_mfma_f32_16x16x32_bf16 v[176:179], v[84:87], v[52:55], v[176:179]
    ds_read_b64_tr_b16 v[42:43], v6 offset:25600
    v_mfma_f32_16x16x32_bf16 v[200:203], v[88:91], v[48:51], v[200:203]
    v_mfma_f32_16x16x32_bf16 v[200:203], v[92:95], v[52:55], v[200:203]
    ds_read_b64_tr_b16 v[44:45], v6 offset:28672
    v_mfma_f32_16x16x32_bf16 v[224:227], v[96:99], v[48:51], v[224:227]
    v_mfma_f32_16x16x32_bf16 v[224:227], v[100:103], v[52:55], v[224:227]
    ds_read_b64_tr_b16 v[46:47], v6 offset:29696
    v_mfma_f32_16x16x32_bf16 v[248:251], v[104:107], v[48:51], v[248:251]
    v_mfma_f32_16x16x32_bf16 v[248:251], v[108:111], v[52:55], v[248:251]
    v_mfma_f32_16x16x32_bf16 v[132:135], v[64:67], v[56:59], v[132:135]
    ds_read_b128 v[64:67], v4 offset:0
    v_mfma_f32_16x16x32_bf16 v[132:135], v[68:71], v[60:63], v[132:135]
    ds_read_b128 v[68:71], v5 offset:0
    ds_read_b64_tr_b16 v[48:49], v7 offset:24576
    v_mfma_f32_16x16x32_bf16 v[156:159], v[72:75], v[56:59], v[156:159]
    ds_read_b128 v[72:75], v2 offset:2048
    v_mfma_f32_16x16x32_bf16 v[156:159], v[76:79], v[60:63], v[156:159]
    ds_read_b128 v[76:79], v3 offset:2048
    ds_read_b64_tr_b16 v[50:51], v7 offset:25600
    v_mfma_f32_16x16x32_bf16 v[180:183], v[80:83], v[56:59], v[180:183]
    ds_read_b128 v[80:83], v2 offset:4096
    v_mfma_f32_16x16x32_bf16 v[180:183], v[84:87], v[60:63], v[180:183]
    ds_read_b128 v[84:87], v3 offset:4096
    ds_read_b64_tr_b16 v[52:53], v7 offset:28672
    v_mfma_f32_16x16x32_bf16 v[204:207], v[88:91], v[56:59], v[204:207]
    ds_read_b128 v[88:91], v2 offset:6144
    v_mfma_f32_16x16x32_bf16 v[204:207], v[92:95], v[60:63], v[204:207]
    ds_read_b128 v[92:95], v3 offset:6144
    ds_read_b64_tr_b16 v[54:55], v7 offset:29696
    v_mfma_f32_16x16x32_bf16 v[228:231], v[96:99], v[56:59], v[228:231]
    ds_read_b128 v[96:99], v2 offset:8192
    v_mfma_f32_16x16x32_bf16 v[228:231], v[100:103], v[60:63], v[228:231]
    ds_read_b128 v[100:103], v3 offset:8192
    v_mfma_f32_16x16x32_bf16 v[252:255], v[104:107], v[56:59], v[252:255]
    ds_read_b128 v[104:107], v2 offset:10240
    v_mfma_f32_16x16x32_bf16 v[252:255], v[108:111], v[60:63], v[252:255]
    ds_read_b128 v[108:111], v3 offset:10240
    s_branch F_loop
F_last:
    s_waitcnt lgkmcnt(5)
    v_mfma_f32_16x16x32_bf16 v[128:131], v[64:67], v[48:51], v[128:131]
    s_waitcnt lgkmcnt(4)
    v_cmp_ne_u32 vcc, 0, v12
    s_waitcnt lgkmcnt(0)
    s_barrier
    v_mfma_f32_16x16x32_bf16 v[128:131], v[68:71], v[52:55], v[128:131]
    s_cmp_eq_u64 vcc, 0
    s_cbranch_scc1 F_sp2
F_ok2:
    v_mfma_f32_16x16x32_bf16 v[132:135], v[64:67], v[56:59], v[132:135]
    ds_write_b128 v13, v[112:115] offset:0
    ds_read2_b32 v[2:3], v30 offset0:0 offset1:16
    v_mfma_f32_16x16x32_bf16 v[132:135], v[68:71], v[60:63], v[132:135]
    ds_write_b128 v13, v[116:119] offset:64
    ds_read2_b32 v[4:5], v30 offset0:32 offset1:48
    v_mfma_f32_16x16x32_bf16 v[152:155], v[72:75], v[48:51], v[152:155]
    ds_write_b128 v13, v[120:123] offset:128
    ds_read2_b32 v[6:7], v30 offset0:64 offset1:80
    v_mfma_f32_16x16x32_bf16 v[152:155], v[76:79], v[52:55], v[152:155]
    ds_write_b128 v13, v[124:127] offset:192
    ds_read2_b64 v[64:67], v17 offset0:64 offset1:80
    v_mfma_f32_16x16x32_bf16 v[176:179], v[80:83], v[48:51], v[176:179]
    ds_read2_b64 v[68:71], v17 offset0:32 offset1:48
    ds_write_b32 v14, v128 offset:256
    v_mfma_f32_16x16x32_bf16 v[176:179], v[84:87], v[52:55], v[176:179]
    ds_write_b32 v14, v132 offset:320
    ds_write_b32 v15, v16 offset:40
    v_mfma_f32_16x16x32_bf16 v[200:203], v[88:91], v[48:51], v[200:203]
    ds_read_b32 v40, v26 offset:0
    ds_read_b32 v41, v27 offset:0
    v_mfma_f32_16x16x32_bf16 v[200:203], v[92:95], v[52:55], v[200:203]
    ds_read_b32 v42, v26 offset:64
    ds_read_b32 v43, v27 offset:64
    v_mfma_f32_16x16x32_bf16 v[224:227], v[96:99], v[48:51], v[224:227]
    ds_read_b32 v44, v26 offset:128
    ds_read_b32 v45, v27 offset:128
    v_mfma_f32_16x16x32_bf16 v[224:227], v[100:103], v[52:55], v[224:227]
    ds_read_b32 v12, v31 offset:40
    v_mfma_f32_16x16x32_bf16 v[248:251], v[104:107], v[48:51], v[248:251]
    ds_read_b32 v46, v26 offset:192
    ds_read_b32 v47, v27 offset:192
    v_mfma_f32_16x16x32_bf16 v[248:251], v[108:111], v[52:55], v[248:251]
    ds_read_b32 v8, v26 offset:256
    ds_read_b32 v9, v27 offset:256
    v_mfma_f32_16x16x32_bf16 v[156:159], v[72:75], v[56:59], v[156:159]
    ds_read_b32 v10, v26 offset:320
    ds_read_b32 v11, v27 offset:320
    v_mfma_f32_16x16x32_bf16 v[156:159], v[76:79], v[60:63], v[156:159]
    s_waitcnt lgkmcnt(6)
    v_cmp_eq_u32 vcc, 1, v12
    v_mul_f32 v2, s61, v2
    v_mfma_f32_16x16x32_bf16 v[180:183], v[80:83], v[56:59], v[180:183]
    ds_read2_b64 v[72:75], v17 offset0:0 offset1:16
    s_cmp_eq_u64 vcc, 0
    s_cbranch_scc1 F_sp3
F_ok3:
    v_mfma_f32_16x16x32_bf16 v[180:183], v[84:87], v[60:63], v[180:183]
    ds_read_b128 v[48:51], v28 offset:128
    v_mul_f32 v3, s61, v3
    v_mfma_f32_16x16x32_bf16 v[204:207], v[88:91], v[56:59], v[204:207]
    ds_read_b128 v[52:55], v28 offset:192
    v_mul_f32 v4, s61, v4
    v_mfma_f32_16x16x32_bf16 v[204:207], v[92:95], v[60:63], v[204:207]
    ds_read_b128 v[76:79], v28 offset:0
    v_mul_f32 v5, s61, v5
    v_mfma_f32_16x16x32_bf16 v[228:231], v[96:99], v[56:59], v[228:231]
    ds_read_b128 v[80:83], v28 offset:64
    v_mul_f32 v6, s61, v6
    v_mfma_f32_16x16x32_bf16 v[228:231], v[100:103], v[60:63], v[228:231]
    ds_read2_b32 v[34:35], v29 offset0:64 offset1:64
    v_mul_f32 v7, s61, v7
    v_mfma_f32_16x16x32_bf16 v[252:255], v[104:107], v[56:59], v[252:255]
    ds_read2_b32 v[36:37], v29 offset0:80 offset1:80
    v_mfma_f32_16x16x32_bf16 v[252:255], v[108:111], v[60:63], v[252:255]
    ds_read_b128 v[108:111], v18 offset:320
    ds_read_b128 v[104:107], v18 offset:256
    ds_read_b128 v[100:103], v18 offset:192
    ds_read_b128 v[96:99], v18 offset:128
    ds_read_b128 v[92:95], v18 offset:64
    ds_read_b128 v[88:91], v18 offset:0
    s_waitcnt lgkmcnt(10)
    v_pk_fma_f32 v[216:217], v[48:49], v[64:65], v[216:217] neg_lo:[0,1,0] neg_hi:[0,1,0]
    v_pk_fma_f32 v[218:219], v[50:51], v[64:65], v[218:219] neg_lo:[0,1,0] neg_hi:[0,1,0]
    v_pk_fma_f32 v[220:221], v[52:53], v[64:65], v[220:221] neg_lo:[0,1,0] neg_hi:[0,1,0]
    v_pk_fma_f32 v[222:223], v[54:55], v[64:65], v[222:223] neg_lo:[0,1,0] neg_hi:[0,1,0]
    v_cvt_pk_bf16_f32 v216, v216, v217
    v_cvt_pk_bf16_f32 v217, v218, v219
    v_cvt_pk_bf16_f32 v218, v220, v221
    v_cvt_pk_bf16_f32 v219, v222, v223
    v_pk_fma_f32 v[240:241], v[48:49], v[66:67], v[240:241] neg_lo:[0,1,0] neg_hi:[0,1,0]
    v_pk_fma_f32 v[242:243], v[50:51], v[66:67], v[242:243] neg_lo:[0,1,0] neg_hi:[0,1,0]
    v_pk_fma_f32 v[244:245], v[52:53], v[66:67], v[244:245] neg_lo:[0,1,0] neg_hi:[0,1,0]
    v_pk_fma_f32 v[246:247], v[54:55], v[66:67], v[246:247] neg_lo:[0,1,0] neg_hi:[0,1,0]
    v_cvt_pk_bf16_f32 v240, v240, v241
    v_cvt_pk_bf16_f32 v241, v242, v243
    v_cvt_pk_bf16_f32 v242, v244, v245
    v_cvt_pk_bf16_f32 v243, v246, v247
    s_waitcnt lgkmcnt(5)
    v_pk_fma_f32 v[248:249], v[108:109], v[34:35], v[248:249] neg_lo:[0,1,0] neg_hi:[0,1,0]
    v_pk_fma_f32 v[250:251], v[110:111], v[34:35], v[250:251] neg_lo:[0,1,0] neg_hi:[0,1,0]
    v_pk_fma_f32 v[252:253], v[108:109], v[36:37], v[252:253] neg_lo:[0,1,0] neg_hi:[0,1,0]
    v_pk_fma_f32 v[254:255], v[110:111], v[36:37], v[254:255] neg_lo:[0,1,0] neg_hi:[0,1,0]
    v_cvt_pk_bf16_f32 v248, v248, v249
    v_cvt_pk_bf16_f32 v249, v250, v251
    v_cvt_pk_bf16_f32 v250, v252, v253
    v_cvt_pk_bf16_f32 v251, v254, v255
    ds_write_b128 v32, v[240:243]
    ds_write_b128 v32, v[248:251] offset:1024
    ds_write_b32 v15, v16 offset:44
    v_pk_fma_f32 v[232:233], v[76:77], v[66:67], v[232:233] neg_lo:[0,1,0] neg_hi:[0,1,0]
    v_pk_fma_f32 v[234:235], v[78:79], v[66:67], v[234:235] neg_lo:[0,1,0] neg_hi:[0,1,0]
    v_pk_fma_f32 v[236:237], v[80:81], v[66:67], v[236:237] neg_lo:[0,1,0] neg_hi:[0,1,0]
    v_pk_fma_f32 v[238:239], v[82:83], v[66:67], v[238:239] neg_lo:[0,1,0] neg_hi:[0,1,0]
    v_cvt_pk_bf16_f32 v232, v232, v233
    v_cvt_pk_bf16_f32 v233, v234, v235
    v_cvt_pk_bf16_f32 v234, v236, v237
    v_cvt_pk_bf16_f32 v235, v238, v239
    v_pk_fma_f32 v[192:193], v[48:49], v[70:71], v[192:193] neg_lo:[0,1,0] neg_hi:[0,1,0]
    v_pk_fma_f32 v[194:195], v[50:51], v[70:71], v[194:195] neg_lo:[0,1,0] neg_hi:[0,1,0]
    v_pk_fma_f32 v[196:197], v[52:53], v[70:71], v[196:197] neg_lo:[0,1,0] neg_hi:[0,1,0]
    v_pk_fma_f32 v[198:199], v[54:55], v[70:71], v[198:199] neg_lo:[0,1,0] neg_hi:[0,1,0]
    v_cvt_pk_bf16_f32 v192, v192, v193
    v_cvt_pk_bf16_f32 v193, v194, v195
    v_cvt_pk_bf16_f32 v194, v196, v197
    v_cvt_pk_bf16_f32 v195, v198, v199
    v_mfma_f32_16x16x32_bf16 v[236:239], v[216:219], v[232:235], 0
    v_mfma_f32_16x16x32_bf16 v[244:247], v[240:243], v[232:235], 0
    v_pk_fma_f32 v[208:209], v[76:77], v[64:65], v[208:209] neg_lo:[0,1,0] neg_hi:[0,1,0]
    v_pk_fma_f32 v[210:211], v[78:79], v[64:65], v[210:211] neg_lo:[0,1,0] neg_hi:[0,1,0]
    v_pk_fma_f32 v[212:213], v[80:81], v[64:65], v[212:213] neg_lo:[0,1,0] neg_hi:[0,1,0]
    v_pk_fma_f32 v[214:215], v[82:83], v[64:65], v[214:215] neg_lo:[0,1,0] neg_hi:[0,1,0]
    v_cvt_pk_bf16_f32 v208, v208, v209
    v_cvt_pk_bf16_f32 v209, v210, v211
    v_cvt_pk_bf16_f32 v210, v212, v213
    v_cvt_pk_bf16_f32 v211, v214, v215
    v_pk_fma_f32 v[168:169], v[48:49], v[68:69], v[168:169] neg_lo:[0,1,0] neg_hi:[0,1,0]
    v_pk_fma_f32 v[170:171], v[50:51], v[68:69], v[170:171] neg_lo:[0,1,0] neg_hi:[0,1,0]
    v_pk_fma_f32 v[172:173], v[52:53], v[68:69], v[172:173] neg_lo:[0,1,0] neg_hi:[0,1,0]
    v_pk_fma_f32 v[174:175], v[54:55], v[68:69], v[174:175] neg_lo:[0,1,0] neg_hi:[0,1,0]
    v_cvt_pk_bf16_f32 v168, v168, v169
    v_cvt_pk_bf16_f32 v169, v170, v171
    v_cvt_pk_bf16_f32 v170, v172, v173
    v_cvt_pk_bf16_f32 v171, v174, v175
    v_mfma_f32_16x16x32_bf16 v[212:215], v[192:195], v[208:211], 0
    v_mfma_f32_16x16x32_bf16 v[220:223], v[216:219], v[208:211], 0
    v_pk_fma_f32 v[184:185], v[76:77], v[70:71], v[184:185] neg_lo:[0,1,0] neg_hi:[0,1,0]
    v_pk_fma_f32 v[186:187], v[78:79], v[70:71], v[186:187] neg_lo:[0,1,0] neg_hi:[0,1,0]
    v_pk_fma_f32 v[188:189], v[80:81], v[70:71], v[188:189] neg_lo:[0,1,0] neg_hi:[0,1,0]
    v_pk_fma_f32 v[190:191], v[82:83], v[70:71], v[190:191] neg_lo:[0,1,0] neg_hi:[0,1,0]
    v_cvt_pk_bf16_f32 v184, v184, v185
    v_cvt_pk_bf16_f32 v185, v186, v187
    v_cvt_pk_bf16_f32 v186, v188, v189
    v_cvt_pk_bf16_f32 v187, v190, v191
    v_pk_fma_f32 v[144:145], v[48:49], v[74:75], v[144:145] neg_lo:[0,1,0] neg_hi:[0,1,0]
    v_pk_fma_f32 v[146:147], v[50:51], v[74:75], v[146:147] neg_lo:[0,1,0] neg_hi:[0,1,0]
    v_pk_fma_f32 v[148:149], v[52:53], v[74:75], v[148:149] neg_lo:[0,1,0] neg_hi:[0,1,0]
    v_pk_fma_f32 v[150:151], v[54:55], v[74:75], v[150:151] neg_lo:[0,1,0] neg_hi:[0,1,0]
    v_cvt_pk_bf16_f32 v144, v144, v145
    v_cvt_pk_bf16_f32 v145, v146, v147
    v_cvt_pk_bf16_f32 v146, v148, v149
    v_cvt_pk_bf16_f32 v147, v150, v151
    v_mfma_f32_16x16x32_bf16 v[188:191], v[168:171], v[184:187], 0
    v_mfma_f32_16x16x32_bf16 v[196:199], v[192:195], v[184:187], 0
    v_pk_fma_f32 v[160:161], v[76:77], v[68:69], v[160:161] neg_lo:[0,1,0] neg_hi:[0,1,0]
    v_pk_fma_f32 v[162:163], v[78:79], v[68:69], v[162:163] neg_lo:[0,1,0] neg_hi:[0,1,0]
    v_pk_fma_f32 v[164:165], v[80:81], v[68:69], v[164:165] neg_lo:[0,1,0] neg_hi:[0,1,0]
    v_pk_fma_f32 v[166:167], v[82:83], v[68:69], v[166:167] neg_lo:[0,1,0] neg_hi:[0,1,0]
    v_cvt_pk_bf16_f32 v160, v160, v161
    v_cvt_pk_bf16_f32 v161, v162, v163
    v_cvt_pk_bf16_f32 v162, v164, v165
    v_cvt_pk_bf16_f32 v163, v166, v167
    ds_read_b32 v12, v31 offset:44
    v_pk_fma_f32 v[120:121], v[48:49], v[72:73], v[120:121] neg_lo:[0,1,0] neg_hi:[0,1,0]
    v_pk_fma_f32 v[122:123], v[50:51], v[72:73], v[122:123] neg_lo:[0,1,0] neg_hi:[0,1,0]
    v_pk_fma_f32 v[124:125], v[52:53], v[72:73], v[124:125] neg_lo:[0,1,0] neg_hi:[0,1,0]
    v_pk_fma_f32 v[126:127], v[54:55], v[72:73], v[126:127] neg_lo:[0,1,0] neg_hi:[0,1,0]
    v_cvt_pk_bf16_f32 v120, v120, v121
    v_cvt_pk_bf16_f32 v121, v122, v123
    v_cvt_pk_bf16_f32 v122, v124, v125
    v_cvt_pk_bf16_f32 v123, v126, v127
    v_mfma_f32_16x16x32_bf16 v[164:167], v[144:147], v[160:163], 0
    v_mfma_f32_16x16x32_bf16 v[172:175], v[168:171], v[160:163], 0
    v_pk_fma_f32 v[136:137], v[76:77], v[74:75], v[136:137] neg_lo:[0,1,0] neg_hi:[0,1,0]
    v_pk_fma_f32 v[138:139], v[78:79], v[74:75], v[138:139] neg_lo:[0,1,0] neg_hi:[0,1,0]
    v_pk_fma_f32 v[140:141], v[80:81], v[74:75], v[140:141] neg_lo:[0,1,0] neg_hi:[0,1,0]
    v_pk_fma_f32 v[142:143], v[82:83], v[74:75], v[142:143] neg_lo:[0,1,0] neg_hi:[0,1,0]
    v_cvt_pk_bf16_f32 v136, v136, v137
    v_cvt_pk_bf16_f32 v137, v138, v139
    v_cvt_pk_bf16_f32 v138, v140, v141
    v_cvt_pk_bf16_f32 v139, v142, v143
    s_waitcnt lgkmcnt(0)
    v_cmp_eq_u32 vcc, 1, v12
    v_pk_fma_f32 v[112:113], v[76:77], v[72:73], v[112:113] neg_lo:[0,1,0] neg_hi:[0,1,0]
    v_pk_fma_f32 v[114:115], v[78:79], v[72:73], v[114:115] neg_lo:[0,1,0] neg_hi:[0,1,0]
    v_pk_fma_f32 v[116:117], v[80:81], v[72:73], v[116:117] neg_lo:[0,1,0] neg_hi:[0,1,0]
    v_pk_fma_f32 v[118:119], v[82:83], v[72:73], v[118:119] neg_lo:[0,1,0] neg_hi:[0,1,0]
    s_cmp_eq_u64 vcc, 0
    s_cbranch_scc1 F_sp4
F_ok4:
    ds_read_b128 v[56:59], v19
    ds_read_b128 v[60:63], v19 offset:1024
    v_mfma_f32_16x16x32_bf16 v[140:143], v[120:123], v[136:139], 0
    v_mfma_f32_16x16x32_bf16 v[148:151], v[144:147], v[136:139], 0
    v_cvt_pk_bf16_f32 v112, v112, v113
    v_cvt_pk_bf16_f32 v113, v114, v115
    v_cvt_pk_bf16_f32 v114, v116, v117
    v_cvt_pk_bf16_f32 v115, v118, v119
    v_cndmask_b32 v236, v236, v237, s[50:51]
    v_cndmask_b32 v238, v238, v239, s[50:51]
    v_cndmask_b32 v244, v244, v245, s[50:51]
    v_cndmask_b32 v246, v246, v247, s[50:51]
    v_cndmask_b32 v236, v236, v244, s[52:53]
    v_cndmask_b32 v237, v238, v246, s[54:55]
    v_pk_mul_f32 v[236:237], v[236:237], v[10:11]
    v_max_f32 v238, v236, v237
    v_cndmask_b32 v212, v212, v213, s[50:51]
    v_cndmask_b32 v214, v214, v215, s[50:51]
    v_cndmask_b32 v220, v220, v221, s[50:51]
    v_cndmask_b32 v222, v222, v223, s[50:51]
    v_cndmask_b32 v212, v212, v220, s[52:53]
    v_cndmask_b32 v213, v214, v222, s[54:55]
    v_pk_mul_f32 v[212:213], v[212:213], v[8:9]
    v_max_f32 v214, v212, v213
    s_waitcnt lgkmcnt(0)
    v_mfma_f32_16x16x32_bf16 v[116:119], v[56:59], v[112:115], 0
    v_mfma_f32_16x16x32_bf16 v[124:127], v[120:123], v[112:115], 0
    v_cndmask_b32 v188, v188, v189, s[50:51]
    v_cndmask_b32 v190, v190, v191, s[50:51]
    v_cndmask_b32 v196, v196, v197, s[50:51]
    v_cndmask_b32 v198, v198, v199, s[50:51]
    v_cndmask_b32 v188, v188, v196, s[52:53]
    v_cndmask_b32 v189, v190, v198, s[54:55]
    v_pk_mul_f32 v[188:189], v[188:189], v[46:47]
    v_max_f32 v190, v188, v189
    v_cndmask_b32 v164, v164, v165, s[50:51]
    v_cndmask_b32 v166, v166, v167, s[50:51]
    v_cndmask_b32 v172, v172, v173, s[50:51]
    v_cndmask_b32 v174, v174, v175, s[50:51]
    v_cndmask_b32 v164, v164, v172, s[52:53]
    v_cndmask_b32 v165, v166, v174, s[54:55]
    v_pk_mul_f32 v[164:165], v[164:165], v[44:45]
    v_max_f32 v166, v164, v165
    v_cndmask_b32 v140, v140, v141, s[50:51]
    v_cndmask_b32 v142, v142, v143, s[50:51]
    v_cndmask_b32 v148, v148, v149, s[50:51]
    v_cndmask_b32 v150, v150, v151, s[50:51]
    v_cndmask_b32 v140, v140, v148, s[52:53]
    v_cndmask_b32 v141, v142, v150, s[54:55]
    v_pk_mul_f32 v[140:141], v[140:141], v[42:43]
    v_cndmask_b32 v140, v140, v24, s[56:57]
    v_cndmask_b32 v141, v141, v24, s[58:59]
    v_max_f32 v142, v140, v141
    v_cndmask_b32 v116, v116, v117, s[50:51]
    v_cndmask_b32 v118, v118, v119, s[50:51]
    v_cndmask_b32 v124, v124, v125, s[50:51]
    v_cndmask_b32 v126, v126, v127, s[50:51]
    v_cndmask_b32 v116, v116, v124, s[52:53]
    v_cndmask_b32 v117, v118, v126, s[54:55]
    v_pk_mul_f32 v[116:117], v[116:117], v[40:41]
    v_max_f32 v118, v116, v117
    v_pk_fma_f32 v[224:225], v[104:105], v[34:35], v[224:225] neg_lo:[0,1,0] neg_hi:[0,1,0]
    v_pk_fma_f32 v[226:227], v[106:107], v[34:35], v[226:227] neg_lo:[0,1,0] neg_hi:[0,1,0]
    v_permlane32_swap_b32 v214, v238
    v_permlane32_swap_b32 v166, v190
    v_permlane32_swap_b32 v118, v142
    v_max_f32 v214, v214, v238
    v_max_f32 v166, v166, v190
    v_max_f32 v118, v118, v142
    v_mov_b32 v119, v118
    v_permlane16_swap_b32 v166, v214
    v_pk_fma_f32 v[228:229], v[104:105], v[36:37], v[228:229] neg_lo:[0,1,0] neg_hi:[0,1,0]
    v_permlane16_swap_b32 v118, v119
    v_max_f32 v166, v166, v214
    v_max_f32 v118, v118, v119
    v_mov_b32 v214, v166
    v_mov_b32 v142, v118
    v_pk_fma_f32 v[230:231], v[106:107], v[36:37], v[230:231] neg_lo:[0,1,0] neg_hi:[0,1,0]
    v_permlane16_swap_b32 v166, v214
    v_permlane32_swap_b32 v118, v142
    v_mov_b32 v190, v166
    v_mov_b32 v238, v214
    v_cvt_pk_bf16_f32 v224, v224, v225
    v_permlane32_swap_b32 v166, v190
    v_permlane32_swap_b32 v214, v238
    v_mul_f32 v118, v118, v2
    v_fma_f32 v116, v116, v2, -v118
    v_fma_f32 v117, v117, v2, -v118
    v_mul_f32 v142, v142, v3
    v_fma_f32 v140, v140, v3, -v142
    v_fma_f32 v141, v141, v3, -v142
    v_mul_f32 v166, v166, v4
    v_fma_f32 v164, v164, v4, -v166
    v_fma_f32 v165, v165, v4, -v166
    v_mul_f32 v190, v190, v5
    v_fma_f32 v188, v188, v5, -v190
    v_fma_f32 v189, v189, v5, -v190
    v_mul_f32 v214, v214, v6
    v_fma_f32 v212, v212, v6, -v214
    v_fma_f32 v213, v213, v6, -v214
    v_mul_f32 v238, v238, v7
    v_fma_f32 v236, v236, v7, -v238
    v_fma_f32 v237, v237, v7, -v238
    v_exp_f32 v236, v236
    v_exp_f32 v237, v237
    v_exp_f32 v212, v212
    v_exp_f32 v213, v213
    v_exp_f32 v188, v188
    v_exp_f32 v189, v189
    v_exp_f32 v164, v164
    v_exp_f32 v165, v165
    v_exp_f32 v140, v140
    v_exp_f32 v141, v141
    v_exp_f32 v116, v116
    v_exp_f32 v117, v117
    v_add_f32 v238, v236, v237
    v_add_f32 v214, v212, v213
    v_add_f32 v190, v188, v189
    v_add_f32 v166, v164, v165
    v_add_f32 v142, v140, v141
    v_add_f32 v118, v116, v117
    v_pk_mul_f32 v[236:237], v[236:237], v[10:11]
    v_pk_mul_f32 v[212:213], v[212:213], v[8:9]
    v_permlane32_swap_b32 v214, v238
    v_permlane32_swap_b32 v166, v190
    v_permlane32_swap_b32 v118, v142
    v_add_f32 v214, v214, v238
    v_add_f32 v166, v166, v190
    v_add_f32 v118, v118, v142
    v_mov_b32 v119, v118
    v_permlane16_swap_b32 v166, v214
    v_pk_mul_f32 v[188:189], v[188:189], v[46:47]
    v_permlane16_swap_b32 v118, v119
    v_add_f32 v166, v166, v214
    v_add_f32 v118, v118, v119
    v_rcp_f32 v166, v166
    v_rcp_f32 v118, v118
    v_pk_mul_f32 v[164:165], v[164:165], v[44:45]
    v_mov_b32 v214, v166
    v_mov_b32 v142, v118
    v_pk_mul_f32 v[140:141], v[140:141], v[42:43]
    v_permlane16_swap_b32 v166, v214
    v_permlane32_swap_b32 v118, v142
    v_mov_b32 v190, v166
    v_mov_b32 v238, v214
    v_pk_mul_f32 v[116:117], v[116:117], v[40:41]
    v_permlane32_swap_b32 v166, v190
    v_permlane32_swap_b32 v214, v238
    v_cvt_pk_bf16_f32 v225, v226, v227
    v_cvt_pk_bf16_f32 v226, v228, v229
    v_cvt_pk_bf16_f32 v227, v230, v231
    v_pk_fma_f32 v[200:201], v[100:101], v[34:35], v[200:201] neg_lo:[0,1,0] neg_hi:[0,1,0]
    v_pk_fma_f32 v[202:203], v[102:103], v[34:35], v[202:203] neg_lo:[0,1,0] neg_hi:[0,1,0]
    v_pk_fma_f32 v[204:205], v[100:101], v[36:37], v[204:205] neg_lo:[0,1,0] neg_hi:[0,1,0]
    v_pk_fma_f32 v[206:207], v[102:103], v[36:37], v[206:207] neg_lo:[0,1,0] neg_hi:[0,1,0]
    v_cvt_pk_bf16_f32 v200, v200, v201
    v_cvt_pk_bf16_f32 v201, v202, v203
    v_cvt_pk_bf16_f32 v202, v204, v205
    v_cvt_pk_bf16_f32 v203, v206, v207
    v_pk_fma_f32 v[176:177], v[96:97], v[34:35], v[176:177] neg_lo:[0,1,0] neg_hi:[0,1,0]
    v_pk_fma_f32 v[178:179], v[98:99], v[34:35], v[178:179] neg_lo:[0,1,0] neg_hi:[0,1,0]
    v_pk_fma_f32 v[180:181], v[96:97], v[36:37], v[180:181] neg_lo:[0,1,0] neg_hi:[0,1,0]
    v_pk_fma_f32 v[182:183], v[98:99], v[36:37], v[182:183] neg_lo:[0,1,0] neg_hi:[0,1,0]
    v_cvt_pk_bf16_f32 v176, v176, v177
    v_cvt_pk_bf16_f32 v177, v178, v179
    v_cvt_pk_bf16_f32 v178, v180, v181
    v_cvt_pk_bf16_f32 v179, v182, v183
    v_pk_fma_f32 v[152:153], v[92:93], v[34:35], v[152:153] neg_lo:[0,1,0] neg_hi:[0,1,0]
    v_pk_fma_f32 v[154:155], v[94:95], v[34:35], v[154:155] neg_lo:[0,1,0] neg_hi:[0,1,0]
    v_pk_fma_f32 v[156:157], v[92:93], v[36:37], v[156:157] neg_lo:[0,1,0] neg_hi:[0,1,0]
    v_pk_fma_f32 v[158:159], v[94:95], v[36:37], v[158:159] neg_lo:[0,1,0] neg_hi:[0,1,0]
    v_cvt_pk_bf16_f32 v152, v152, v153
    v_cvt_pk_bf16_f32 v153, v154, v155
    v_cvt_pk_bf16_f32 v154, v156, v157
    v_cvt_pk_bf16_f32 v155, v158, v159
    v_pk_fma_f32 v[128:129], v[88:89], v[34:35], v[128:129] neg_lo:[0,1,0] neg_hi:[0,1,0]
    v_pk_fma_f32 v[130:131], v[90:91], v[34:35], v[130:131] neg_lo:[0,1,0] neg_hi:[0,1,0]
    v_pk_fma_f32 v[132:133], v[88:89], v[36:37], v[132:133] neg_lo:[0,1,0] neg_hi:[0,1,0]
    v_pk_fma_f32 v[134:135], v[90:91], v[36:37], v[134:135] neg_lo:[0,1,0] neg_hi:[0,1,0]
    v_cvt_pk_bf16_f32 v128, v128, v129
    v_cvt_pk_bf16_f32 v129, v130, v131
    v_cvt_pk_bf16_f32 v130, v132, v133
    v_cvt_pk_bf16_f32 v131, v134, v135
    v_mul_f32 v140, v140, v142
    v_mul_f32 v141, v141, v142
    v_cvt_pk_bf16_f32 v140, v140, v141
    v_perm_b32 v136, v140, v140, v20
    v_perm_b32 v137, v140, v140, v21
    v_perm_b32 v138, v140, v140, v22
    v_perm_b32 v139, v140, v140, v23
    v_mul_f32 v164, v164, v166
    v_mul_f32 v165, v165, v166
    v_cvt_pk_bf16_f32 v164, v164, v165
    v_perm_b32 v160, v164, v164, v20
    v_perm_b32 v161, v164, v164, v21
    v_perm_b32 v162, v164, v164, v22
    v_perm_b32 v163, v164, v164, v23
    v_mfma_f32_16x16x16_bf16 v[148:151], v[128:129], v[136:137], 0
    v_mfma_f32_16x16x16_bf16 v[156:159], v[130:131], v[136:137], 0
    v_mfma_f32_16x16x16_bf16 v[148:151], v[152:153], v[138:139], v[148:151]
    v_mfma_f32_16x16x16_bf16 v[156:159], v[154:155], v[138:139], v[156:159]
    v_mul_f32 v188, v188, v190
    v_mul_f32 v189, v189, v190
    v_cvt_pk_bf16_f32 v188, v188, v189
    v_perm_b32 v184, v188, v188, v20
    v_perm_b32 v185, v188, v188, v21
    v_perm_b32 v186, v188, v188, v22
    v_perm_b32 v187, v188, v188, v23
    v_mfma_f32_16x16x16_bf16 v[172:175], v[152:153], v[160:161], 0
    v_mfma_f32_16x16x16_bf16 v[180:183], v[154:155], v[160:161], 0
    v_mfma_f32_16x16x16_bf16 v[172:175], v[176:177], v[162:163], v[172:175]
    v_mfma_f32_16x16x16_bf16 v[180:183], v[178:179], v[162:163], v[180:183]
    v_mul_f32 v212, v212, v214
    v_mul_f32 v213, v213, v214
    v_cvt_pk_bf16_f32 v212, v212, v213
    v_perm_b32 v208, v212, v212, v20
    v_perm_b32 v209, v212, v212, v21
    v_perm_b32 v210, v212, v212, v22
    v_perm_b32 v211, v212, v212, v23
    v_mfma_f32_16x16x16_bf16 v[196:199], v[176:177], v[184:185], 0
    v_mfma_f32_16x16x16_bf16 v[204:207], v[178:179], v[184:185], 0
    v_mfma_f32_16x16x16_bf16 v[196:199], v[200:201], v[186:187], v[196:199]
    v_mfma_f32_16x16x16_bf16 v[204:207], v[202:203], v[186:187], v[204:207]
    v_cvt_pk_bf16_f32 v140, v148, v149
    v_cvt_pk_bf16_f32 v141, v150, v151
    v_cvt_pk_bf16_f32 v142, v156, v157
    v_cvt_pk_bf16_f32 v143, v158, v159
    buffer_store_dwordx4 v[140:143], v25, s[20:23], s66 offen sc1
    v_mul_f32 v236, v236, v238
    v_mul_f32 v237, v237, v238
    v_cvt_pk_bf16_f32 v236, v236, v237
    v_perm_b32 v232, v236, v236, v20
    v_perm_b32 v233, v236, v236, v21
    v_perm_b32 v234, v236, v236, v22
    v_perm_b32 v235, v236, v236, v23
    v_mfma_f32_16x16x16_bf16 v[220:223], v[200:201], v[208:209], 0
    v_mfma_f32_16x16x16_bf16 v[228:231], v[202:203], v[208:209], 0
    v_mfma_f32_16x16x16_bf16 v[220:223], v[224:225], v[210:211], v[220:223]
    v_mfma_f32_16x16x16_bf16 v[228:231], v[226:227], v[210:211], v[228:231]
    v_cvt_pk_bf16_f32 v164, v172, v173
    v_cvt_pk_bf16_f32 v165, v174, v175
    v_cvt_pk_bf16_f32 v166, v180, v181
    v_cvt_pk_bf16_f32 v167, v182, v183
    buffer_store_dwordx4 v[164:167], v25, s[20:23], s67 offen sc1
    v_mul_f32 v116, v116, v118
    v_mul_f32 v117, v117, v118
    v_cvt_pk_bf16_f32 v116, v116, v117
    v_perm_b32 v112, v116, v116, v20
    v_perm_b32 v113, v116, v116, v21
    v_perm_b32 v114, v116, v116, v22
    v_perm_b32 v115, v116, v116, v23
    v_mfma_f32_16x16x16_bf16 v[244:247], v[224:225], v[232:233], 0
    v_mfma_f32_16x16x16_bf16 v[252:255], v[226:227], v[232:233], 0
    v_mfma_f32_16x16x16_bf16 v[244:247], v[248:249], v[234:235], v[244:247]
    v_mfma_f32_16x16x16_bf16 v[252:255], v[250:251], v[234:235], v[252:255]
    v_cvt_pk_bf16_f32 v188, v196, v197
    v_cvt_pk_bf16_f32 v189, v198, v199
    v_cvt_pk_bf16_f32 v190, v204, v205
    v_cvt_pk_bf16_f32 v191, v206, v207
    buffer_store_dwordx4 v[188:191], v25, s[20:23], s68 offen sc1
    v_mfma_f32_16x16x16_bf16 v[124:127], v[60:61], v[112:113], 0
    v_mfma_f32_16x16x16_bf16 v[132:135], v[62:63], v[112:113], 0
    v_mfma_f32_16x16x16_bf16 v[124:127], v[128:129], v[114:115], v[124:127]
    v_mfma_f32_16x16x16_bf16 v[132:135], v[130:131], v[114:115], v[132:135]
    v_cvt_pk_bf16_f32 v212, v220, v221
    v_cvt_pk_bf16_f32 v213, v222, v223
    v_cvt_pk_bf16_f32 v214, v228, v229
    v_cvt_pk_bf16_f32 v215, v230, v231
    buffer_store_dwordx4 v[212:215], v25, s[20:23], s69 offen sc1
    v_cvt_pk_bf16_f32 v236, v244, v245
    v_cvt_pk_bf16_f32 v237, v246, v247
    v_cvt_pk_bf16_f32 v238, v252, v253
    v_cvt_pk_bf16_f32 v239, v254, v255
    buffer_store_dwordx4 v[236:239], v25, s[20:23], s70 offen sc1
    s_cmp_eq_u32 s41, 0
    s_cbranch_scc1 F_cdone
    v_cvt_pk_bf16_f32 v116, v124, v125
    v_cvt_pk_bf16_f32 v117, v126, v127
    v_cvt_pk_bf16_f32 v118, v132, v133
    v_cvt_pk_bf16_f32 v119, v134, v135
    buffer_store_dwordx4 v[116:119], v25, s[20:23], 0 offen sc1
F_cdone:
    s_mov_b64 exec, 1
    s_waitcnt vmcnt(0)
    ds_add_rtn_u32 v3, v1, v16 offset:20
    s_waitcnt lgkmcnt(0)
    v_readfirstlane_b32 s42, v3
    s_nop 0
    s_cmp_lg_u32 s42, 3
    s_cbranch_scc1 F_nfl
    buffer_store_dword v16, v33, s[20:23], 0 offen sc1
F_nfl:
    s_mov_b64 exec, -1
    s_setprio 0
F_help2:
    s_and_b32 s30, s28, 1
    s_lshl_b32 s30, s30, 3
    s_and_b32 s31, s28, 2
    s_lshl_b32 s31, s31, 1
    s_add_u32 s30, s30, s31
    s_lshr_b32 s31, s29, 3
    s_add_u32 s30, s30, s31
    s_and_b32 s34, s29, 7
    s_add_u32 s32, s28, 3
    s_and_b32 s32, s32, 7
    s_cmp_eq_u32 s29, 27
    s_cselect_b32 s34, s32, s34
    s_add_u32 s32, s32, 24
    s_cmp_eq_u32 s29, s32
    s_cselect_b32 s34, 3, s34
    s_and_b32 s32, s28, 4
    s_lshl_b32 s32, s32, 1
    s_add_u32 s32, s32, s34
    s_mov_b32 s20, s74
    s_mov_b32 s21, s75
    s_mov_b32 s22, 0x1000000
    s_mov_b32 s23, 0x20000
    s_branch F_sp_27_e
F_sp_27:
    s_sleep 1
F_sp_27_e:
    ds_read_b32 v16, v1 offset:24
    s_waitcnt lgkmcnt(0)
    v_readfirstlane_b32 s49, v16
    s_nop 0
    s_cmp_ge_u32 s49, 1
    s_cbranch_scc0 F_sp_27
    s_cmp_lg_u32 s3, 0
    s_cbranch_scc1 F_h2t
F_h2p:
    s_lshl_b32 s49, s30, 3
    s_mul_i32 s50, s49, 187
    s_lshr_b32 s50, s50, 11
    s_add_u32 s49, s49, 7
    s_mul_i32 s49, s49, 187
    s_lshr_b32 s49, s49, 11
    v_mov_b32 v16, s50
    v_mov_b32 v17, s49
    v_cmp_gt_u32 vcc, 16, v0
    s_nop 1
    v_cndmask_b32 v16, v17, v16, vcc
    v_and_b32 v17, 15, v0
    v_lshlrev_b32 v17, 7, v17
    v_lshl_add_u32 v8, v16, 11, v17
    v_add_u32 v8, 0x10000, v8
    s_mov_b32 s49, 0
    s_mov_b32 exec_hi, 0
    s_mov_b32 s52, -1
    s_mov_b32 s53, 0
F_opl_28:
    buffer_load_dword v16, v8, s[20:23], 0 offen sc1
    s_add_u32 s49, s49, 1
    s_waitcnt vmcnt(0)
    v_cmp_ne_u32 vcc, 0, v16
    s_nop 0
    s_or_b32 s53, s53, vcc_lo
    s_cmp_lt_u32 s49, 0x8000
    s_cselect_b32 s50, s53, s52
    s_mov_b32 exec_lo, 1
    v_mov_b32 v17, s50
    ds_or_b32 v1, v17 offset:28
    s_cmp_eq_u32 s50, s52
    s_cbranch_scc1 F_h2e
    s_not_b32 exec_lo, s53
    s_cmp_eq_u32 s53, 0
    s_cbranch_scc0 F_ops_29
    s_sleep 12
F_ops_29:
    s_sleep 8
    s_branch F_opl_28
F_h2t:
    s_lshl_b32 s35, s30, 7
    s_lshl_b32 s36, s3, 2
    v_add_u32 v2, s36, v1
    ds_read_b32 v10, v2 offset:276
    ds_read2_b32 v[2:3], v2 offset0:63 offset1:66
    v_lshrrev_b32 v4, 4, v0
    v_lshlrev_b32 v4, 15, v4
    v_and_b32 v5, 15, v0
    v_lshl_add_u32 v4, v5, 4, v4
    s_lshl_b32 s36, s32, 8
    s_add_u32 s36, s36, 0x600000
    v_add_u32 v4, s36, v4
    v_lshlrev_b32 v5, 4, v5
    v_add_u32 v5, 157184, v5
    v_min_u32 v7, 55, v0
    v_lshlrev_b32 v7, 7, v7
    v_add_u32 v7, 0x16000, v7
    s_waitcnt lgkmcnt(0)
    v_readfirstlane_b32 s60, v2
    v_readfirstlane_b32 s61, v3
    v_readfirstlane_b32 s62, v10
    s_sub_u32 s36, s3, 1
F_hl:
    s_and_b32 s49, s60, 0x7ff
    s_sub_u32 s49, 2047, s49
    s_sub_u32 s49, s49, s35
    s_cmp_lt_u32 s49, 128
    s_cbranch_scc0 F_hn
    s_mov_b32 s24, s72
    s_mov_b32 s25, s73
    s_mov_b32 s26, 0x100
    s_mov_b32 s27, 0x20000
    s_branch F_sp_31_e
F_sp_31:
    s_sleep 2
F_sp_31_e:
    ds_read_b32 v8, v1 offset:0
    s_waitcnt lgkmcnt(0)
    v_readfirstlane_b32 s49, v8
    s_nop 0
    s_cmp_ge_u32 s49, 4
    s_cbranch_scc0 F_sp_31
    v_mov_b32 v7, 64
    s_mov_b32 s49, 0
F_pl_32:
    buffer_load_dword v8, v7, s[24:27], 0 offen sc1
    s_waitcnt vmcnt(0)
F_pc_33:
    v_cmp_ne_u32 vcc, 0, v8
    s_nop 0
    s_cmp_eq_u64 vcc, -1
    s_cbranch_scc1 F_pd_34
    s_add_u32 s49, s49, 1
    s_cmp_lt_u32 s49, 0x8000
    s_cbranch_scc0 F_pd_34
    s_sleep 12
    s_branch F_pl_32
F_pd_34:
    s_branch F_sp_35_e
F_sp_35:
    s_sleep 2
F_sp_35_e:
    ds_read_b32 v8, v1 offset:0
    s_waitcnt lgkmcnt(0)
    v_readfirstlane_b32 s49, v8
    s_nop 0
    s_cmp_ge_u32 s49, 8
    s_cbranch_scc0 F_sp_35
    s_lshl_b32 s37, s36, 12
    buffer_load_dwordx4 v[16:19], v4, s[20:23], s37 offen sc1
    s_add_u32 s37, s37, 0x20000
    buffer_load_dwordx4 v[20:23], v4, s[20:23], s37 offen sc1
    s_add_u32 s37, s37, 0x20000
    buffer_load_dwordx4 v[24:27], v4, s[20:23], s37 offen sc1
    s_add_u32 s37, s37, 0x20000
    buffer_load_dwordx4 v[28:31], v4, s[20:23], s37 offen sc1
    s_add_u32 s37, s37, 0x20000
    buffer_load_dwordx4 v[32:35], v4, s[20:23], s37 offen sc1
    s_add_u32 s37, s37, 0x20000
    buffer_load_dwordx4 v[36:39], v4, s[20:23], s37 offen sc1
    s_add_u32 s37, s37, 0x20000
    buffer_load_dwordx4 v[40:43], v4, s[20:23], s37 offen sc1
    s_add_u32 s37, s37, 0x20000
    buffer_load_dwordx4 v[44:47], v4, s[20:23], s37 offen sc1
    s_add_u32 s37, s37, 0x20000
    buffer_load_dwordx4 v[48:51], v4, s[20:23], s37 offen sc1
    s_add_u32 s37, s37, 0x20000
    buffer_load_dwordx4 v[52:55], v4, s[20:23], s37 offen sc1
    s_add_u32 s37, s37, 0x20000
    buffer_load_dwordx4 v[56:59], v4, s[20:23], s37 offen sc1
    s_add_u32 s37, s37, 0x20000
    buffer_load_dwordx4 v[60:63], v4, s[20:23], s37 offen sc1
    s_add_u32 s37, s37, 0x20000
    buffer_load_dwordx4 v[64:67], v4, s[20:23], s37 offen sc1
    s_add_u32 s37, s37, 0x20000
    buffer_load_dwordx4 v[68:71], v4, s[20:23], s37 offen sc1
    s_lshr_b32 s50, s60, 16
    s_xor_b32 s51, s50, 0x8000
    s_xor_b32 s52, s50, 0xffff
    s_bitcmp1_b32 s50, 15
    s_cselect_b32 s50, s51, s52
    s_lshl_b32 s50, s50, 16
    v_mov_b32 v8, s50
    v_mul_f32 v8, 0xbfb8aa3b, v8
    v_exp_f32 v8, v8
    s_nop 0
    v_add_f32 v8, 1.0, v8
    v_rcp_f32 v8, v8
    s_nop 0
    v_cvt_pk_bf16_f32 v8, v8, v8
    v_and_b32 v8, s39, v8
    s_waitcnt vmcnt(12)
    v_pk_add_f32 v[16:17], v[16:17], v[20:21]
    v_pk_add_f32 v[18:19], v[18:19], v[22:23]
    s_waitcnt vmcnt(11)
    v_pk_add_f32 v[16:17], v[16:17], v[24:25]
    v_pk_add_f32 v[18:19], v[18:19], v[26:27]
    s_waitcnt vmcnt(10)
    v_pk_add_f32 v[16:17], v[16:17], v[28:29]
    v_pk_add_f32 v[18:19], v[18:19], v[30:31]
    s_waitcnt vmcnt(9)
    v_pk_add_f32 v[16:17], v[16:17], v[32:33]
    v_pk_add_f32 v[18:19], v[18:19], v[34:35]
    s_waitcnt vmcnt(8)
    v_pk_add_f32 v[16:17], v[16:17], v[36:37]
    v_pk_add_f32 v[18:19], v[18:19], v[38:39]
    s_waitcnt vmcnt(7)
    v_pk_add_f32 v[16:17], v[16:17], v[40:41]
    v_pk_add_f32 v[18:19], v[18:19], v[42:43]
    s_waitcnt vmcnt(6)
    v_pk_add_f32 v[16:17], v[16:17], v[44:45]
    v_pk_add_f32 v[18:19], v[18:19], v[46:47]
    s_waitcnt vmcnt(5)
    v_pk_add_f32 v[16:17], v[16:17], v[48:49]
    v_pk_add_f32 v[18:19], v[18:19], v[50:51]
    s_waitcnt vmcnt(4)
    v_pk_add_f32 v[16:17], v[16:17], v[52:53]
    v_pk_add_f32 v[18:19], v[18:19], v[54:55]
    s_waitcnt vmcnt(3)
    v_pk_add_f32 v[16:17], v[16:17], v[56:57]
    v_pk_add_f32 v[18:19], v[18:19], v[58:59]
    s_waitcnt vmcnt(2)
    v_pk_add_f32 v[16:17], v[16:17], v[60:61]
    v_pk_add_f32 v[18:19], v[18:19], v[62:63]
    s_waitcnt vmcnt(1)
    v_pk_add_f32 v[16:17], v[16:17], v[64:65]
    v_pk_add_f32 v[18:19], v[18:19], v[66:67]
    s_waitcnt vmcnt(0)
    v_pk_add_f32 v[16:17], v[16:17], v[68:69]
    v_pk_add_f32 v[18:19], v[18:19], v[70:71]
    v_mov_b32 v20, v16
    v_mov_b32 v21, v17
    v_mov_b32 v22, v18
    v_mov_b32 v23, v19
    v_permlane32_swap_b32 v16, v20
    v_permlane32_swap_b32 v17, v21
    v_permlane32_swap_b32 v18, v22
    v_permlane32_swap_b32 v19, v23
    v_pk_add_f32 v[16:17], v[16:17], v[20:21]
    v_pk_add_f32 v[18:19], v[18:19], v[22:23]
    v_mov_b32 v20, v16
    v_mov_b32 v21, v17
    v_mov_b32 v22, v18
    v_mov_b32 v23, v19
    v_permlane16_swap_b32 v16, v20
    v_permlane16_swap_b32 v17, v21
    v_permlane16_swap_b32 v18, v22
    v_permlane16_swap_b32 v19, v23
    v_pk_add_f32 v[16:17], v[16:17], v[20:21]
    v_pk_add_f32 v[18:19], v[18:19], v[22:23]
    v_cvt_pk_bf16_f32 v20, v16, v17
    v_cvt_pk_bf16_f32 v21, v18, v19
    v_lshlrev_b32 v16, 16, v20
    v_and_b32 v17, s39, v20
    v_lshlrev_b32 v18, 16, v21
    v_and_b32 v19, s39, v21
    v_mul_f32 v16, v16, v8
    v_mul_f32 v17, v17, v8
    v_mul_f32 v18, v18, v8
    v_mul_f32 v19, v19, v8
    v_cvt_pk_bf16_f32 v20, v16, v17
    v_cvt_pk_bf16_f32 v21, v18, v19
    v_lshlrev_b32 v16, 16, v20
    v_and_b32 v17, s39, v20
    v_lshlrev_b32 v18, 16, v21
    v_and_b32 v19, s39, v21
    s_lshl_b32 s37, s36, 8
    v_add_u32 v6, s37, v5
    ds_write_b128 v6, v[16:19]
F_hn:
    s_mov_b32 s60, s61
    s_mov_b32 s61, s62
    s_add_u32 s36, s36, 3
    s_cmp_lt_u32 s36, 8
    s_cbranch_scc1 F_hl
    v_mov_b32 v9, 1
    s_mov_b64 exec, 1
    s_waitcnt lgkmcnt(0)
    ds_add_u32 v1, v9 offset:32
F_h2e:
    s_endpgm
F_moe:
    s_load_dwordx8 s[64:71], s[0:1], 32
    s_mov_b32 s60, 0x3a800000
    v_lshlrev_b32 v13, 2, v0
    v_add_u32 v13, 147456, v13
    v_mov_b32 v14, 0
    v_cmp_lt_u32 vcc, 10, v0
    ds_write_b32 v13, v14 offset:11776
    ds_write_b32 v13, v14 offset:256
    v_cndmask_b32 v15, 0, 4, vcc
    ds_write_b32 v13, v15
    s_and_b32 s33, s28, 1
    s_lshl_b32 s33, s33, 10
    s_lshr_b32 s36, s28, 1
    s_lshl_b32 s36, s36, 8
    s_add_u32 s33, s33, s36
    s_sub_u32 s36, s29, 24
    s_lshl_b32 s36, s36, 5
    s_add_u32 s33, s33, s36
    s_lshl_b32 s36, s3, 2
    s_add_u32 s33, s33, s36
    s_mul_i32 s30, s28, 7
    s_add_u32 s30, s30, s29
    s_sub_u32 s30, s30, 24
    s_cmp_eq_u32 s29, 31
    s_cselect_b32 s30, 0, s30
    s_lshl_b32 s45, s3, 14
    v_bfe_u32 v13, v0, 2, 3
    v_lshrrev_b32 v14, 1, v13
    v_xor_b32 v14, 0, v14
    v_lshlrev_b32 v1, 5, v14
    v_lshl_add_u32 v1, v13, 7, v1
    v_and_b32 v13, 3, v0
    v_lshl_add_u32 v1, v13, 3, v1
    v_lshrrev_b32 v13, 5, v0
    v_lshl_add_u32 v1, v13, 11, v1
    v_add_u32 v1, s45, v1
    v_bfe_u32 v13, v0, 2, 3
    v_lshrrev_b32 v14, 1, v13
    v_xor_b32 v14, 1, v14
    v_lshlrev_b32 v2, 5, v14
    v_lshl_add_u32 v2, v13, 7, v2
    v_and_b32 v13, 3, v0
    v_lshl_add_u32 v2, v13, 3, v2
    v_lshrrev_b32 v13, 5, v0
    v_lshl_add_u32 v2, v13, 11, v2
    v_add_u32 v2, s45, v2
    v_bfe_u32 v13, v0, 2, 3
    v_lshrrev_b32 v14, 1, v13
    v_xor_b32 v14, 2, v14
    v_lshlrev_b32 v3, 5, v14
    v_lshl_add_u32 v3, v13, 7, v3
    v_and_b32 v13, 3, v0
    v_lshl_add_u32 v3, v13, 3, v3
    v_lshrrev_b32 v13, 5, v0
    v_lshl_add_u32 v3, v13, 11, v3
    v_add_u32 v3, s45, v3
    v_bfe_u32 v13, v0, 2, 3
    v_lshrrev_b32 v14, 1, v13
    v_xor_b32 v14, 3, v14
    v_lshlrev_b32 v4, 5, v14
    v_lshl_add_u32 v4, v13, 7, v4
    v_and_b32 v13, 3, v0
    v_lshl_add_u32 v4, v13, 3, v4
    v_lshrrev_b32 v13, 5, v0
    v_lshl_add_u32 v4, v13, 11, v4
    v_add_u32 v4, s45, v4
    s_mov_b32 s36, 7168
    v_lshrrev_b32 v13, 3, v0
    v_and_b32 v14, 6, v13
    v_and_b32 v5, 7, v0
    v_xor_b32 v5, v5, v14
    v_lshlrev_b32 v5, 4, v5
    v_and_b32 v14, 4, v13
    v_add_u32 v13, v13, v14
    v_mul_lo_u32 v13, v13, s36
    v_add_u32 v5, v5, v13
    s_lshl_b32 s36, s30, 7
    s_mul_i32 s37, s3, 917504
    s_add_u32 s36, s36, s37
    v_add_u32 v5, s36, v5
    v_add_u32 v6, 27648, v5
    v_add_u32 v7, 112640, v5
    v_add_u32 v8, 140288, v5
    s_mov_b32 s36, 2048
    v_lshrrev_b32 v13, 3, v0
    v_and_b32 v14, 6, v13
    v_and_b32 v9, 7, v0
    v_xor_b32 v9, v9, v14
    v_lshlrev_b32 v9, 4, v9
    v_mul_lo_u32 v13, v13, s36
    v_add_u32 v9, v9, v13
    s_lshl_b32 s36, s30, 17
    s_lshl_b32 s37, s3, 8
    s_add_u32 s36, s36, s37
    v_add_u32 v9, s36, v9
    v_add_u32 v10, 31744, v9
    v_add_u32 v11, 14336, v9
    v_add_u32 v12, 46080, v9
    s_waitcnt lgkmcnt(0)
    s_mov_b32 s76, s4
    s_mov_b32 s77, s5
    s_mov_b32 s78, 0x400000
    s_mov_b32 s79, 0x20000
    s_mov_b32 s80, s64
    s_mov_b32 s81, s65
    s_mov_b32 s82, 0x800
    s_mov_b32 s83, 0x20000
    s_mov_b32 s20, s74
    s_mov_b32 s21, s75
    s_mov_b32 s22, 0x1000000
    s_mov_b32 s23, 0x20000
    s_cmp_lg_u32 s2, 252
    s_cbranch_scc1 F_nz
    s_mov_b32 s24, s72
    s_mov_b32 s25, s73
    s_mov_b32 s26, 0x100
    s_mov_b32 s27, 0x20000
    s_lshl_b32 s36, s3, 10
    s_add_u32 s36, s36, 0x18000
    v_lshlrev_b32 v13, 4, v0
    v_mov_b64 v[144:145], 0
    v_mov_b64 v[146:147], 0
    buffer_store_dwordx4 v[144:147], v13, s[20:23], s36 offen sc1
    v_mov_b32 v14, 1
    s_waitcnt vmcnt(0)
    s_barrier
    s_cmp_lg_u32 s3, 0
    s_cbranch_scc1 F_nz1
    s_mov_b64 exec, 1
    buffer_store_dword v14, v145, s[24:27], 0 offen sc1
    s_mov_b64 exec, -1
F_nz1:
    s_lshl_b32 s36, s3, 12
    s_add_u32 s36, s36, 0x10000
    v_lshlrev_b32 v13, 7, v0
    v_mov_b32 v15, 0
    s_mov_b32 exec_hi, 0
    buffer_store_dword v15, v13, s[20:23], s36 offen sc1
    s_mov_b32 exec_hi, -1
F_nz:
    s_mov_b32 s8, s6
    s_mov_b32 s9, s7
    s_mov_b32 s10, 0x600000
    s_mov_b32 s11, 0x20000
    s_sub_u32 s36, s29, 24
    s_lshl_b32 s36, s36, 3
    s_add_u32 s36, s36, s3
    s_lshl_b32 s36, s36, 1
    s_and_b32 s37, s28, 1
    s_add_u32 s36, s36, s37
    s_mul_i32 s36, s36, 16384
    s_lshr_b32 s37, s28, 1
    s_lshl_b32 s37, s37, 9
    s_add_u32 s36, s36, s37
    s_add_u32 s36, s36, 393216
    v_lshrrev_b32 v13, 2, v0
    v_lshlrev_b32 v13, 11, v13
    v_and_b32 v14, 3, v0
    v_lshl_add_u32 v13, v14, 7, v13
    s_mov_b32 exec_hi, 0x0
    buffer_load_dword v15, v13, s[8:11], s36 offen
    s_mov_b64 exec, -1
    v_lshlrev_b32 v16, 4, v0
    s_lshl_b32 s54, s33, 11
    s_add_u32 s55, s54, 0x1000
    buffer_load_dwordx4 v[24:27], v16, s[76:79], s54 offen offset:0
    buffer_load_dwordx4 v[32:35], v16, s[76:79], s54 offen offset:2048
    buffer_load_dwordx4 v[40:43], v16, s[76:79], s55 offen offset:0
    buffer_load_dwordx4 v[48:51], v16, s[76:79], s55 offen offset:2048
    buffer_load_dwordx4 v[28:31], v16, s[76:79], s54 offen offset:1024
    buffer_load_dwordx4 v[36:39], v16, s[76:79], s54 offen offset:3072
    buffer_load_dwordx4 v[44:47], v16, s[76:79], s55 offen offset:1024
    buffer_load_dwordx4 v[52:55], v16, s[76:79], s55 offen offset:3072
    buffer_load_dwordx4 v[56:59], v16, s[80:83], 0 offen offset:0
    buffer_load_dwordx4 v[60:63], v16, s[80:83], 0 offen offset:1024
    s_mov_b32 s8, s66
    s_mov_b32 s9, s67
    s_mov_b32 s10, 0x700000
    s_mov_b32 s11, 0x20000
    s_mov_b32 s12, s68
    s_mov_b32 s13, s69
    s_mov_b32 s14, 0x700000
    s_mov_b32 s15, 0x20000
    s_mov_b32 s16, s70
    s_mov_b32 s17, s71
    s_mov_b32 s18, 0x700000
    s_mov_b32 s19, 0x20000
    s_mov_b32 s24, s72
    s_mov_b32 s25, s73
    s_mov_b32 s26, 0x100
    s_mov_b32 s27, 0x20000
    s_cmp_eq_u32 s29, 31
    s_cselect_b32 s18, 0, s18
    v_mov_b32 v145, 0
    v_mov_b32 v144, 0
    s_mov_b32 s52, 0x3f803f80
    s_waitcnt vmcnt(5)
    v_dot2_f32_bf16 v64, v24, s52, 0
    v_dot2_f32_bf16 v68, v24, v24, 0
    v_dot2_f32_bf16 v64, v25, s52, v64
    v_dot2_f32_bf16 v68, v25, v25, v68
    v_dot2_f32_bf16 v64, v26, s52, v64
    v_dot2_f32_bf16 v68, v26, v26, v68
    v_dot2_f32_bf16 v64, v27, s52, v64
    v_dot2_f32_bf16 v68, v27, v27, v68
    v_dot2_f32_bf16 v64, v28, s52, v64
    v_dot2_f32_bf16 v68, v28, v28, v68
    v_dot2_f32_bf16 v64, v29, s52, v64
    v_dot2_f32_bf16 v68, v29, v29, v68
    v_dot2_f32_bf16 v64, v30, s52, v64
    v_dot2_f32_bf16 v68, v30, v30, v68
    v_dot2_f32_bf16 v64, v31, s52, v64
    v_dot2_f32_bf16 v68, v31, v31, v68
    s_waitcnt vmcnt(4)
    v_dot2_f32_bf16 v65, v32, s52, 0
    v_dot2_f32_bf16 v69, v32, v32, 0
    v_dot2_f32_bf16 v65, v33, s52, v65
    v_dot2_f32_bf16 v69, v33, v33, v69
    v_dot2_f32_bf16 v65, v34, s52, v65
    v_dot2_f32_bf16 v69, v34, v34, v69
    v_dot2_f32_bf16 v65, v35, s52, v65
    v_dot2_f32_bf16 v69, v35, v35, v69
    v_dot2_f32_bf16 v65, v36, s52, v65
    v_dot2_f32_bf16 v69, v36, v36, v69
    v_dot2_f32_bf16 v65, v37, s52, v65
    v_dot2_f32_bf16 v69, v37, v37, v69
    v_dot2_f32_bf16 v65, v38, s52, v65
    v_dot2_f32_bf16 v69, v38, v38, v69
    v_dot2_f32_bf16 v65, v39, s52, v65
    v_dot2_f32_bf16 v69, v39, v39, v69
    s_waitcnt vmcnt(3)
    v_dot2_f32_bf16 v66, v40, s52, 0
    v_dot2_f32_bf16 v70, v40, v40, 0
    v_dot2_f32_bf16 v66, v41, s52, v66
    v_dot2_f32_bf16 v70, v41, v41, v70
    v_dot2_f32_bf16 v66, v42, s52, v66
    v_dot2_f32_bf16 v70, v42, v42, v70
    v_dot2_f32_bf16 v66, v43, s52, v66
    v_dot2_f32_bf16 v70, v43, v43, v70
    v_dot2_f32_bf16 v66, v44, s52, v66
    v_dot2_f32_bf16 v70, v44, v44, v70
    v_dot2_f32_bf16 v66, v45, s52, v66
    v_dot2_f32_bf16 v70, v45, v45, v70
    v_dot2_f32_bf16 v66, v46, s52, v66
    v_dot2_f32_bf16 v70, v46, v46, v70
    v_dot2_f32_bf16 v66, v47, s52, v66
    v_dot2_f32_bf16 v70, v47, v47, v70
    s_waitcnt vmcnt(2)
    s_waitcnt vmcnt(0)
    s_add_u32 m0, s45, 0
    s_mov_b32 s46, 0
    buffer_load_dwordx4 v9, s[16:19], s46 offen offset:0 nt lds
    buffer_load_dwordx4 v10, s[16:19], s46 offen offset:1024 nt lds
    buffer_load_dwordx4 v11, s[16:19], s46 offen offset:2048 nt lds
    buffer_load_dwordx4 v12, s[16:19], s46 offen offset:3072 nt lds
    s_add_u32 m0, s45, 4096
    s_mov_b32 s46, 65536
    buffer_load_dwordx4 v9, s[16:19], s46 offen offset:0 nt lds
    buffer_load_dwordx4 v10, s[16:19], s46 offen offset:1024 nt lds
    buffer_load_dwordx4 v11, s[16:19], s46 offen offset:2048 nt lds
    buffer_load_dwordx4 v12, s[16:19], s46 offen offset:3072 nt lds
    v_dot2_f32_bf16 v67, v48, s52, 0
    v_dot2_f32_bf16 v71, v48, v48, 0
    v_dot2_f32_bf16 v67, v49, s52, v67
    v_dot2_f32_bf16 v71, v49, v49, v71
    v_dot2_f32_bf16 v67, v50, s52, v67
    v_dot2_f32_bf16 v71, v50, v50, v71
    v_dot2_f32_bf16 v67, v51, s52, v67
    v_dot2_f32_bf16 v71, v51, v51, v71
    v_dot2_f32_bf16 v67, v52, s52, v67
    v_dot2_f32_bf16 v71, v52, v52, v71
    v_dot2_f32_bf16 v67, v53, s52, v67
    v_dot2_f32_bf16 v71, v53, v53, v71
    v_dot2_f32_bf16 v67, v54, s52, v67
    v_dot2_f32_bf16 v71, v54, v54, v71
    v_dot2_f32_bf16 v67, v55, s52, v67
    v_dot2_f32_bf16 v71, v55, v55, v71
    v_dot2_f32_bf16 v72, v24, v56, 0
    v_dot2_f32_bf16 v73, v32, v56, 0
    v_dot2_f32_bf16 v74, v40, v56, 0
    v_dot2_f32_bf16 v75, v48, v56, 0
    v_dot2_f32_bf16 v76, v56, s52, 0
    v_dot2_f32_bf16 v72, v25, v57, v72
    v_dot2_f32_bf16 v73, v33, v57, v73
    v_dot2_f32_bf16 v74, v41, v57, v74
    v_dot2_f32_bf16 v75, v49, v57, v75
    v_dot2_f32_bf16 v76, v57, s52, v76
    v_dot2_f32_bf16 v72, v26, v58, v72
    v_dot2_f32_bf16 v73, v34, v58, v73
    v_dot2_f32_bf16 v74, v42, v58, v74
    v_dot2_f32_bf16 v75, v50, v58, v75
    v_dot2_f32_bf16 v76, v58, s52, v76
    v_dot2_f32_bf16 v72, v27, v59, v72
    v_dot2_f32_bf16 v73, v35, v59, v73
    v_dot2_f32_bf16 v74, v43, v59, v74
    v_dot2_f32_bf16 v75, v51, v59, v75
    v_dot2_f32_bf16 v76, v59, s52, v76
    v_dot2_f32_bf16 v72, v28, v60, v72
    v_dot2_f32_bf16 v73, v36, v60, v73
    v_dot2_f32_bf16 v74, v44, v60, v74
    v_dot2_f32_bf16 v75, v52, v60, v75
    v_dot2_f32_bf16 v76, v60, s52, v76
    v_dot2_f32_bf16 v72, v29, v61, v72
    v_dot2_f32_bf16 v73, v37, v61, v73
    v_dot2_f32_bf16 v74, v45, v61, v74
    v_dot2_f32_bf16 v75, v53, v61, v75
    v_dot2_f32_bf16 v76, v61, s52, v76
    v_dot2_f32_bf16 v72, v30, v62, v72
    v_dot2_f32_bf16 v73, v38, v62, v73
    v_dot2_f32_bf16 v74, v46, v62, v74
    v_dot2_f32_bf16 v75, v54, v62, v75
    v_dot2_f32_bf16 v76, v62, s52, v76
    v_dot2_f32_bf16 v72, v31, v63, v72
    v_dot2_f32_bf16 v73, v39, v63, v73
    v_dot2_f32_bf16 v74, v47, v63, v74
    v_dot2_f32_bf16 v75, v55, v63, v75
    v_dot2_f32_bf16 v76, v63, s52, v76
    v_bfe_u32 v23, v0, 4, 1
    v_lshrrev_b32 v22, 5, v0
    v_lshl_add_u32 v23, v23, 1, v22
    v_add_u32 v23, s33, v23
    v_mov_b32 v77, v76
    v_mov_b32 v78, v76
    v_mov_b32 v79, v76
    v_permlane32_swap_b32 v64, v65
    v_permlane32_swap_b32 v68, v69
    v_permlane32_swap_b32 v72, v73
    v_permlane32_swap_b32 v76, v77
    v_permlane32_swap_b32 v66, v67
    v_permlane32_swap_b32 v70, v71
    v_permlane32_swap_b32 v74, v75
    v_permlane32_swap_b32 v78, v79
    v_add_f32 v64, v64, v65
    v_add_f32 v68, v68, v69
    v_add_f32 v72, v72, v73
    v_add_f32 v76, v76, v77
    v_add_f32 v66, v66, v67
    v_add_f32 v70, v70, v71
    v_add_f32 v74, v74, v75
    v_add_f32 v78, v78, v79
    v_permlane16_swap_b32 v64, v66
    v_permlane16_swap_b32 v68, v70
    v_permlane16_swap_b32 v72, v74
    v_permlane16_swap_b32 v76, v78
    v_add_f32 v64, v64, v66
    v_add_f32 v68, v68, v70
    v_add_f32 v72, v72, v74
    v_add_f32 v76, v76, v78
    v_add_f32_dpp v64, v64, v64 quad_perm:[1,0,3,2] row_mask:0xf bank_mask:0xf
    v_add_f32_dpp v68, v68, v68 quad_perm:[1,0,3,2] row_mask:0xf bank_mask:0xf
    v_add_f32_dpp v72, v72, v72 quad_perm:[1,0,3,2] row_mask:0xf bank_mask:0xf
    v_add_f32_dpp v76, v76, v76 quad_perm:[1,0,3,2] row_mask:0xf bank_mask:0xf
    v_add_f32_dpp v64, v64, v64 quad_perm:[2,3,0,1] row_mask:0xf bank_mask:0xf
    v_add_f32_dpp v68, v68, v68 quad_perm:[2,3,0,1] row_mask:0xf bank_mask:0xf
    v_add_f32_dpp v72, v72, v72 quad_perm:[2,3,0,1] row_mask:0xf bank_mask:0xf
    v_add_f32_dpp v76, v76, v76 quad_perm:[2,3,0,1] row_mask:0xf bank_mask:0xf
    v_add_f32_dpp v64, v64, v64 row_half_mirror row_mask:0xf bank_mask:0xf
    v_add_f32_dpp v68, v68, v68 row_half_mirror row_mask:0xf bank_mask:0xf
    v_add_f32_dpp v72, v72, v72 row_half_mirror row_mask:0xf bank_mask:0xf
    v_add_f32_dpp v76, v76, v76 row_half_mirror row_mask:0xf bank_mask:0xf
    v_add_f32_dpp v64, v64, v64 row_mirror row_mask:0xf bank_mask:0xf
    v_add_f32_dpp v68, v68, v68 row_mirror row_mask:0xf bank_mask:0xf
    v_add_f32_dpp v72, v72, v72 row_mirror row_mask:0xf bank_mask:0xf
    v_add_f32_dpp v76, v76, v76 row_mirror row_mask:0xf bank_mask:0xf
    v_mul_f32 v16, s60, v64
    v_cvt_pk_bf16_f32 v20, v16, v16
    v_and_b32 v20, s39, v20
    v_mul_f32 v16, v16, v16
    v_fma_f32 v16, v68, s60, -v16
    v_max_f32 v16, 0, v16
    v_fma_f32 v17, -v20, v76, v72
    v_cvt_pk_bf16_f32 v16, v16, v16
    v_and_b32 v16, s39, v16
    v_add_f32 v16, 0x3727c5ac, v16
    v_cvt_pk_bf16_f32 v16, v16, v16
    v_and_b32 v16, s39, v16
    v_sqrt_f32 v16, v16
    s_nop 0
    v_cvt_pk_bf16_f32 v16, v16, v16
    v_and_b32 v16, s39, v16
    v_rcp_f32 v21, v16
    s_nop 0
    v_mul_f32 v16, v17, v21
    v_cvt_pk_bf16_f32 v16, v16, v16
    v_and_b32 v16, s39, v16
    v_ashrrev_i32 v17, 31, v16
    v_or_b32 v17, 0x80000000, v17
    v_xor_b32 v16, v16, v17
    v_and_b32 v16, s39, v16
    v_sub_u32 v17, 0x7ff, v23
    v_or_b32 v22, v16, v17
    s_cmp_lg_u32 s3, 0
    s_cbranch_scc1 F_nzl
    buffer_load_dword v144, v145, s[24:27], 0 offen sc1
F_nzl:
    v_lshlrev_b32 v16, 2, v23
    v_lshlrev_b32 v17, 3, v23
    s_mov_b32 s46, 0x4000
    s_mov_b32 exec_lo, 0x10001
    s_mov_b32 exec_hi, 0x10001
    buffer_store_dword v22, v16, s[20:23], 0 offen sc1
    buffer_store_dwordx2 v[20:21], v17, s[20:23], s46 offen sc1
    s_mov_b64 exec, -1
    s_add_u32 m0, s45, 8192
    s_mov_b32 s46, 128
    buffer_load_dwordx4 v9, s[16:19], s46 offen offset:0 nt lds
    buffer_load_dwordx4 v10, s[16:19], s46 offen offset:1024 nt lds
    buffer_load_dwordx4 v11, s[16:19], s46 offen offset:2048 nt lds
    buffer_load_dwordx4 v12, s[16:19], s46 offen offset:3072 nt lds
    s_add_u32 m0, s45, 12288
    s_mov_b32 s46, 65664
    buffer_load_dwordx4 v9, s[16:19], s46 offen offset:0 nt lds
    buffer_load_dwordx4 v10, s[16:19], s46 offen offset:1024 nt lds
    buffer_load_dwordx4 v11, s[16:19], s46 offen offset:2048 nt lds
    buffer_load_dwordx4 v12, s[16:19], s46 offen offset:3072 nt lds
    s_cmp_eq_u32 s28, 4
    s_cselect_b32 s36, 30, 31
    s_cmp_lg_u32 s29, s36
    s_cbranch_scc1 F_sc0
    s_add_u32 s36, s3, 32
    s_mov_b32 s80, s6
    s_mov_b32 s81, s7
    s_mov_b32 s82, 0x600000
    s_mov_b32 s83, 0x20000
    s_lshl_b32 s37, s36, 1
    s_and_b32 s38, s28, 1
    s_add_u32 s37, s37, s38
    s_lshl_b32 s37, s37, 15
    s_lshr_b32 s38, s28, 1
    s_lshl_b32 s38, s38, 9
    s_add_u32 s37, s37, s38
    s_add_u32 s37, s37, 393216
    v_lshrrev_b32 v13, 2, v0
    v_lshlrev_b32 v13, 11, v13
    v_and_b32 v14, 3, v0
    v_lshl_add_u32 v13, v14, 7, v13
    buffer_load_dword v200, v13, s[80:83], s37 offen
F_sc0:
    s_cmp_lg_u32 s29, 31
    s_cbranch_scc1 F_sc1
    s_waitcnt vmcnt(1)
    s_cmp_lg_u32 s2, 252
    s_cbranch_scc1 F_sc1
    s_waitcnt vmcnt(0)
F_sc1:
    s_sub_u32 s47, s2, 192
    s_lshl_b32 s47, s47, 1
    v_mov_b32 v13, s47
    v_mov_b32 v15, 1
    s_waitcnt vmcnt(10)
    ds_read_b64_tr_b16 v[64:65], v1 offset:0
    ds_read_b64_tr_b16 v[66:67], v1 offset:1024
    ds_read_b64_tr_b16 v[68:69], v2 offset:0
    ds_read_b64_tr_b16 v[70:71], v2 offset:1024
    ds_read_b64_tr_b16 v[72:73], v3 offset:0
    ds_read_b64_tr_b16 v[74:75], v3 offset:1024
    ds_read_b64_tr_b16 v[76:77], v4 offset:0
    ds_read_b64_tr_b16 v[78:79], v4 offset:1024
    ds_read_b64_tr_b16 v[96:97], v1 offset:4096
    ds_read_b64_tr_b16 v[98:99], v1 offset:5120
    ds_read_b64_tr_b16 v[100:101], v2 offset:4096
    ds_read_b64_tr_b16 v[102:103], v2 offset:5120
    s_waitcnt lgkmcnt(8)
    ds_read_b64_tr_b16 v[104:105], v3 offset:4096
    ds_read_b64_tr_b16 v[106:107], v3 offset:5120
    ds_read_b64_tr_b16 v[108:109], v4 offset:4096
    ds_read_b64_tr_b16 v[110:111], v4 offset:5120
    s_waitcnt lgkmcnt(0)
    s_waitcnt vmcnt(8)
    s_barrier
    s_cmp_lg_u32 s3, 0
    s_cbranch_scc1 F_na
    s_mov_b32 s47, 0
    s_branch F_pc_37
F_pl_36:
    buffer_load_dword v144, v145, s[24:27], 0 offen sc1
    s_waitcnt vmcnt(0)
F_pc_37:
    v_cmp_ne_u32 vcc, 0, v144
    s_nop 0
    s_cmp_eq_u64 vcc, -1
    s_cbranch_scc1 F_pd_38
    s_add_u32 s47, s47, 1
    s_cmp_lt_u32 s47, 0x8000
    s_cbranch_scc0 F_pd_38
    s_sleep 8
    s_branch F_pl_36
F_pd_38:
    v_lshlrev_b32 v13, 6, v13
    v_add_u32 v13, 0x18000, v13
    s_mov_b64 exec, 1
    buffer_store_dword v15, v13, s[20:23], 0 offen sc1
    s_mov_b64 exec, -1
F_na:
    s_cmp_lg_u32 s28, 4
    s_cbranch_scc1 F_nuc
    s_cmp_ge_u32 s29, 30
    s_cbranch_scc1 F_nuc
    s_sub_u32 s36, 7, s3
    s_mul_i32 s36, s36, 6
    s_add_u32 s36, s36, s29
    s_add_u32 s36, s36, 40
    s_cmp_ge_u32 s36, 78
    s_cbranch_scc1 F_nuc
    s_mov_b32 s80, s6
    s_mov_b32 s81, s7
    s_mov_b32 s82, 0x600000
    s_mov_b32 s83, 0x20000
    s_lshl_b32 s37, s36, 1
    s_and_b32 s38, s28, 1
    s_add_u32 s37, s37, s38
    s_lshl_b32 s37, s37, 15
    s_lshr_b32 s38, s28, 1
    s_lshl_b32 s38, s38, 9
    s_add_u32 s37, s37, s38
    s_add_u32 s37, s37, 393216
    v_lshrrev_b32 v13, 2, v0
    v_lshlrev_b32 v13, 11, v13
    v_and_b32 v14, 3, v0
    v_lshl_add_u32 v13, v14, 7, v13
    buffer_load_dword v15, v13, s[80:83], s37 offen
F_nuc:
    v_and_b32 v13, 7, v0
    v_lshlrev_b32 v13, 2, v13
    s_cmp_eq_u32 s29, 31
    s_cbranch_scc1 F_spare
    s_add_u32 m0, s45, 0
    s_mov_b32 s46, 0
    buffer_load_dwordx4 v5, s[8:11], s46 offen offset:0 nt lds
    buffer_load_dwordx4 v6, s[8:11], s46 offen offset:1024 nt lds
    buffer_load_dwordx4 v7, s[8:11], s46 offen offset:2048 nt lds
    buffer_load_dwordx4 v8, s[8:11], s46 offen offset:3072 nt lds
    s_add_u32 m0, s45, 4096
    s_mov_b32 s46, 229376
    buffer_load_dwordx4 v5, s[8:11], s46 offen offset:0 nt lds
    buffer_load_dwordx4 v6, s[8:11], s46 offen offset:1024 nt lds
    buffer_load_dwordx4 v7, s[8:11], s46 offen offset:2048 nt lds
    buffer_load_dwordx4 v8, s[8:11], s46 offen offset:3072 nt lds
    s_waitcnt vmcnt(8)
    ds_read_b64_tr_b16 v[80:81], v1 offset:8192
    ds_read_b64_tr_b16 v[82:83], v1 offset:9216
    ds_read_b64_tr_b16 v[84:85], v2 offset:8192
    ds_read_b64_tr_b16 v[86:87], v2 offset:9216
    ds_read_b64_tr_b16 v[88:89], v3 offset:8192
    ds_read_b64_tr_b16 v[90:91], v3 offset:9216
    ds_read_b64_tr_b16 v[92:93], v4 offset:8192
    ds_read_b64_tr_b16 v[94:95], v4 offset:9216
    ds_read_b64_tr_b16 v[112:113], v1 offset:12288
    ds_read_b64_tr_b16 v[114:115], v1 offset:13312
    ds_read_b64_tr_b16 v[116:117], v2 offset:12288
    ds_read_b64_tr_b16 v[118:119], v2 offset:13312
    s_waitcnt lgkmcnt(8)
    ds_read_b64_tr_b16 v[120:121], v3 offset:12288
    ds_read_b64_tr_b16 v[122:123], v3 offset:13312
    ds_read_b64_tr_b16 v[124:125], v4 offset:12288
    ds_read_b64_tr_b16 v[126:127], v4 offset:13312
    s_waitcnt lgkmcnt(0)
    s_add_u32 m0, s45, 8192
    s_mov_b32 s46, 458752
    buffer_load_dwordx4 v5, s[8:11], s46 offen offset:0 nt lds
    buffer_load_dwordx4 v6, s[8:11], s46 offen offset:1024 nt lds
    buffer_load_dwordx4 v7, s[8:11], s46 offen offset:2048 nt lds
    buffer_load_dwordx4 v8, s[8:11], s46 offen offset:3072 nt lds
    s_add_u32 m0, s45, 12288
    s_mov_b32 s46, 688128
    buffer_load_dwordx4 v5, s[8:11], s46 offen offset:0 nt lds
    buffer_load_dwordx4 v6, s[8:11], s46 offen offset:1024 nt lds
    buffer_load_dwordx4 v7, s[8:11], s46 offen offset:2048 nt lds
    buffer_load_dwordx4 v8, s[8:11], s46 offen offset:3072 nt lds
    s_waitcnt vmcnt(8)
    ds_read_b64_tr_b16 v[128:129], v1 offset:0
    ds_read_b64_tr_b16 v[130:131], v1 offset:1024
    ds_read_b64_tr_b16 v[132:133], v2 offset:0
    ds_read_b64_tr_b16 v[134:135], v2 offset:1024
    ds_read_b64_tr_b16 v[136:137], v3 offset:0
    ds_read_b64_tr_b16 v[138:139], v3 offset:1024
    ds_read_b64_tr_b16 v[140:141], v4 offset:0
    ds_read_b64_tr_b16 v[142:143], v4 offset:1024
    ds_read_b64_tr_b16 v[144:145], v1 offset:4096
    ds_read_b64_tr_b16 v[146:147], v1 offset:5120
    ds_read_b64_tr_b16 v[148:149], v2 offset:4096
    ds_read_b64_tr_b16 v[150:151], v2 offset:5120
    s_waitcnt lgkmcnt(8)
    ds_read_b64_tr_b16 v[152:153], v3 offset:4096
    ds_read_b64_tr_b16 v[154:155], v3 offset:5120
    ds_read_b64_tr_b16 v[156:157], v4 offset:4096
    ds_read_b64_tr_b16 v[158:159], v4 offset:5120
    s_waitcnt lgkmcnt(0)
    s_add_u32 m0, s45, 0
    s_mov_b32 s46, 0
    buffer_load_dwordx4 v5, s[12:15], s46 offen offset:0 nt lds
    buffer_load_dwordx4 v6, s[12:15], s46 offen offset:1024 nt lds
    buffer_load_dwordx4 v7, s[12:15], s46 offen offset:2048 nt lds
    buffer_load_dwordx4 v8, s[12:15], s46 offen offset:3072 nt lds
    s_add_u32 m0, s45, 4096
    s_mov_b32 s46, 229376
    buffer_load_dwordx4 v5, s[12:15], s46 offen offset:0 nt lds
    buffer_load_dwordx4 v6, s[12:15], s46 offen offset:1024 nt lds
    buffer_load_dwordx4 v7, s[12:15], s46 offen offset:2048 nt lds
    buffer_load_dwordx4 v8, s[12:15], s46 offen offset:3072 nt lds
    s_waitcnt vmcnt(8)
    ds_read_b64_tr_b16 v[160:161], v1 offset:8192
    ds_read_b64_tr_b16 v[162:163], v1 offset:9216
    ds_read_b64_tr_b16 v[164:165], v2 offset:8192
    ds_read_b64_tr_b16 v[166:167], v2 offset:9216
    ds_read_b64_tr_b16 v[168:169], v3 offset:8192
    ds_read_b64_tr_b16 v[170:171], v3 offset:9216
    ds_read_b64_tr_b16 v[172:173], v4 offset:8192
    ds_read_b64_tr_b16 v[174:175], v4 offset:9216
    ds_read_b64_tr_b16 v[176:177], v1 offset:12288
    ds_read_b64_tr_b16 v[178:179], v1 offset:13312
    ds_read_b64_tr_b16 v[180:181], v2 offset:12288
    ds_read_b64_tr_b16 v[182:183], v2 offset:13312
    s_waitcnt lgkmcnt(8)
    ds_read_b64_tr_b16 v[184:185], v3 offset:12288
    ds_read_b64_tr_b16 v[186:187], v3 offset:13312
    ds_read_b64_tr_b16 v[188:189], v4 offset:12288
    ds_read_b64_tr_b16 v[190:191], v4 offset:13312
    s_waitcnt lgkmcnt(0)
    v_add_u32 v15, 147712, v13
    s_cmp_lg_u32 s3, 0
    s_cbranch_scc1 F_np1
    s_mov_b32 m0, 147712
    s_mov_b32 s46, 128
    buffer_load_dword v13, s[24:27], s46 offen sc1 lds
F_np1:
    s_add_u32 m0, s45, 8192
    s_mov_b32 s46, 458752
    buffer_load_dwordx4 v5, s[12:15], s46 offen offset:0 nt lds
    buffer_load_dwordx4 v6, s[12:15], s46 offen offset:1024 nt lds
    buffer_load_dwordx4 v7, s[12:15], s46 offen offset:2048 nt lds
    buffer_load_dwordx4 v8, s[12:15], s46 offen offset:3072 nt lds
    s_add_u32 m0, s45, 12288
    s_mov_b32 s46, 688128
    buffer_load_dwordx4 v5, s[12:15], s46 offen offset:0 nt lds
    buffer_load_dwordx4 v6, s[12:15], s46 offen offset:1024 nt lds
    buffer_load_dwordx4 v7, s[12:15], s46 offen offset:2048 nt lds
    buffer_load_dwordx4 v8, s[12:15], s46 offen offset:3072 nt lds
    s_waitcnt vmcnt(8)
    ds_read_b64_tr_b16 v[192:193], v1 offset:0
    ds_read_b64_tr_b16 v[194:195], v1 offset:1024
    ds_read_b64_tr_b16 v[196:197], v2 offset:0
    ds_read_b64_tr_b16 v[198:199], v2 offset:1024
    ds_read_b64_tr_b16 v[200:201], v3 offset:0
    ds_read_b64_tr_b16 v[202:203], v3 offset:1024
    ds_read_b64_tr_b16 v[204:205], v4 offset:0
    ds_read_b64_tr_b16 v[206:207], v4 offset:1024
    ds_read_b64_tr_b16 v[208:209], v1 offset:4096
    ds_read_b64_tr_b16 v[210:211], v1 offset:5120
    ds_read_b64_tr_b16 v[212:213], v2 offset:4096
    ds_read_b64_tr_b16 v[214:215], v2 offset:5120
    s_waitcnt lgkmcnt(8)
    ds_read_b64_tr_b16 v[216:217], v3 offset:4096
    ds_read_b64_tr_b16 v[218:219], v3 offset:5120
    ds_read_b64_tr_b16 v[220:221], v4 offset:4096
    ds_read_b64_tr_b16 v[222:223], v4 offset:5120
    s_waitcnt lgkmcnt(0)
    s_mov_b32 s47, 0
F_sl1:
    ds_read_b32 v24, v15
    s_waitcnt lgkmcnt(0)
    v_cmp_ne_u32 vcc, 0, v24
    s_nop 0
    s_cmp_eq_u64 vcc, -1
    s_cbranch_scc1 F_sl2
    s_add_u32 s47, s47, 1
    s_cmp_lt_u32 s47, 0x8000
    s_cbranch_scc0 F_sl2
    s_sleep 8
    s_cmp_lg_u32 s3, 0
    s_cbranch_scc1 F_sl1
    s_waitcnt vmcnt(40)
    s_mov_b32 m0, 147712
    s_mov_b32 s46, 128
    buffer_load_dword v13, s[24:27], s46 offen sc1 lds
    s_branch F_sl1
F_sl2:
    v_or_b32 v12, 0x800, v24
    v_add_u32 v15, 147712, v13
    v_and_b32 v25, 0x7ff, v24
    v_sub_u32 v25, 0x7ff, v25
    v_lshrrev_b32 v13, 4, v0
    v_lshlrev_b32 v13, 4, v13
    v_lshl_add_u32 v13, v25, 11, v13
    v_bfe_u32 v14, v0, 3, 1
    v_lshl_add_u32 v13, v14, 7, v13
    s_lshl_b32 s36, s3, 8
    v_lshlrev_b32 v14, 3, v25
    s_mov_b32 s46, 0x4000
    buffer_load_dwordx2 v[6:7], v14, s[20:23], s46 offen sc1
    buffer_load_dwordx4 v[16:19], v13, s[76:79], s36 offen offset:0
    buffer_load_dwordx4 v[20:23], v13, s[76:79], s36 offen offset:64
    s_waitcnt vmcnt(3)
    ds_read_b64_tr_b16 v[224:225], v1 offset:8192
    ds_read_b64_tr_b16 v[226:227], v1 offset:9216
    ds_read_b64_tr_b16 v[228:229], v2 offset:8192
    ds_read_b64_tr_b16 v[230:231], v2 offset:9216
    ds_read_b64_tr_b16 v[232:233], v3 offset:8192
    ds_read_b64_tr_b16 v[234:235], v3 offset:9216
    ds_read_b64_tr_b16 v[236:237], v4 offset:8192
    ds_read_b64_tr_b16 v[238:239], v4 offset:9216
    ds_read_b64_tr_b16 v[240:241], v1 offset:12288
    ds_read_b64_tr_b16 v[242:243], v1 offset:13312
    ds_read_b64_tr_b16 v[244:245], v2 offset:12288
    ds_read_b64_tr_b16 v[246:247], v2 offset:13312
    s_waitcnt lgkmcnt(8)
    ds_read_b64_tr_b16 v[248:249], v3 offset:12288
    ds_read_b64_tr_b16 v[250:251], v3 offset:13312
    ds_read_b64_tr_b16 v[252:253], v4 offset:12288
    ds_read_b64_tr_b16 v[254:255], v4 offset:13312
    s_waitcnt lgkmcnt(0)
    v_lshl_add_u32 v13, v0, 4, s45
    s_and_b32 s36, s3, 3
    s_lshl_b32 s37, s36, 10
    v_lshl_add_u32 v14, v0, 4, s37
    s_lshl_b32 s37, s36, 9
    s_add_u32 s37, s37, 131328
    v_lshl_add_u32 v8, v0, 3, s37
    v_and_b32 v9, 0x37, v0
    v_lshlrev_b32 v9, 3, v9
    v_add_u32 v9, 131328, v9
    v_and_b32 v10, 7, v0
    v_lshlrev_b32 v10, 12, v10
    v_bfe_u32 v11, v0, 3, 1
    v_lshl_add_u32 v10, v11, 6, v10
    v_lshrrev_b32 v11, 4, v0
    v_lshl_add_u32 v10, v11, 4, v10
    s_lshl_b32 s36, s30, 15
    s_lshl_b32 s37, s3, 9
    s_add_u32 s36, s36, s37
    s_add_u32 s36, s36, 0x600000
    v_add_u32 v10, s36, v10
    s_mov_b32 s50, 0xff00ff00
    s_mov_b32 s51, 0xff00ff00
    s_waitcnt vmcnt(1)
    v_mov_b32 v4, v7
    v_mov_b32 v5, v7
    v_mov_b32 v7, v6
    v_lshlrev_b32 v24, 16, v16
    v_and_b32 v25, s39, v16
    v_lshlrev_b32 v26, 16, v17
    v_and_b32 v27, s39, v17
    v_lshlrev_b32 v28, 16, v18
    v_and_b32 v29, s39, v18
    v_lshlrev_b32 v30, 16, v19
    v_and_b32 v31, s39, v19
    v_pk_add_f32 v[24:25], v[24:25], v[6:7] neg_lo:[0,1] neg_hi:[0,1]
    v_pk_add_f32 v[26:27], v[26:27], v[6:7] neg_lo:[0,1] neg_hi:[0,1]
    v_pk_add_f32 v[28:29], v[28:29], v[6:7] neg_lo:[0,1] neg_hi:[0,1]
    v_pk_add_f32 v[30:31], v[30:31], v[6:7] neg_lo:[0,1] neg_hi:[0,1]
    v_cvt_pk_bf16_f32 v16, v24, v25
    v_cvt_pk_bf16_f32 v17, v26, v27
    v_cvt_pk_bf16_f32 v18, v28, v29
    v_cvt_pk_bf16_f32 v19, v30, v31
    v_lshlrev_b32 v24, 16, v16
    v_and_b32 v25, s39, v16
    v_lshlrev_b32 v26, 16, v17
    v_and_b32 v27, s39, v17
    v_lshlrev_b32 v28, 16, v18
    v_and_b32 v29, s39, v18
    v_lshlrev_b32 v30, 16, v19
    v_and_b32 v31, s39, v19
    v_pk_mul_f32 v[24:25], v[24:25], v[4:5]
    v_pk_mul_f32 v[26:27], v[26:27], v[4:5]
    v_pk_mul_f32 v[28:29], v[28:29], v[4:5]
    v_pk_mul_f32 v[30:31], v[30:31], v[4:5]
    v_cvt_pk_bf16_f32 v16, v24, v25
    v_cvt_pk_bf16_f32 v17, v26, v27
    v_cvt_pk_bf16_f32 v18, v28, v29
    v_cvt_pk_bf16_f32 v19, v30, v31
    s_nop 1
    v_mfma_f32_16x16x32_bf16 v[32:35], v[128:131], v[16:19], 0
    v_mfma_f32_16x16x32_bf16 v[36:39], v[132:135], v[16:19], 0
    v_mfma_f32_16x16x32_bf16 v[40:43], v[136:139], v[16:19], 0
    v_mfma_f32_16x16x32_bf16 v[44:47], v[140:143], v[16:19], 0
    v_mfma_f32_16x16x32_bf16 v[48:51], v[192:195], v[16:19], 0
    v_mfma_f32_16x16x32_bf16 v[52:55], v[196:199], v[16:19], 0
    v_mfma_f32_16x16x32_bf16 v[56:59], v[200:203], v[16:19], 0
    v_mfma_f32_16x16x32_bf16 v[60:63], v[204:207], v[16:19], 0
    s_waitcnt vmcnt(0)
    v_lshlrev_b32 v24, 16, v20
    v_and_b32 v25, s39, v20
    v_lshlrev_b32 v26, 16, v21
    v_and_b32 v27, s39, v21
    v_lshlrev_b32 v28, 16, v22
    v_and_b32 v29, s39, v22
    v_lshlrev_b32 v30, 16, v23
    v_and_b32 v31, s39, v23
    v_pk_add_f32 v[24:25], v[24:25], v[6:7] neg_lo:[0,1] neg_hi:[0,1]
    v_pk_add_f32 v[26:27], v[26:27], v[6:7] neg_lo:[0,1] neg_hi:[0,1]
    v_pk_add_f32 v[28:29], v[28:29], v[6:7] neg_lo:[0,1] neg_hi:[0,1]
    v_pk_add_f32 v[30:31], v[30:31], v[6:7] neg_lo:[0,1] neg_hi:[0,1]
    v_cvt_pk_bf16_f32 v20, v24, v25
    v_cvt_pk_bf16_f32 v21, v26, v27
    v_cvt_pk_bf16_f32 v22, v28, v29
    v_cvt_pk_bf16_f32 v23, v30, v31
    v_lshlrev_b32 v24, 16, v20
    v_and_b32 v25, s39, v20
    v_lshlrev_b32 v26, 16, v21
    v_and_b32 v27, s39, v21
    v_lshlrev_b32 v28, 16, v22
    v_and_b32 v29, s39, v22
    v_lshlrev_b32 v30, 16, v23
    v_and_b32 v31, s39, v23
    v_pk_mul_f32 v[24:25], v[24:25], v[4:5]
    v_pk_mul_f32 v[26:27], v[26:27], v[4:5]
    v_pk_mul_f32 v[28:29], v[28:29], v[4:5]
    v_pk_mul_f32 v[30:31], v[30:31], v[4:5]
    v_cvt_pk_bf16_f32 v20, v24, v25
    v_cvt_pk_bf16_f32 v21, v26, v27
    v_cvt_pk_bf16_f32 v22, v28, v29
    v_cvt_pk_bf16_f32 v23, v30, v31
    v_mov_b32_dpp v24, v16 row_ror:8 row_mask:0xf bank_mask:0xf
    v_mov_b32_dpp v25, v17 row_ror:8 row_mask:0xf bank_mask:0xf
    v_mov_b32_dpp v26, v18 row_ror:8 row_mask:0xf bank_mask:0xf
    v_mov_b32_dpp v27, v19 row_ror:8 row_mask:0xf bank_mask:0xf
    v_mov_b32_dpp v28, v20 row_ror:8 row_mask:0xf bank_mask:0xf
    v_mov_b32_dpp v29, v21 row_ror:8 row_mask:0xf bank_mask:0xf
    v_mov_b32_dpp v30, v22 row_ror:8 row_mask:0xf bank_mask:0xf
    v_mov_b32_dpp v31, v23 row_ror:8 row_mask:0xf bank_mask:0xf
    v_mfma_f32_16x16x32_bf16 v[32:35], v[144:147], v[20:23], v[32:35]
    v_mfma_f32_16x16x32_bf16 v[36:39], v[148:151], v[20:23], v[36:39]
    v_mfma_f32_16x16x32_bf16 v[40:43], v[152:155], v[20:23], v[40:43]
    v_mfma_f32_16x16x32_bf16 v[44:47], v[156:159], v[20:23], v[44:47]
    v_mfma_f32_16x16x32_bf16 v[48:51], v[208:211], v[20:23], v[48:51]
    v_mfma_f32_16x16x32_bf16 v[52:55], v[212:215], v[20:23], v[52:55]
    v_mfma_f32_16x16x32_bf16 v[56:59], v[216:219], v[20:23], v[56:59]
    v_mfma_f32_16x16x32_bf16 v[60:63], v[220:223], v[20:23], v[60:63]
    v_mfma_f32_16x16x32_bf16 v[32:35], v[160:163], v[24:27], v[32:35]
    v_mfma_f32_16x16x32_bf16 v[36:39], v[164:167], v[24:27], v[36:39]
    v_mfma_f32_16x16x32_bf16 v[40:43], v[168:171], v[24:27], v[40:43]
    v_mfma_f32_16x16x32_bf16 v[44:47], v[172:175], v[24:27], v[44:47]
    v_mfma_f32_16x16x32_bf16 v[48:51], v[224:227], v[24:27], v[48:51]
    v_mfma_f32_16x16x32_bf16 v[52:55], v[228:231], v[24:27], v[52:55]
    v_mfma_f32_16x16x32_bf16 v[56:59], v[232:235], v[24:27], v[56:59]
    v_mfma_f32_16x16x32_bf16 v[60:63], v[236:239], v[24:27], v[60:63]
    v_mfma_f32_16x16x32_bf16 v[32:35], v[176:179], v[28:31], v[32:35]
    v_mfma_f32_16x16x32_bf16 v[36:39], v[180:183], v[28:31], v[36:39]
    v_mfma_f32_16x16x32_bf16 v[40:43], v[184:187], v[28:31], v[40:43]
    v_mfma_f32_16x16x32_bf16 v[44:47], v[188:191], v[28:31], v[44:47]
    v_mfma_f32_16x16x32_bf16 v[48:51], v[240:243], v[28:31], v[48:51]
    v_mfma_f32_16x16x32_bf16 v[52:55], v[244:247], v[28:31], v[52:55]
    v_mfma_f32_16x16x32_bf16 v[56:59], v[248:251], v[28:31], v[56:59]
    v_mfma_f32_16x16x32_bf16 v[60:63], v[252:255], v[28:31], v[60:63]
    ds_write_b32 v15, v12
    ds_write_b128 v13, v[32:35] offset:0
    ds_write_b128 v13, v[36:39] offset:1024
    ds_write_b128 v13, v[40:43] offset:2048
    ds_write_b128 v13, v[44:47] offset:3072
    ds_write_b128 v13, v[48:51] offset:4096
    ds_write_b128 v13, v[52:55] offset:5120
    ds_write_b128 v13, v[56:59] offset:6144
    ds_write_b128 v13, v[60:63] offset:7168
    s_waitcnt lgkmcnt(0)
    s_barrier
    s_lshl_b32 s56, s30, 7
    s_add_u32 s56, s56, 0x16000
    s_mov_b32 s59, 0
    s_cmp_ge_u32 s3, 4
    s_cbranch_scc1 F_nored
    v_add_u32 v15, 0x10000, v14
    ds_read_b128 v[128:131], v14 offset:0
    ds_read_b128 v[132:135], v14 offset:16384
    ds_read_b128 v[136:139], v14 offset:32768
    ds_read_b128 v[140:143], v14 offset:49152
    ds_read_b128 v[144:147], v15 offset:0
    ds_read_b128 v[148:151], v15 offset:16384
    ds_read_b128 v[152:155], v15 offset:32768
    ds_read_b128 v[156:159], v15 offset:49152
    s_waitcnt lgkmcnt(4)
    ds_read_b128 v[160:163], v14 offset:4096
    ds_read_b128 v[164:167], v14 offset:20480
    ds_read_b128 v[168:171], v14 offset:36864
    ds_read_b128 v[172:175], v14 offset:53248
    ds_read_b128 v[176:179], v15 offset:4096
    ds_read_b128 v[180:183], v15 offset:20480
    ds_read_b128 v[184:187], v15 offset:36864
    ds_read_b128 v[188:191], v15 offset:53248
    s_waitcnt lgkmcnt(8)
    v_pk_add_f32 v[128:129], v[128:129], v[144:145]
    v_pk_add_f32 v[130:131], v[130:131], v[146:147]
    v_pk_add_f32 v[132:133], v[132:133], v[148:149]
    v_pk_add_f32 v[134:135], v[134:135], v[150:151]
    v_pk_add_f32 v[136:137], v[136:137], v[152:153]
    v_pk_add_f32 v[138:139], v[138:139], v[154:155]
    v_pk_add_f32 v[140:141], v[140:141], v[156:157]
    v_pk_add_f32 v[142:143], v[142:143], v[158:159]
    v_pk_add_f32 v[128:129], v[128:129], v[136:137]
    v_pk_add_f32 v[130:131], v[130:131], v[138:139]
    v_pk_add_f32 v[132:133], v[132:133], v[140:141]
    v_pk_add_f32 v[134:135], v[134:135], v[142:143]
    v_pk_add_f32 v[128:129], v[128:129], v[132:133]
    v_pk_add_f32 v[130:131], v[130:131], v[134:135]
    s_waitcnt lgkmcnt(0)
    v_pk_add_f32 v[160:161], v[160:161], v[176:177]
    v_pk_add_f32 v[162:163], v[162:163], v[178:179]
    v_pk_add_f32 v[164:165], v[164:165], v[180:181]
    v_pk_add_f32 v[166:167], v[166:167], v[182:183]
    v_pk_add_f32 v[168:169], v[168:169], v[184:185]
    v_pk_add_f32 v[170:171], v[170:171], v[186:187]
    v_pk_add_f32 v[172:173], v[172:173], v[188:189]
    v_pk_add_f32 v[174:175], v[174:175], v[190:191]
    v_pk_add_f32 v[160:161], v[160:161], v[168:169]
    v_pk_add_f32 v[162:163], v[162:163], v[170:171]
    v_pk_add_f32 v[164:165], v[164:165], v[172:173]
    v_pk_add_f32 v[166:167], v[166:167], v[174:175]
    v_pk_add_f32 v[160:161], v[160:161], v[164:165]
    v_pk_add_f32 v[162:163], v[162:163], v[166:167]
    v_cvt_pk_bf16_f32 v136, v128, v129
    v_cvt_pk_bf16_f32 v137, v130, v131
    v_lshlrev_b32 v128, 16, v136
    v_and_b32 v129, s39, v136
    v_lshlrev_b32 v130, 16, v137
    v_and_b32 v131, s39, v137
    v_cvt_pk_bf16_f32 v168, v160, v161
    v_cvt_pk_bf16_f32 v169, v162, v163
    v_lshlrev_b32 v160, 16, v168
    v_and_b32 v161, s39, v168
    v_lshlrev_b32 v162, 16, v169
    v_and_b32 v163, s39, v169
    v_mul_f32 v132, 0xbfb8aa3b, v128
    v_mul_f32 v133, 0xbfb8aa3b, v129
    v_mul_f32 v134, 0xbfb8aa3b, v130
    v_mul_f32 v135, 0xbfb8aa3b, v131
    v_exp_f32 v132, v132
    v_exp_f32 v133, v133
    v_exp_f32 v134, v134
    v_exp_f32 v135, v135
    v_add_f32 v132, 1.0, v132
    v_add_f32 v133, 1.0, v133
    v_add_f32 v134, 1.0, v134
    v_add_f32 v135, 1.0, v135
    v_rcp_f32 v132, v132
    v_rcp_f32 v133, v133
    v_rcp_f32 v134, v134
    v_rcp_f32 v135, v135
    v_mul_f32 v128, v128, v132
    v_mul_f32 v129, v129, v133
    v_mul_f32 v130, v130, v134
    v_mul_f32 v131, v131, v135
    v_cvt_pk_bf16_f32 v136, v128, v129
    v_cvt_pk_bf16_f32 v137, v130, v131
    v_lshlrev_b32 v128, 16, v136
    v_and_b32 v129, s39, v136
    v_lshlrev_b32 v130, 16, v137
    v_and_b32 v131, s39, v137
    v_pk_mul_f32 v[128:129], v[128:129], v[160:161]
    v_pk_mul_f32 v[130:131], v[130:131], v[162:163]
    v_cvt_pk_bf16_f32 v136, v128, v129
    v_cvt_pk_bf16_f32 v137, v130, v131
    ds_write_b64 v8, v[136:137]
    s_waitcnt lgkmcnt(0)
    s_branch F_hb
F_nored:
    s_sub_u32 s3, s3, 4
    s_mov_b32 s59, 1
    s_and_b32 s30, s28, 1
    s_lshl_b32 s30, s30, 3
    s_and_b32 s31, s28, 2
    s_lshl_b32 s31, s31, 1
    s_add_u32 s30, s30, s31
    s_lshr_b32 s31, s29, 3
    s_add_u32 s30, s30, s31
    s_and_b32 s34, s29, 7
    s_add_u32 s32, s28, 3
    s_and_b32 s32, s32, 7
    s_cmp_eq_u32 s29, 27
    s_cselect_b32 s34, s32, s34
    s_add_u32 s32, s32, 24
    s_cmp_eq_u32 s29, s32
    s_cselect_b32 s34, 3, s34
    s_and_b32 s32, s28, 4
    s_lshl_b32 s32, s32, 1
    s_add_u32 s32, s32, s34
    s_mov_b32 s8, s4
    s_mov_b32 s9, s5
    s_mov_b32 s10, 0x400000
    s_mov_b32 s11, 0x20000
    s_mov_b32 s16, s86
    s_mov_b32 s17, s87
    s_mov_b32 s18, 0x400000
    s_mov_b32 s19, 0x20000
    s_mov_b32 s20, s74
    s_mov_b32 s21, s75
    s_mov_b32 s22, 0x1000000
    s_mov_b32 s23, 0x20000
    s_lshl_b32 s35, s30, 7
    s_lshl_b32 s36, s3, 5
    s_add_u32 s35, s35, s36
    v_and_b32 v14, 15, v0
    v_add_u32 v14, s35, v14
    v_lshlrev_b32 v7, 3, v14
    v_add_u32 v7, 0x4000, v7
    v_lshlrev_b32 v6, 11, v14
    v_bfe_u32 v15, v0, 4, 1
    v_lshl_add_u32 v6, v15, 5, v6
    v_lshrrev_b32 v15, 5, v0
    v_lshl_add_u32 v6, v15, 4, v6
    s_lshl_b32 s36, s32, 7
    v_add_u32 v6, s36, v6
    s_lshl_b32 s36, s35, 11
    s_add_u32 s36, s36, 0x100000
    v_lshl_add_u32 v4, v0, 4, s36
    v_add_u32 v5, 0x8000, v4
    s_mov_b32 s37, 0x8000
    buffer_load_dwordx2 v[216:217], v7, s[20:23], 0 offen offset:0 sc1
    buffer_load_dwordx4 v[200:203], v6, s[8:11], 0 offen offset:0
    buffer_load_dwordx4 v[204:207], v6, s[8:11], 0 offen offset:64
    buffer_load_dwordx2 v[218:219], v7, s[20:23], 0 offen offset:128 sc1
    buffer_load_dwordx4 v[208:211], v6, s[8:11], s37 offen offset:0
    buffer_load_dwordx4 v[212:215], v6, s[8:11], s37 offen offset:64
    s_mov_b32 s36, 2048
    v_lshrrev_b32 v14, 3, v0
    v_and_b32 v15, 6, v14
    v_and_b32 v220, 7, v0
    v_xor_b32 v220, v220, v15
    v_lshlrev_b32 v220, 4, v220
    v_mul_lo_u32 v14, v14, s36
    v_add_u32 v220, v220, v14
    s_lshl_b32 s36, s32, 7
    v_add_u32 v220, s36, v220
    v_add_u32 v221, 15360, v220
    v_add_u32 v222, 30720, v220
    v_add_u32 v223, 46080, v220
    s_mov_b32 s12, s84
    s_mov_b32 s13, s85
    s_mov_b32 s14, 0x200000
    s_mov_b32 s15, 0x20000
F_hb:
    s_barrier
F_hb2:
    ds_read_b64 v[16:17], v9 offset:0
    ds_read_b64 v[18:19], v9 offset:512
    ds_read_b64 v[20:21], v9 offset:1024
    ds_read_b64 v[22:23], v9 offset:1536
    s_waitcnt lgkmcnt(0)
    v_mfma_f32_16x16x32_bf16 v[32:35], v[64:67], v[16:19], 0
    v_mfma_f32_16x16x32_bf16 v[36:39], v[68:71], v[16:19], 0
    v_mfma_f32_16x16x32_bf16 v[40:43], v[72:75], v[16:19], 0
    v_mfma_f32_16x16x32_bf16 v[44:47], v[76:79], v[16:19], 0
    v_mfma_f32_16x16x32_bf16 v[48:51], v[80:83], v[16:19], 0
    v_mfma_f32_16x16x32_bf16 v[52:55], v[84:87], v[16:19], 0
    v_mfma_f32_16x16x32_bf16 v[56:59], v[88:91], v[16:19], 0
    v_mfma_f32_16x16x32_bf16 v[60:63], v[92:95], v[16:19], 0
    v_mfma_f32_16x16x32_bf16 v[32:35], v[96:99], v[20:23], v[32:35]
    v_mfma_f32_16x16x32_bf16 v[36:39], v[100:103], v[20:23], v[36:39]
    v_mfma_f32_16x16x32_bf16 v[40:43], v[104:107], v[20:23], v[40:43]
    v_mfma_f32_16x16x32_bf16 v[44:47], v[108:111], v[20:23], v[44:47]
    v_mfma_f32_16x16x32_bf16 v[48:51], v[112:115], v[20:23], v[48:51]
    v_mfma_f32_16x16x32_bf16 v[52:55], v[116:119], v[20:23], v[52:55]
    v_mfma_f32_16x16x32_bf16 v[56:59], v[120:123], v[20:23], v[56:59]
    v_mfma_f32_16x16x32_bf16 v[60:63], v[124:127], v[20:23], v[60:63]
    s_nop 1
    v_cndmask_b32 v32, v32, v36, s[50:51]
    v_cndmask_b32 v33, v33, v37, s[50:51]
    v_cndmask_b32 v34, v34, v38, s[50:51]
    v_cndmask_b32 v35, v35, v39, s[50:51]
    buffer_store_dwordx4 v[32:35], v10, s[20:23], 0 offen offset:0 sc1
    v_cndmask_b32 v40, v40, v44, s[50:51]
    v_cndmask_b32 v41, v41, v45, s[50:51]
    v_cndmask_b32 v42, v42, v46, s[50:51]
    v_cndmask_b32 v43, v43, v47, s[50:51]
    buffer_store_dwordx4 v[40:43], v10, s[20:23], 0 offen offset:128 sc1
    v_cndmask_b32 v48, v48, v52, s[50:51]
    v_cndmask_b32 v49, v49, v53, s[50:51]
    v_cndmask_b32 v50, v50, v54, s[50:51]
    v_cndmask_b32 v51, v51, v55, s[50:51]
    buffer_store_dwordx4 v[48:51], v10, s[20:23], 0 offen offset:256 sc1
    v_cndmask_b32 v56, v56, v60, s[50:51]
    v_cndmask_b32 v57, v57, v61, s[50:51]
    v_cndmask_b32 v58, v58, v62, s[50:51]
    v_cndmask_b32 v59, v59, v63, s[50:51]
    buffer_store_dwordx4 v[56:59], v10, s[20:23], 0 offen offset:384 sc1
    v_mov_b32 v1, 147456
    s_cmp_lg_u32 s59, 0
    s_cbranch_scc1 F_p2d
F_mlo:
    v_mov_b32 v2, s56
    v_mov_b32 v3, 1
    s_waitcnt vmcnt(0)
    s_barrier
    s_cmp_lg_u32 s3, 0
    s_cbranch_scc1 F_help2
    s_mov_b64 exec, 1
    buffer_store_dword v3, v2, s[20:23], 0 offen sc1
    s_mov_b64 exec, -1
    s_branch F_help2
F_spare:
    v_add_u32 v29, 147712, v13
    v_mov_b32 v28, v13
    s_cmp_eq_u32 s2, 252
    s_cbranch_scc1 F_top8
    s_cmp_lg_u32 s3, 0
    s_cbranch_scc1 F_sdone
    s_mov_b32 s47, 0
F_pl_39:
    buffer_load_dword v24, v13, s[24:27], 0 offen offset:128 sc1
    s_waitcnt vmcnt(0)
F_pc_40:
    v_cmp_ne_u32 vcc, 0, v24
    s_nop 0
    s_cmp_eq_u64 vcc, -1
    s_cbranch_scc1 F_pd_41
    s_add_u32 s47, s47, 1
    s_cmp_lt_u32 s47, 0x8000
    s_cbranch_scc0 F_pd_41
    s_sleep 32
    s_branch F_pl_39
F_pd_41:
    s_branch F_swr
F_top8:
    v_and_b32 v13, 31, v0
    v_lshlrev_b32 v13, 2, v13
    s_mov_b32 s48, 0x10001
    s_lshl_b32 s36, s3, 10
    v_lshl_add_u32 v14, v0, 4, s36
    s_lshl_b32 s36, s3, 5
    v_add_u32 v26, s36, v28
    v_add_u32 v26, 131072, v26
    v_lshlrev_b32 v27, 2, v0
    v_add_u32 v27, 131072, v27
    v_mov_b32 v30, 0
    ds_write_b32 v27, v30 offset:1024
    ds_write_b32 v27, v30 offset:1536
    v_lshrrev_b32 v30, 4, v0
    s_lshl_b32 s36, s3, 2
    v_add_u32 v30, s36, v30
    v_lshlrev_b32 v30, 2, v30
    v_add_u32 v30, 131584, v30
    v_add_u32 v31, 131584, v13
    v_lshrrev_b32 v32, 5, v0
    v_lshlrev_b32 v32, 6, v32
    v_add_u32 v32, 131584, v32
    v_mov_b32 v33, 132096
    v_mov_b32 v34, 1
    s_waitcnt lgkmcnt(0)
    s_cmp_lg_u32 s3, 0
    s_cbranch_scc1 F_spd
    v_lshlrev_b32 v35, 7, v0
    v_add_u32 v35, 0x18000, v35
    s_mov_b32 s47, 0
F_pl_42:
    buffer_load_dword v15, v35, s[20:23], 0 offen sc1
    s_waitcnt vmcnt(0)
F_pc_43:
    v_cmp_ne_u32 vcc, 0, v15
    s_nop 0
    s_cmp_eq_u64 vcc, -1
    s_cbranch_scc1 F_pd_44
    s_add_u32 s47, s47, 1
    s_cmp_lt_u32 s47, 0x8000
    s_cbranch_scc0 F_pd_44
    s_sleep 4
    s_branch F_pl_42
F_pd_44:
F_spd:
    s_barrier
    buffer_load_dwordx4 v[16:19], v14, s[20:23], 0 offen sc1
    s_mov_b32 s48, 0
    s_waitcnt vmcnt(0)
    v_max3_u32 v20, v16, v17, v18
    v_max_u32 v20, v20, v19
    s_nop 1
    v_max_u32_dpp v20, v20, v20 quad_perm:[1,0,3,2] row_mask:0xf bank_mask:0xf
    s_nop 1
    v_max_u32_dpp v20, v20, v20 quad_perm:[2,3,0,1] row_mask:0xf bank_mask:0xf
    s_nop 1
    v_max_u32_dpp v20, v20, v20 row_half_mirror row_mask:0xf bank_mask:0xf
    s_nop 1
    v_max_u32_dpp v20, v20, v20 row_mirror row_mask:0xf bank_mask:0xf
    ds_write_b32 v30, v20
    v_mov_b32 v21, 0
    s_waitcnt lgkmcnt(0)
    s_barrier
    ds_read_b32 v20, v31
    ds_read_b128 v[40:43], v32 offset:0
    ds_read_b128 v[44:47], v32 offset:16
    ds_read_b128 v[48:51], v32 offset:32
    ds_read_b128 v[52:55], v32 offset:48
    s_waitcnt lgkmcnt(0)
    v_cmp_gt_u32 s[52:53], v40, v20
    v_cmp_gt_u32 s[54:55], v41, v20
    v_cmp_gt_u32 s[56:57], v42, v20
    v_cmp_gt_u32 s[58:59], v43, v20
    v_addc_co_u32 v21, vcc, 0, v21, s[52:53]
    v_addc_co_u32 v21, vcc, 0, v21, s[54:55]
    v_addc_co_u32 v21, vcc, 0, v21, s[56:57]
    v_addc_co_u32 v21, vcc, 0, v21, s[58:59]
    v_cmp_gt_u32 s[52:53], v44, v20
    v_cmp_gt_u32 s[54:55], v45, v20
    v_cmp_gt_u32 s[56:57], v46, v20
    v_cmp_gt_u32 s[58:59], v47, v20
    v_addc_co_u32 v21, vcc, 0, v21, s[52:53]
    v_addc_co_u32 v21, vcc, 0, v21, s[54:55]
    v_addc_co_u32 v21, vcc, 0, v21, s[56:57]
    v_addc_co_u32 v21, vcc, 0, v21, s[58:59]
    v_cmp_gt_u32 s[52:53], v48, v20
    v_cmp_gt_u32 s[54:55], v49, v20
    v_cmp_gt_u32 s[56:57], v50, v20
    v_cmp_gt_u32 s[58:59], v51, v20
    v_addc_co_u32 v21, vcc, 0, v21, s[52:53]
    v_addc_co_u32 v21, vcc, 0, v21, s[54:55]
    v_addc_co_u32 v21, vcc, 0, v21, s[56:57]
    v_addc_co_u32 v21, vcc, 0, v21, s[58:59]
    v_cmp_gt_u32 s[52:53], v52, v20
    v_cmp_gt_u32 s[54:55], v53, v20
    v_cmp_gt_u32 s[56:57], v54, v20
    v_cmp_gt_u32 s[58:59], v55, v20
    v_addc_co_u32 v21, vcc, 0, v21, s[52:53]
    v_addc_co_u32 v21, vcc, 0, v21, s[54:55]
    v_addc_co_u32 v21, vcc, 0, v21, s[56:57]
    v_addc_co_u32 v21, vcc, 0, v21, s[58:59]
    v_mov_b32 v22, v21
    s_nop 1
    v_permlane32_swap_b32 v21, v22
    v_add_u32 v21, v21, v22
    v_cmp_eq_u32 vcc, 7, v21
    s_nop 0
    s_ff1_i32_b64 s46, vcc
    v_readlane_b32 s46, v20, s46
    s_nop 1
    v_cmp_le_u32 s[52:53], s46, v16
    v_cmp_le_u32 s[54:55], s46, v17
    v_cmp_le_u32 s[56:57], s46, v18
    v_cmp_le_u32 s[58:59], s46, v19
    s_mov_b64 exec, s[52:53]
    ds_add_rtn_u32 v20, v33, v34 offset:512
    s_mov_b64 exec, s[54:55]
    ds_add_rtn_u32 v21, v33, v34 offset:512
    s_mov_b64 exec, s[56:57]
    ds_add_rtn_u32 v22, v33, v34 offset:512
    s_mov_b64 exec, s[58:59]
    ds_add_rtn_u32 v23, v33, v34 offset:512
    s_mov_b64 exec, -1
    s_waitcnt lgkmcnt(0)
    v_min_u32 v20, 64, v20
    v_lshl_add_u32 v20, v20, 2, v33
    v_min_u32 v21, 64, v21
    v_lshl_add_u32 v21, v21, 2, v33
    v_min_u32 v22, 64, v22
    v_lshl_add_u32 v22, v22, 2, v33
    v_min_u32 v23, 64, v23
    v_lshl_add_u32 v23, v23, 2, v33
    s_mov_b64 exec, s[52:53]
    ds_write_b32 v20, v16
    s_mov_b64 exec, s[54:55]
    ds_write_b32 v21, v17
    s_mov_b64 exec, s[56:57]
    ds_write_b32 v22, v18
    s_mov_b64 exec, s[58:59]
    ds_write_b32 v23, v19
    s_mov_b64 exec, -1
    s_waitcnt lgkmcnt(0)
    s_barrier
    ds_read_b32 v21, v33 offset:512
    ds_read_b32 v24, v27 offset:1024
    ds_read_b128 v[40:43], v33 offset:0
    ds_read_b128 v[44:47], v33 offset:16
    ds_read_b128 v[48:51], v33 offset:32
    ds_read_b128 v[52:55], v33 offset:48
    s_waitcnt lgkmcnt(0)
    v_readfirstlane_b32 s47, v21
    v_mov_b32 v21, 0
    s_cmp_gt_u32 s47, 64
    s_cbranch_scc1 F_lv
    s_cmp_lg_u32 s3, 0
    s_cbranch_scc1 F_sd255
    s_mov_b32 s46, 16
F_rk:
    v_cmp_gt_u32 s[52:53], v40, v24
    v_cmp_gt_u32 s[54:55], v41, v24
    v_cmp_gt_u32 s[56:57], v42, v24
    v_cmp_gt_u32 s[58:59], v43, v24
    v_addc_co_u32 v21, vcc, 0, v21, s[52:53]
    v_addc_co_u32 v21, vcc, 0, v21, s[54:55]
    v_addc_co_u32 v21, vcc, 0, v21, s[56:57]
    v_addc_co_u32 v21, vcc, 0, v21, s[58:59]
    v_cmp_gt_u32 s[52:53], v44, v24
    v_cmp_gt_u32 s[54:55], v45, v24
    v_cmp_gt_u32 s[56:57], v46, v24
    v_cmp_gt_u32 s[58:59], v47, v24
    v_addc_co_u32 v21, vcc, 0, v21, s[52:53]
    v_addc_co_u32 v21, vcc, 0, v21, s[54:55]
    v_addc_co_u32 v21, vcc, 0, v21, s[56:57]
    v_addc_co_u32 v21, vcc, 0, v21, s[58:59]
    v_cmp_gt_u32 s[52:53], v48, v24
    v_cmp_gt_u32 s[54:55], v49, v24
    v_cmp_gt_u32 s[56:57], v50, v24
    v_cmp_gt_u32 s[58:59], v51, v24
    v_addc_co_u32 v21, vcc, 0, v21, s[52:53]
    v_addc_co_u32 v21, vcc, 0, v21, s[54:55]
    v_addc_co_u32 v21, vcc, 0, v21, s[56:57]
    v_addc_co_u32 v21, vcc, 0, v21, s[58:59]
    v_cmp_gt_u32 s[52:53], v52, v24
    v_cmp_gt_u32 s[54:55], v53, v24
    v_cmp_gt_u32 s[56:57], v54, v24
    v_cmp_gt_u32 s[58:59], v55, v24
    v_addc_co_u32 v21, vcc, 0, v21, s[52:53]
    v_addc_co_u32 v21, vcc, 0, v21, s[54:55]
    v_addc_co_u32 v21, vcc, 0, v21, s[56:57]
    v_addc_co_u32 v21, vcc, 0, v21, s[58:59]
    s_cmp_ge_u32 s46, s47
    s_cbranch_scc1 F_rkd
    v_add_u32 v33, 64, v33
    s_add_u32 s46, s46, 16
    ds_read_b128 v[40:43], v33 offset:0
    ds_read_b128 v[44:47], v33 offset:16
    ds_read_b128 v[48:51], v33 offset:32
    ds_read_b128 v[52:55], v33 offset:48
    s_waitcnt lgkmcnt(0)
    s_branch F_rk
F_rkd:
    v_cmp_gt_u32 vcc, 8, v21
    v_cmp_gt_u32 s[52:53], s47, v0
    v_lshlrev_b32 v28, 2, v21
    v_or_b32 v24, 0x800, v24
    v_add_u32 v29, 147712, v28
    s_and_b64 exec, vcc, s[52:53]
    s_branch F_tst
F_lv:
    s_mov_b32 s46, 0
    s_mov_b32 s50, 0x01010101
    s_mov_b32 s51, 0x01010101
    s_mov_b32 s47, 0
F_rd:
    v_subrev_u32 v20, s46, v16
    v_subrev_u32 v21, s46, v17
    v_subrev_u32 v22, s46, v18
    v_subrev_u32 v23, s46, v19
    v_max3_u32 v20, v20, v21, v22
    v_max_u32 v20, v20, v23
    s_nop 1
    v_max_u32_dpp v20, v20, v20 quad_perm:[1,0,3,2] row_mask:0xf bank_mask:0xf
    s_nop 1
    v_max_u32_dpp v20, v20, v20 quad_perm:[2,3,0,1] row_mask:0xf bank_mask:0xf
    s_nop 1
    v_max_u32_dpp v20, v20, v20 row_half_mirror row_mask:0xf bank_mask:0xf
    s_nop 1
    v_max_u32_dpp v20, v20, v20 row_mirror row_mask:0xf bank_mask:0xf
    s_nop 0
    v_readlane_b32 s52, v20, 0
    v_readlane_b32 s53, v20, 16
    v_readlane_b32 s54, v20, 32
    v_readlane_b32 s55, v20, 48
    s_max_u32 s52, s52, s53
    s_max_u32 s54, s54, s55
    s_max_u32 s52, s52, s54
    s_add_u32 s46, s46, s52
    s_mov_b64 exec, s[50:51]
    v_mov_b32 v24, s46
    s_mov_b64 exec, -1
    s_lshl_b64 s[50:51], s[50:51], 1
    s_add_u32 s47, s47, 1
    s_cmp_lt_u32 s47, 8
    s_cbranch_scc1 F_rd
    s_cmp_lg_u32 s48, 0
    s_cbranch_scc1 F_td
    ds_write_b32 v26, v24
    s_waitcnt lgkmcnt(0)
    s_barrier
    s_cmp_lg_u32 s3, 0
    s_cbranch_scc1 F_sd255
    ds_read_b32 v16, v27
    s_mov_b32 s48, 1
    s_waitcnt lgkmcnt(0)
    v_mov_b32 v17, v16
    v_mov_b32 v18, v16
    v_mov_b32 v19, v16
    s_branch F_lv
F_td:
    v_or_b32 v24, 0x800, v24
    s_mov_b64 exec, 0xff
F_tst:
    buffer_store_dword v24, v28, s[24:27], 0 offen offset:128 sc1
    s_waitcnt vmcnt(0)
    s_barrier
F_swr:
    ds_write_b32 v29, v24
    s_mov_b64 exec, 1
    v_mov_b32 v1, 147456
    v_mov_b32 v24, 0x800
    ds_or_b32 v1, v24 offset:256
    s_mov_b64 exec, -1
    s_waitcnt lgkmcnt(0)
    s_branch F_sbar
F_sd255:
    s_barrier
F_sdone:
    v_mov_b32 v1, 147456
    s_mov_b32 s59, 2
    s_cmp_ge_u32 s3, 4
    s_cbranch_scc1 F_p2
    s_cmp_eq_u32 s2, 252
    s_mov_b32 s36, 63
    s_cselect_b32 s36, 77, s36
    s_add_u32 s36, s3, s36
F_st1:
    s_mov_b32 s80, s6
    s_mov_b32 s81, s7
    s_mov_b32 s82, 0x600000
    s_mov_b32 s83, 0x20000
    s_lshl_b32 s37, s36, 1
    s_and_b32 s38, s28, 1
    s_add_u32 s37, s37, s38
    s_lshl_b32 s37, s37, 15
    s_lshr_b32 s38, s28, 1
    s_lshl_b32 s38, s38, 9
    s_add_u32 s37, s37, s38
    s_add_u32 s37, s37, 393216
    v_lshrrev_b32 v16, 2, v0
    v_lshlrev_b32 v16, 11, v16
    v_and_b32 v14, 3, v0
    v_lshl_add_u32 v16, v14, 7, v16
    buffer_load_dword v17, v16, s[80:83], s37 offen
    s_add_u32 s36, s36, 3
    s_cmp_lt_u32 s36, 90
    s_cbranch_scc1 F_st1
F_st2:
    s_mov_b32 s8, s84
    s_mov_b32 s9, s85
    s_mov_b32 s10, 0x200000
    s_mov_b32 s11, 0x20000
    v_lshrrev_b32 v16, 3, v0
    v_lshlrev_b32 v16, 11, v16
    v_and_b32 v18, 7, v0
    v_lshl_add_u32 v16, v18, 7, v16
    s_and_b32 s36, s28, 4
    s_lshl_b32 s36, s36, 8
    v_add_u32 v16, s36, v16
    s_add_u32 s36, s3, 23
    s_and_b32 s38, s28, 3
F_stl:
    s_lshl_b32 s37, s36, 2
    s_add_u32 s37, s37, s38
    s_lshl_b32 s37, s37, 14
    buffer_load_dword v17, v16, s[8:11], s37 offen
    s_add_u32 s36, s36, 3
    s_cmp_lt_u32 s36, 32
    s_cbranch_scc1 F_stl
F_sbar:
    v_mov_b32 v1, 147456
    s_barrier
    s_waitcnt vmcnt(0)
    s_cmp_lg_u32 s2, 255
    s_cbranch_scc1 F_help2
    s_cmp_lg_u32 s3, 1
    s_cbranch_scc1 F_help2
    s_branch F_sp_45_e
F_sp_45:
    s_sleep 4
F_sp_45_e:
    ds_read_b32 v16, v1 offset:24
    s_waitcnt lgkmcnt(0)
    v_readfirstlane_b32 s49, v16
    s_nop 0
    s_cmp_ge_u32 s49, 4
    s_cbranch_scc0 F_sp_45
    v_min_u32 v7, 55, v0
    v_lshlrev_b32 v7, 7, v7
    v_add_u32 v7, 0x16000, v7
    s_mov_b32 s49, 0
F_ap:
    buffer_load_dword v8, v7, s[20:23], 0 offen sc1
    s_waitcnt vmcnt(0)
    v_cmp_eq_u32 vcc, 0, v8
    s_add_u32 s49, s49, 1
    s_cmp_eq_u64 vcc, 0
    s_cbranch_scc1 F_aq
    s_cmp_lt_u32 s49, 0x8000
    s_cbranch_scc0 F_aq
    s_mov_b64 exec, vcc
    s_sleep 8
    s_branch F_ap
F_aq:
    s_mov_b64 exec, 1
    v_mov_b32 v7, 64
    v_mov_b32 v8, 1
    buffer_store_dword v8, v7, s[24:27], 0 offen sc1
    s_mov_b64 exec, -1
    s_branch F_help2
F_end:
    s_endpgm
.section .rodata,"a"
.p2align 6
.amdhsa_kernel parallel_sum__sliding_local_dilated__moe_arch_mod__prompt_kernel
  .amdhsa_next_free_vgpr 256
  .amdhsa_next_free_sgpr 102
  .amdhsa_accum_offset 256
  .amdhsa_group_segment_fixed_size 0
  .amdhsa_kernarg_size 88
  .amdhsa_user_sgpr_count 2
  .amdhsa_user_sgpr_kernarg_segment_ptr 1
  .amdhsa_system_sgpr_workgroup_id_x 1
  .amdhsa_float_denorm_mode_32 3
  .amdhsa_float_denorm_mode_16_64 3
.end_amdhsa_kernel
```

```asm
; @launch grid=(256,1,1) block=(512,1,1) lds=161600
.amdgcn_target "amdgcn-amd-amdhsa--gfx950"
.text
.globl parallel_sum__sliding_local_dilated__moe_arch_mod__prompt_kernel
.p2align 8
.type parallel_sum__sliding_local_dilated__moe_arch_mod__prompt_kernel,@function
parallel_sum__sliding_local_dilated__moe_arch_mod__prompt_kernel:
    s_cmp_ge_u32 s2, 256
    s_cbranch_scc1 F_end
    s_load_dwordx4 s[4:7], s[0:1], 0
    s_load_dwordx4 s[72:75], s[0:1], 72
    s_load_dwordx2 s[84:85], s[0:1], 16
    s_load_dwordx2 s[86:87], s[0:1], 64
    v_lshrrev_b32 v1, 6, v0
    v_and_b32 v0, 63, v0
    v_readfirstlane_b32 s3, v1
    s_and_b32 s28, s2, 7
    s_lshr_b32 s29, s2, 3
    s_mov_b32 s39, 0xffff0000
    s_cmp_ge_u32 s29, 24
    s_cbranch_scc1 F_moe
    s_mul_i32 s31, s29, 43
    s_lshr_b32 s31, s31, 8
    s_mul_i32 s30, s31, 6
    s_sub_u32 s30, s29, s30
    s_and_b32 s32, s28, 1
    s_mul_i32 s32, s32, 6
    s_add_u32 s30, s30, s32
    s_lshr_b32 s32, s28, 1
    s_lshl_b32 s32, s32, 2
    s_add_u32 s31, s31, s32
    s_mul_i32 s33, s30, 176
    s_sub_u32 s33, s33, 16
    v_mov_b32 v1, 147456
    s_mov_b32 s56, 0
    s_cmp_lt_u32 s3, 4
    s_cbranch_scc1 F_cons
    s_sub_u32 s3, s3, 4
    s_mul_i32 s45, s3, 12288
    s_cmp_ge_u32 s3, 2
    s_cbranch_scc1 F_lw
    v_lshrrev_b32 v16, 3, v0
    v_lshrrev_b32 v17, 4, v0
    v_and_b32 v18, 7, v0
    v_xor_b32 v17, v17, v18
    v_lshlrev_b32 v17, 4, v17
    v_xor_b32 v18, 64, v17
    s_mul_i32 s36, s3, 96
    s_add_u32 s36, s36, s33
    v_add_u32 v16, s36, v16
    v_add_u32 v19, 0, v16
    v_max_i32 v19, 0, v19
    v_lshl_add_u32 v2, v19, 11, v17
    v_add_u32 v2, 4096, v2
    v_add_u32 v19, 8, v16
    v_max_i32 v19, 0, v19
    v_lshl_add_u32 v3, v19, 11, v18
    v_add_u32 v3, 3072, v3
    v_lshl_add_u32 v4, v16, 11, v17
    v_add_u32 v4, 34816, v4
    v_lshl_add_u32 v5, v16, 11, v18
    v_add_u32 v5, 50176, v5
    v_add_u32 v6, 34816, v4
    v_add_u32 v7, 34816, v5
    v_add_u32 v8, 65536, v4
    v_add_u32 v9, 65536, v5
    v_add_u32 v10, 100352, v4
    v_add_u32 v11, 100352, v5
    v_add_u32 v12, 131072, v4
    v_add_u32 v13, 131072, v5
    s_mov_b32 s42, 128
    s_waitcnt lgkmcnt(0)
    s_sub_u32 s12, s4, 0x1000
    s_subb_u32 s13, s5, 0
    s_mov_b32 s14, 0x401000
    s_mov_b32 s15, 0x20000
    s_branch F_lgo
F_lw:
    s_mov_b32 s36, 6144
    v_lshrrev_b32 v16, 3, v0
    v_and_b32 v17, 6, v16
    v_and_b32 v2, 7, v0
    v_xor_b32 v2, v2, v17
    v_lshlrev_b32 v2, 4, v2
    v_and_b32 v17, 4, v16
    v_add_u32 v16, v16, v17
    v_mul_lo_u32 v16, v16, s36
    v_add_u32 v2, v2, v16
    s_lshl_b32 s36, s31, 7
    s_cmp_eq_u32 s3, 3
    s_cselect_b32 s37, 198656, 0
    s_add_u32 s36, s36, s37
    v_add_u32 v2, s36, v2
    s_cmp_eq_u32 s3, 3
    s_mov_b32 s36, 196608
    s_cselect_b32 s36, -194560, s36
    v_add_u32 v3, 23552, v2
    v_add_u32 v4, 96256, v2
    v_add_u32 v5, 119808, v2
    v_add_u32 v6, s36, v2
    v_add_u32 v10, 2048, v2
    v_add_u32 v7, s36, v3
    v_add_u32 v11, 2048, v3
    v_add_u32 v8, s36, v4
    v_add_u32 v12, 2048, v4
    v_add_u32 v9, s36, v5
    v_add_u32 v13, 2048, v5
    s_mov_b32 s42, 393216
    s_waitcnt lgkmcnt(0)
    s_mov_b32 s12, s6
    s_mov_b32 s13, s7
    s_mov_b32 s14, 0x600000
    s_mov_b32 s15, 0x20000
F_lgo:
    s_mov_b32 s43, 0
    s_mov_b32 s40, s45
    s_add_u32 m0, s40, 0
    s_nop 0
    buffer_load_dwordx4 v2, s[12:15], s43 offen offset:0 lds
    buffer_load_dwordx4 v3, s[12:15], s43 offen offset:1024 lds
    buffer_load_dwordx4 v4, s[12:15], s43 offen offset:2048 lds
    buffer_load_dwordx4 v5, s[12:15], s43 offen offset:3072 lds
    s_add_u32 m0, s40, 4096
    s_nop 0
    buffer_load_dwordx4 v6, s[12:15], s43 offen offset:0 lds
    buffer_load_dwordx4 v7, s[12:15], s43 offen offset:1024 lds
    buffer_load_dwordx4 v8, s[12:15], s43 offen offset:2048 lds
    buffer_load_dwordx4 v9, s[12:15], s43 offen offset:3072 lds
    s_add_u32 m0, s40, 8192
    s_nop 0
    buffer_load_dwordx4 v10, s[12:15], s43 offen offset:0 lds
    buffer_load_dwordx4 v11, s[12:15], s43 offen offset:1024 lds
    buffer_load_dwordx4 v12, s[12:15], s43 offen offset:2048 lds
    buffer_load_dwordx4 v13, s[12:15], s43 offen offset:3072 lds
    s_add_u32 s43, s43, s42
    s_add_u32 s40, s40, 49152
    s_cmp_ge_u32 s40, 147456
    s_cselect_b32 s40, s45, s40
    s_add_u32 m0, s40, 0
    s_nop 0
    buffer_load_dwordx4 v2, s[12:15], s43 offen offset:0 lds
    buffer_load_dwordx4 v3, s[12:15], s43 offen offset:1024 lds
    buffer_load_dwordx4 v4, s[12:15], s43 offen offset:2048 lds
    buffer_load_dwordx4 v5, s[12:15], s43 offen offset:3072 lds
    s_add_u32 m0, s40, 4096
    s_nop 0
    buffer_load_dwordx4 v6, s[12:15], s43 offen offset:0 lds
    buffer_load_dwordx4 v7, s[12:15], s43 offen offset:1024 lds
    buffer_load_dwordx4 v8, s[12:15], s43 offen offset:2048 lds
    buffer_load_dwordx4 v9, s[12:15], s43 offen offset:3072 lds
    s_add_u32 m0, s40, 8192
    s_nop 0
    buffer_load_dwordx4 v10, s[12:15], s43 offen offset:0 lds
    buffer_load_dwordx4 v11, s[12:15], s43 offen offset:1024 lds
    buffer_load_dwordx4 v12, s[12:15], s43 offen offset:2048 lds
    buffer_load_dwordx4 v13, s[12:15], s43 offen offset:3072 lds
    s_add_u32 s43, s43, s42
    s_add_u32 s40, s40, 49152
    s_cmp_ge_u32 s40, 147456
    s_cselect_b32 s40, s45, s40
    s_load_dwordx4 s[64:67], s[0:1], 40
    s_mov_b32 s61, 0
    s_mov_b32 s59, 0
    s_mov_b32 s11, 0x20000
    s_cmp_eq_u32 s3, 1
    s_cbranch_scc1 F_r1
    s_cmp_eq_u32 s3, 2
    s_cbranch_scc1 F_r2
    s_cmp_eq_u32 s3, 3
    s_cbranch_scc1 F_r3
    s_lshl_b32 s36, s29, 14
    s_lshr_b32 s37, s28, 1
    s_lshl_b32 s37, s37, 9
    s_add_u32 s36, s36, s37
    s_add_u32 s36, s36, 1573248
    v_lshl_add_u32 v21, v0, 11, s36
    s_bitcmp1_b32 s28, 1
    s_cselect_b32 s58, 0, 6291456
    s_mov_b64 s[62:63], 0xff
    s_mov_b32 s60, 393216
    s_mov_b32 s8, s6
    s_mov_b32 s9, s7
    s_branch F_rd0
F_r1:
    v_lshrrev_b32 v21, 3, v0
    v_lshlrev_b32 v21, 11, v21
    v_and_b32 v17, 7, v0
    v_lshl_add_u32 v21, v17, 7, v21
    s_and_b32 s36, s28, 4
    s_lshl_b32 s36, s36, 8
    v_add_u32 v21, s36, v21
    s_lshl_b32 s36, s29, 2
    s_and_b32 s37, s28, 3
    s_add_u32 s36, s36, s37
    s_lshl_b32 s36, s36, 14
    v_add_u32 v21, s36, v21
    s_mov_b64 s[62:63], -1
    s_mov_b32 s60, 0x200000
    s_mov_b32 s58, 0x200000
    s_mov_b32 s59, 10
    s_mov_b32 s8, s84
    s_mov_b32 s9, s85
    s_branch F_rd0
F_r2:
    s_add_u32 s37, s28, 3
    s_and_b32 s37, s37, 7
    s_min_u32 s37, s37, 6
    s_mov_b32 s58, 7340032
    s_mul_i32 s38, s28, 7
    s_add_u32 s37, s37, s38
    s_lshl_b32 s37, s37, 7
    s_mul_i32 s38, s29, 315392
    s_add_u32 s37, s37, s38
    s_mov_b32 s38, 7168
    v_mul_lo_u32 v21, v0, s38
    v_add_u32 v21, s37, v21
    s_mov_b32 s62, -1
    s_mov_b32 s63, 0xfff
    s_mov_b32 s60, 7340032
    s_mov_b32 s59, 1
    s_waitcnt lgkmcnt(0)
    s_mov_b32 s8, s64
    s_mov_b32 s9, s65
    s_branch F_rd0
F_r3:
    v_and_b32 v21, 7, v0
    v_lshlrev_b32 v21, 2, v21
    v_add_u32 v21, 128, v21
    s_mov_b64 s[62:63], -1
    s_mov_b32 s60, 0
    s_mov_b32 s58, 0x100
    s_mov_b32 s59, 10
    s_mov_b32 s8, s72
    s_mov_b32 s9, s73
F_rd0:
    s_mov_b32 s41, 0
    s_mov_b32 s44, 0
    v_mov_b32 v28, 0
    s_waitcnt vmcnt(12) lgkmcnt(0)
    s_barrier
    s_add_u32 m0, s40, 0
    s_nop 0
    buffer_load_dwordx4 v2, s[12:15], s43 offen offset:0 lds
    buffer_load_dwordx4 v3, s[12:15], s43 offen offset:1024 lds
    buffer_load_dwordx4 v4, s[12:15], s43 offen offset:2048 lds
    buffer_load_dwordx4 v5, s[12:15], s43 offen offset:3072 lds
    s_add_u32 m0, s40, 4096
    s_nop 0
    buffer_load_dwordx4 v6, s[12:15], s43 offen offset:0 lds
    buffer_load_dwordx4 v7, s[12:15], s43 offen offset:1024 lds
    buffer_load_dwordx4 v8, s[12:15], s43 offen offset:2048 lds
    buffer_load_dwordx4 v9, s[12:15], s43 offen offset:3072 lds
    s_add_u32 m0, s40, 8192
    s_nop 0
    buffer_load_dwordx4 v10, s[12:15], s43 offen offset:0 lds
    buffer_load_dwordx4 v11, s[12:15], s43 offen offset:1024 lds
    buffer_load_dwordx4 v12, s[12:15], s43 offen offset:2048 lds
    buffer_load_dwordx4 v13, s[12:15], s43 offen offset:3072 lds
    s_add_u32 s43, s43, s42
    s_add_u32 s40, s40, 49152
    s_cmp_ge_u32 s40, 147456
    s_cselect_b32 s40, s45, s40
    s_cmp_ge_u32 s44, s59
    s_cselect_b32 s10, s58, 0
    s_cselect_b32 s36, s60, 0
    s_mov_b64 exec, s[62:63]
    buffer_load_dword v28, v21, s[8:11], 0 offen sc1
    s_mov_b64 exec, -1
    v_add_u32 v21, s36, v21
    s_mov_b32 s20, s74
    s_mov_b32 s21, s75
    s_mov_b32 s22, 0x1000000
    s_mov_b32 s23, 0x20000
    s_mov_b32 s24, s72
    s_mov_b32 s25, s73
    s_mov_b32 s26, 0x100
    s_mov_b32 s27, 0x20000
    v_add_u32 v24, s33, v0
    v_add_u32 v24, 0, v24
    v_max_i32 v24, 0, v24
    v_min_i32 v24, 0x7ff, v24
    v_lshlrev_b32 v24, 3, v24
    v_add_u32 v25, s33, v0
    v_add_u32 v25, 64, v25
    v_max_i32 v25, 0, v25
    v_min_i32 v25, 0x7ff, v25
    v_lshlrev_b32 v25, 3, v25
    v_add_u32 v26, s33, v0
    v_add_u32 v26, 128, v26
    v_max_i32 v26, 0, v26
    v_min_i32 v26, 0x7ff, v26
    v_lshlrev_b32 v26, 3, v26
    v_lshrrev_b32 v16, 1, v0
    v_add_u32 v16, s33, v16
    v_add_u32 v36, 0, v16
    v_max_i32 v36, 0, v36
    v_min_i32 v36, 0x7ff, v36
    v_lshlrev_b32 v36, 3, v36
    v_add_u32 v37, 32, v16
    v_max_i32 v37, 0, v37
    v_min_i32 v37, 0x7ff, v37
    v_lshlrev_b32 v37, 3, v37
    v_add_u32 v38, 64, v16
    v_max_i32 v38, 0, v38
    v_min_i32 v38, 0x7ff, v38
    v_lshlrev_b32 v38, 3, v38
    v_add_u32 v39, 96, v16
    v_max_i32 v39, 0, v39
    v_min_i32 v39, 0x7ff, v39
    v_lshlrev_b32 v39, 3, v39
    v_add_u32 v40, 128, v16
    v_max_i32 v40, 0, v40
    v_min_i32 v40, 0x7ff, v40
    v_lshlrev_b32 v40, 3, v40
    v_add_u32 v41, 160, v16
    v_max_i32 v41, 0, v41
    v_min_i32 v41, 0x7ff, v41
    v_lshlrev_b32 v41, 3, v41
    v_and_b32 v27, 7, v0
    v_lshlrev_b32 v27, 2, v27
    s_cmp_lg_u32 s3, 3
    s_cselect_b32 s41, 1, 0
    s_mov_b32 s16, s6
    s_mov_b32 s17, s7
    s_mov_b32 s18, 0x600000
    s_mov_b32 s19, 0x20000
    s_lshl_b32 s36, s29, 1
    s_and_b32 s37, s28, 1
    s_add_u32 s36, s36, s37
    s_lshl_b32 s36, s36, 15
    s_lshr_b32 s37, s28, 1
    s_lshl_b32 s37, s37, 9
    s_add_u32 s36, s36, s37
    s_add_u32 s36, s36, 3014656
    v_lshrrev_b32 v22, 2, v0
    v_lshlrev_b32 v22, 11, v22
    v_and_b32 v17, 3, v0
    v_lshl_add_u32 v22, v17, 7, v22
    v_add_u32 v22, s36, v22
    s_cmp_eq_u32 s3, 1
    s_cselect_b32 s68, 4, -1
    s_cmp_lg_u32 s3, 2
    s_cbranch_scc1 F_nup
    s_mov_b32 s68, 7
    s_mov_b32 s16, s66
    s_mov_b32 s17, s67
    s_mov_b32 s18, s58
    v_mov_b32 v22, v21
F_nup:
    s_waitcnt vmcnt(13)
F_ll:
    s_barrier
    s_add_u32 m0, s40, 0
    s_nop 0
    buffer_load_dwordx4 v2, s[12:15], s43 offen offset:0 lds
    buffer_load_dwordx4 v3, s[12:15], s43 offen offset:1024 lds
    buffer_load_dwordx4 v4, s[12:15], s43 offen offset:2048 lds
    buffer_load_dwordx4 v5, s[12:15], s43 offen offset:3072 lds
    s_add_u32 m0, s40, 4096
    s_nop 0
    buffer_load_dwordx4 v6, s[12:15], s43 offen offset:0 lds
    buffer_load_dwordx4 v7, s[12:15], s43 offen offset:1024 lds
    buffer_load_dwordx4 v8, s[12:15], s43 offen offset:2048 lds
    buffer_load_dwordx4 v9, s[12:15], s43 offen offset:3072 lds
    s_add_u32 m0, s40, 8192
    s_nop 0
    buffer_load_dwordx4 v10, s[12:15], s43 offen offset:0 lds
    buffer_load_dwordx4 v11, s[12:15], s43 offen offset:1024 lds
    buffer_load_dwordx4 v12, s[12:15], s43 offen offset:2048 lds
    buffer_load_dwordx4 v13, s[12:15], s43 offen offset:3072 lds
    s_add_u32 s43, s43, s42
    s_add_u32 s40, s40, 49152
    s_cmp_ge_u32 s40, 147456
    s_cselect_b32 s40, s45, s40
    s_add_u32 s44, s44, 1
    s_cmp_lg_u32 s41, 0
    s_cbranch_scc1 F_lsd
    v_cmp_ne_u32 vcc, 0, v28
    s_nop 0
    s_cmp_eq_u64 vcc, -1
    s_cbranch_scc0 F_lsd
    s_mov_b32 s46, 0x4000
    s_mov_b32 s47, 0x4004
    s_mov_b32 m0, 148992
    s_nop 0
    buffer_load_dword v24, s[20:23], s46 offen sc1 lds
    s_mov_b32 m0, 149760
    s_nop 0
    buffer_load_dword v24, s[20:23], s47 offen sc1 lds
    s_mov_b32 m0, 149248
    s_nop 0
    buffer_load_dword v25, s[20:23], s46 offen sc1 lds
    s_mov_b32 m0, 150016
    s_nop 0
    buffer_load_dword v25, s[20:23], s47 offen sc1 lds
    s_mov_b32 m0, 149504
    s_nop 0
    buffer_load_dword v26, s[20:23], s46 offen sc1 lds
    s_mov_b32 m0, 150272
    s_nop 0
    buffer_load_dword v26, s[20:23], s47 offen sc1 lds
    s_mov_b32 m0, 150528
    s_nop 0
    buffer_load_dword v36, s[20:23], s46 offen sc1 lds
    s_mov_b32 m0, 150784
    s_nop 0
    buffer_load_dword v37, s[20:23], s46 offen sc1 lds
    s_mov_b32 m0, 151040
    s_nop 0
    buffer_load_dword v38, s[20:23], s46 offen sc1 lds
    s_mov_b32 m0, 151296
    s_nop 0
    buffer_load_dword v39, s[20:23], s46 offen sc1 lds
    s_mov_b32 m0, 151552
    s_nop 0
    buffer_load_dword v40, s[20:23], s46 offen sc1 lds
    s_mov_b32 m0, 151808
    s_nop 0
    buffer_load_dword v41, s[20:23], s46 offen sc1 lds
    s_mov_b32 m0, 147712
    s_mov_b32 s46, 128
    buffer_load_dword v27, s[24:27], s46 offen sc1 lds
    s_mov_b32 s41, 1
    s_mov_b32 s58, 0
    s_waitcnt vmcnt(26)
    s_branch F_lnx
F_lsd:
    s_cmp_lg_u32 s44, s68
    s_cbranch_scc1 F_lsd2
    s_mov_b64 exec, s[62:63]
    buffer_load_dword v20, v22, s[16:19], 0 offen
    s_mov_b64 exec, -1
    s_waitcnt vmcnt(14)
    s_branch F_lnx
F_lsd2:
    s_cmp_ge_u32 s44, s59
    s_cselect_b32 s10, s58, 0
    s_cselect_b32 s36, s60, 0
    s_mov_b64 exec, s[62:63]
    buffer_load_dword v28, v21, s[8:11], 0 offen sc1
    s_mov_b64 exec, -1
    v_add_u32 v21, s36, v21
    s_waitcnt vmcnt(14)
F_lnx:
    s_cmp_lt_u32 s44, 13
    s_cbranch_scc1 F_ll
    s_and_b32 s30, s28, 1
    s_lshl_b32 s30, s30, 3
    s_and_b32 s31, s28, 2
    s_lshl_b32 s31, s31, 1
    s_add_u32 s30, s30, s31
    s_lshr_b32 s31, s29, 3
    s_add_u32 s30, s30, s31
    s_and_b32 s34, s29, 7
    s_add_u32 s32, s28, 3
    s_and_b32 s32, s32, 7
    s_cmp_eq_u32 s29, 27
    s_cselect_b32 s34, s32, s34
    s_add_u32 s32, s32, 24
    s_cmp_eq_u32 s29, s32
    s_cselect_b32 s34, 3, s34
    s_and_b32 s32, s28, 4
    s_lshl_b32 s32, s32, 1
    s_add_u32 s32, s32, s34
    s_mov_b32 s36, 2048
    v_lshrrev_b32 v14, 3, v0
    v_and_b32 v15, 6, v14
    v_and_b32 v220, 7, v0
    v_xor_b32 v220, v220, v15
    v_lshlrev_b32 v220, 4, v220
    v_mul_lo_u32 v14, v14, s36
    v_add_u32 v220, v220, v14
    s_lshl_b32 s36, s32, 7
    v_add_u32 v220, s36, v220
    v_add_u32 v221, 15360, v220
    v_add_u32 v222, 30720, v220
    v_add_u32 v223, 46080, v220
    s_mov_b32 s12, s84
    s_mov_b32 s13, s85
    s_mov_b32 s14, 0x200000
    s_mov_b32 s15, 0x20000
    s_barrier
    s_mul_i32 s49, s3, 12288
    s_lshl_b32 s38, s49, 4
    s_add_u32 s49, s49, 49152
    s_add_u32 s38, s38, 0
    s_add_u32 m0, s49, 0
    s_nop 0
    buffer_load_dwordx4 v220, s[12:15], s38 offen offset:0 lds
    buffer_load_dwordx4 v221, s[12:15], s38 offen offset:1024 lds
    buffer_load_dwordx4 v222, s[12:15], s38 offen offset:2048 lds
    buffer_load_dwordx4 v223, s[12:15], s38 offen offset:3072 lds
    s_add_u32 m0, s49, 4096
    s_add_u32 s38, s38, 0x10000
    buffer_load_dwordx4 v220, s[12:15], s38 offen offset:0 lds
    buffer_load_dwordx4 v221, s[12:15], s38 offen offset:1024 lds
    buffer_load_dwordx4 v222, s[12:15], s38 offen offset:2048 lds
    buffer_load_dwordx4 v223, s[12:15], s38 offen offset:3072 lds
    s_add_u32 m0, s49, 8192
    s_add_u32 s38, s38, 0x10000
    buffer_load_dwordx4 v220, s[12:15], s38 offen offset:0 lds
    buffer_load_dwordx4 v221, s[12:15], s38 offen offset:1024 lds
    buffer_load_dwordx4 v222, s[12:15], s38 offen offset:2048 lds
    buffer_load_dwordx4 v223, s[12:15], s38 offen offset:3072 lds
    s_waitcnt vmcnt(12)
    s_barrier
    s_mul_i32 s49, s3, 12288
    s_lshl_b32 s38, s49, 4
    s_add_u32 s49, s49, 98304
    s_add_u32 s38, s38, 786432
    s_add_u32 m0, s49, 0
    s_nop 0
    buffer_load_dwordx4 v220, s[12:15], s38 offen offset:0 lds
    buffer_load_dwordx4 v221, s[12:15], s38 offen offset:1024 lds
    buffer_load_dwordx4 v222, s[12:15], s38 offen offset:2048 lds
    buffer_load_dwordx4 v223, s[12:15], s38 offen offset:3072 lds
    s_add_u32 m0, s49, 4096
    s_add_u32 s38, s38, 0x10000
    buffer_load_dwordx4 v220, s[12:15], s38 offen offset:0 lds
    buffer_load_dwordx4 v221, s[12:15], s38 offen offset:1024 lds
    buffer_load_dwordx4 v222, s[12:15], s38 offen offset:2048 lds
    buffer_load_dwordx4 v223, s[12:15], s38 offen offset:3072 lds
    s_add_u32 m0, s49, 8192
    s_add_u32 s38, s38, 0x10000
    buffer_load_dwordx4 v220, s[12:15], s38 offen offset:0 lds
    buffer_load_dwordx4 v221, s[12:15], s38 offen offset:1024 lds
    buffer_load_dwordx4 v222, s[12:15], s38 offen offset:2048 lds
    buffer_load_dwordx4 v223, s[12:15], s38 offen offset:3072 lds
    s_barrier
    s_cmp_lg_u32 s41, 0
    s_cbranch_scc1 F_p2g
    s_mov_b32 s47, 0
F_pl_1:
    buffer_load_dword v28, v27, s[24:27], 0 offen offset:128 sc1
    s_waitcnt vmcnt(0)
F_pc_2:
    v_cmp_ne_u32 vcc, 0, v28
    s_nop 0
    s_cmp_eq_u64 vcc, -1
    s_cbranch_scc1 F_pd_3
    s_add_u32 s47, s47, 1
    s_cmp_lt_u32 s47, 0x8000
    s_cbranch_scc0 F_pd_3
    s_sleep 8
    s_branch F_pl_1
F_pd_3:
    s_mov_b32 s46, 0x4000
    s_mov_b32 s47, 0x4004
    s_mov_b32 m0, 148992
    s_nop 0
    buffer_load_dword v24, s[20:23], s46 offen sc1 lds
    s_mov_b32 m0, 149760
    s_nop 0
    buffer_load_dword v24, s[20:23], s47 offen sc1 lds
    s_mov_b32 m0, 149248
    s_nop 0
    buffer_load_dword v25, s[20:23], s46 offen sc1 lds
    s_mov_b32 m0, 150016
    s_nop 0
    buffer_load_dword v25, s[20:23], s47 offen sc1 lds
    s_mov_b32 m0, 149504
    s_nop 0
    buffer_load_dword v26, s[20:23], s46 offen sc1 lds
    s_mov_b32 m0, 150272
    s_nop 0
    buffer_load_dword v26, s[20:23], s47 offen sc1 lds
    s_mov_b32 m0, 150528
    s_nop 0
    buffer_load_dword v36, s[20:23], s46 offen sc1 lds
    s_mov_b32 m0, 150784
    s_nop 0
    buffer_load_dword v37, s[20:23], s46 offen sc1 lds
    s_mov_b32 m0, 151040
    s_nop 0
    buffer_load_dword v38, s[20:23], s46 offen sc1 lds
    s_mov_b32 m0, 151296
    s_nop 0
    buffer_load_dword v39, s[20:23], s46 offen sc1 lds
    s_mov_b32 m0, 151552
    s_nop 0
    buffer_load_dword v40, s[20:23], s46 offen sc1 lds
    s_mov_b32 m0, 151808
    s_nop 0
    buffer_load_dword v41, s[20:23], s46 offen sc1 lds
    v_or_b32 v28, 0x800, v28
    v_add_u32 v16, v27, v1
    s_waitcnt vmcnt(0)
    ds_write_b32 v16, v28 offset:256
F_p2g:
    s_mov_b32 s59, 0
    s_branch F_p2c
F_p2:
    s_and_b32 s30, s28, 1
    s_lshl_b32 s30, s30, 3
    s_and_b32 s31, s28, 2
    s_lshl_b32 s31, s31, 1
    s_add_u32 s30, s30, s31
    s_lshr_b32 s31, s29, 3
    s_add_u32 s30, s30, s31
    s_and_b32 s34, s29, 7
    s_add_u32 s32, s28, 3
    s_and_b32 s32, s32, 7
    s_cmp_eq_u32 s29, 27
    s_cselect_b32 s34, s32, s34
    s_add_u32 s32, s32, 24
    s_cmp_eq_u32 s29, s32
    s_cselect_b32 s34, 3, s34
    s_and_b32 s32, s28, 4
    s_lshl_b32 s32, s32, 1
    s_add_u32 s32, s32, s34
    s_sub_u32 s3, s3, 4
    s_mov_b32 s36, 2048
    v_lshrrev_b32 v14, 3, v0
    v_and_b32 v15, 6, v14
    v_and_b32 v220, 7, v0
    v_xor_b32 v220, v220, v15
    v_lshlrev_b32 v220, 4, v220
    v_mul_lo_u32 v14, v14, s36
    v_add_u32 v220, v220, v14
    s_lshl_b32 s36, s32, 7
    v_add_u32 v220, s36, v220
    v_add_u32 v221, 15360, v220
    v_add_u32 v222, 30720, v220
    v_add_u32 v223, 46080, v220
    s_mov_b32 s12, s84
    s_mov_b32 s13, s85
    s_mov_b32 s14, 0x200000
    s_mov_b32 s15, 0x20000
F_p2c:
    s_mov_b32 s8, s4
    s_mov_b32 s9, s5
    s_mov_b32 s10, 0x400000
    s_mov_b32 s11, 0x20000
    s_mov_b32 s16, s86
    s_mov_b32 s17, s87
    s_mov_b32 s18, 0x400000
    s_mov_b32 s19, 0x20000
    s_mov_b32 s20, s74
    s_mov_b32 s21, s75
    s_mov_b32 s22, 0x1000000
    s_mov_b32 s23, 0x20000
    s_lshl_b32 s35, s30, 7
    s_lshl_b32 s36, s3, 5
    s_add_u32 s35, s35, s36
    v_and_b32 v14, 15, v0
    v_add_u32 v14, s35, v14
    v_lshlrev_b32 v7, 3, v14
    v_add_u32 v7, 0x4000, v7
    v_lshlrev_b32 v6, 11, v14
    v_bfe_u32 v15, v0, 4, 1
    v_lshl_add_u32 v6, v15, 5, v6
    v_lshrrev_b32 v15, 5, v0
    v_lshl_add_u32 v6, v15, 4, v6
    s_lshl_b32 s36, s32, 7
    v_add_u32 v6, s36, v6
    s_lshl_b32 s36, s35, 11
    s_add_u32 s36, s36, 0x100000
    v_lshl_add_u32 v4, v0, 4, s36
    v_add_u32 v5, 0x8000, v4
    s_mov_b32 s37, 0x8000
    s_branch F_sp_4_e
F_sp_4:
    s_sleep 2
F_sp_4_e:
    ds_read_b32 v8, v1 offset:256
    s_waitcnt lgkmcnt(0)
    v_readfirstlane_b32 s49, v8
    s_nop 0
    s_cmp_lg_u32 s49, 0
    s_cbranch_scc0 F_sp_4
    buffer_load_dwordx2 v[216:217], v7, s[20:23], 0 offen offset:0 sc1
    buffer_load_dwordx4 v[200:203], v6, s[8:11], 0 offen offset:0
    buffer_load_dwordx4 v[204:207], v6, s[8:11], 0 offen offset:64
    buffer_load_dwordx2 v[218:219], v7, s[20:23], 0 offen offset:128 sc1
    buffer_load_dwordx4 v[208:211], v6, s[8:11], s37 offen offset:0
    buffer_load_dwordx4 v[212:215], v6, s[8:11], s37 offen offset:64
    s_branch F_sp_5_e
F_sp_5:
    s_sleep 1
F_sp_5_e:
    ds_read_b32 v8, v1 offset:44
    s_waitcnt lgkmcnt(0)
    v_readfirstlane_b32 s49, v8
    s_nop 0
    s_cmp_lg_u32 s49, 0
    s_cbranch_scc0 F_sp_5
    s_branch F_sp_6_e
F_sp_6:
    s_sleep 1
F_sp_6_e:
    ds_read_b32 v8, v1 offset:52
    s_waitcnt lgkmcnt(0)
    v_readfirstlane_b32 s49, v8
    s_nop 0
    s_cmp_lg_u32 s49, 0
    s_cbranch_scc0 F_sp_6
    s_mul_i32 s49, s3, 8192
    s_lshl_b32 s38, s49, 4
    s_add_u32 s49, s49, 16384
    s_add_u32 s38, s38, 1572864
    s_add_u32 m0, s49, 0
    s_nop 0
    buffer_load_dwordx4 v220, s[12:15], s38 offen offset:0 lds
    buffer_load_dwordx4 v221, s[12:15], s38 offen offset:1024 lds
    buffer_load_dwordx4 v222, s[12:15], s38 offen offset:2048 lds
    buffer_load_dwordx4 v223, s[12:15], s38 offen offset:3072 lds
    s_add_u32 m0, s49, 4096
    s_add_u32 s38, s38, 0x10000
    buffer_load_dwordx4 v220, s[12:15], s38 offen offset:0 lds
    buffer_load_dwordx4 v221, s[12:15], s38 offen offset:1024 lds
    buffer_load_dwordx4 v222, s[12:15], s38 offen offset:2048 lds
    buffer_load_dwordx4 v223, s[12:15], s38 offen offset:3072 lds
    s_waitcnt vmcnt(8)
    s_branch F_p2e
F_p2d:
    s_mul_i32 s49, s3, 12288
    s_lshl_b32 s38, s49, 4
    s_add_u32 s49, s49, 49152
    s_add_u32 s38, s38, 0
    s_add_u32 m0, s49, 0
    s_nop 0
    buffer_load_dwordx4 v220, s[12:15], s38 offen offset:0 lds
    buffer_load_dwordx4 v221, s[12:15], s38 offen offset:1024 lds
    buffer_load_dwordx4 v222, s[12:15], s38 offen offset:2048 lds
    buffer_load_dwordx4 v223, s[12:15], s38 offen offset:3072 lds
    s_add_u32 m0, s49, 4096
    s_add_u32 s38, s38, 0x10000
    buffer_load_dwordx4 v220, s[12:15], s38 offen offset:0 lds
    buffer_load_dwordx4 v221, s[12:15], s38 offen offset:1024 lds
    buffer_load_dwordx4 v222, s[12:15], s38 offen offset:2048 lds
    buffer_load_dwordx4 v223, s[12:15], s38 offen offset:3072 lds
    s_add_u32 m0, s49, 8192
    s_add_u32 s38, s38, 0x10000
    buffer_load_dwordx4 v220, s[12:15], s38 offen offset:0 lds
    buffer_load_dwordx4 v221, s[12:15], s38 offen offset:1024 lds
    buffer_load_dwordx4 v222, s[12:15], s38 offen offset:2048 lds
    buffer_load_dwordx4 v223, s[12:15], s38 offen offset:3072 lds
    s_waitcnt vmcnt(16)
F_p2e:
    ds_read_b128 v[24:27], v1 offset:256
    ds_read_b128 v[28:31], v1 offset:272
    v_mov_b32 v22, v217
    v_mov_b32 v23, v217
    v_mov_b32 v217, v216
    v_permlane16_swap_b32 v200, v202
    v_permlane16_swap_b32 v201, v203
    v_permlane16_swap_b32 v204, v206
    v_permlane16_swap_b32 v205, v207
    v_lshlrev_b32 v224, 16, v200
    v_and_b32 v225, s39, v200
    v_lshlrev_b32 v226, 16, v201
    v_and_b32 v227, s39, v201
    v_pk_add_f32 v[16:17], v[224:225], v[216:217] neg_lo:[0,1] neg_hi:[0,1]
    v_pk_add_f32 v[18:19], v[226:227], v[216:217] neg_lo:[0,1] neg_hi:[0,1]
    v_pk_fma_f32 v[224:225], v[16:17], v[22:23], v[224:225]
    v_pk_fma_f32 v[226:227], v[18:19], v[22:23], v[226:227]
    v_lshlrev_b32 v228, 16, v202
    v_and_b32 v229, s39, v202
    v_lshlrev_b32 v230, 16, v203
    v_and_b32 v231, s39, v203
    v_pk_add_f32 v[16:17], v[228:229], v[216:217] neg_lo:[0,1] neg_hi:[0,1]
    v_pk_add_f32 v[18:19], v[230:231], v[216:217] neg_lo:[0,1] neg_hi:[0,1]
    v_pk_fma_f32 v[228:229], v[16:17], v[22:23], v[228:229]
    v_pk_fma_f32 v[230:231], v[18:19], v[22:23], v[230:231]
    v_lshlrev_b32 v232, 16, v204
    v_and_b32 v233, s39, v204
    v_lshlrev_b32 v234, 16, v205
    v_and_b32 v235, s39, v205
    v_pk_add_f32 v[16:17], v[232:233], v[216:217] neg_lo:[0,1] neg_hi:[0,1]
    v_pk_add_f32 v[18:19], v[234:235], v[216:217] neg_lo:[0,1] neg_hi:[0,1]
    v_pk_fma_f32 v[232:233], v[16:17], v[22:23], v[232:233]
    v_pk_fma_f32 v[234:235], v[18:19], v[22:23], v[234:235]
    v_lshlrev_b32 v236, 16, v206
    v_and_b32 v237, s39, v206
    v_lshlrev_b32 v238, 16, v207
    v_and_b32 v239, s39, v207
    v_pk_add_f32 v[16:17], v[236:237], v[216:217] neg_lo:[0,1] neg_hi:[0,1]
    v_pk_add_f32 v[18:19], v[238:239], v[216:217] neg_lo:[0,1] neg_hi:[0,1]
    v_pk_fma_f32 v[236:237], v[16:17], v[22:23], v[236:237]
    v_pk_fma_f32 v[238:239], v[18:19], v[22:23], v[238:239]
    s_cmp_lg_u32 s59, 1
    s_cbranch_scc1 F_nl3
    s_waitcnt vmcnt(12)
    s_barrier
    s_mul_i32 s49, s3, 12288
    s_lshl_b32 s38, s49, 4
    s_add_u32 s49, s49, 98304
    s_add_u32 s38, s38, 786432
    s_add_u32 m0, s49, 0
    s_nop 0
    buffer_load_dwordx4 v220, s[12:15], s38 offen offset:0 lds
    buffer_load_dwordx4 v221, s[12:15], s38 offen offset:1024 lds
    buffer_load_dwordx4 v222, s[12:15], s38 offen offset:2048 lds
    buffer_load_dwordx4 v223, s[12:15], s38 offen offset:3072 lds
    s_add_u32 m0, s49, 4096
    s_add_u32 s38, s38, 0x10000
    buffer_load_dwordx4 v220, s[12:15], s38 offen offset:0 lds
    buffer_load_dwordx4 v221, s[12:15], s38 offen offset:1024 lds
    buffer_load_dwordx4 v222, s[12:15], s38 offen offset:2048 lds
    buffer_load_dwordx4 v223, s[12:15], s38 offen offset:3072 lds
    s_add_u32 m0, s49, 8192
    s_add_u32 s38, s38, 0x10000
    buffer_load_dwordx4 v220, s[12:15], s38 offen offset:0 lds
    buffer_load_dwordx4 v221, s[12:15], s38 offen offset:1024 lds
    buffer_load_dwordx4 v222, s[12:15], s38 offen offset:2048 lds
    buffer_load_dwordx4 v223, s[12:15], s38 offen offset:3072 lds
F_nl3:
    v_mov_b32 v22, v219
    v_mov_b32 v23, v219
    v_mov_b32 v219, v218
    v_permlane16_swap_b32 v208, v210
    v_permlane16_swap_b32 v209, v211
    v_permlane16_swap_b32 v212, v214
    v_permlane16_swap_b32 v213, v215
    v_lshlrev_b32 v240, 16, v208
    v_and_b32 v241, s39, v208
    v_lshlrev_b32 v242, 16, v209
    v_and_b32 v243, s39, v209
    v_pk_add_f32 v[16:17], v[240:241], v[218:219] neg_lo:[0,1] neg_hi:[0,1]
    v_pk_add_f32 v[18:19], v[242:243], v[218:219] neg_lo:[0,1] neg_hi:[0,1]
    v_pk_fma_f32 v[240:241], v[16:17], v[22:23], v[240:241]
    v_pk_fma_f32 v[242:243], v[18:19], v[22:23], v[242:243]
    v_lshlrev_b32 v244, 16, v210
    v_and_b32 v245, s39, v210
    v_lshlrev_b32 v246, 16, v211
    v_and_b32 v247, s39, v211
    v_pk_add_f32 v[16:17], v[244:245], v[218:219] neg_lo:[0,1] neg_hi:[0,1]
    v_pk_add_f32 v[18:19], v[246:247], v[218:219] neg_lo:[0,1] neg_hi:[0,1]
    v_pk_fma_f32 v[244:245], v[16:17], v[22:23], v[244:245]
    v_pk_fma_f32 v[246:247], v[18:19], v[22:23], v[246:247]
    v_lshlrev_b32 v248, 16, v212
    v_and_b32 v249, s39, v212
    v_lshlrev_b32 v250, 16, v213
    v_and_b32 v251, s39, v213
    v_pk_add_f32 v[16:17], v[248:249], v[218:219] neg_lo:[0,1] neg_hi:[0,1]
    v_pk_add_f32 v[18:19], v[250:251], v[218:219] neg_lo:[0,1] neg_hi:[0,1]
    v_pk_fma_f32 v[248:249], v[16:17], v[22:23], v[248:249]
    v_pk_fma_f32 v[250:251], v[18:19], v[22:23], v[250:251]
    v_lshlrev_b32 v252, 16, v214
    v_and_b32 v253, s39, v214
    v_lshlrev_b32 v254, 16, v215
    v_and_b32 v255, s39, v215
    v_pk_add_f32 v[16:17], v[252:253], v[218:219] neg_lo:[0,1] neg_hi:[0,1]
    v_pk_add_f32 v[18:19], v[254:255], v[218:219] neg_lo:[0,1] neg_hi:[0,1]
    v_pk_fma_f32 v[252:253], v[16:17], v[22:23], v[252:253]
    v_pk_fma_f32 v[254:255], v[18:19], v[22:23], v[254:255]
    s_cmp_lg_u32 s59, 1
    s_cbranch_scc1 F_nl4
    s_mul_i32 s49, s3, 8192
    s_lshl_b32 s38, s49, 4
    s_add_u32 s49, s49, 16384
    s_add_u32 s38, s38, 1572864
    s_add_u32 m0, s49, 0
    s_nop 0
    buffer_load_dwordx4 v220, s[12:15], s38 offen offset:0 lds
    buffer_load_dwordx4 v221, s[12:15], s38 offen offset:1024 lds
    buffer_load_dwordx4 v222, s[12:15], s38 offen offset:2048 lds
    buffer_load_dwordx4 v223, s[12:15], s38 offen offset:3072 lds
    s_add_u32 m0, s49, 4096
    s_add_u32 s38, s38, 0x10000
    buffer_load_dwordx4 v220, s[12:15], s38 offen offset:0 lds
    buffer_load_dwordx4 v221, s[12:15], s38 offen offset:1024 lds
    buffer_load_dwordx4 v222, s[12:15], s38 offen offset:2048 lds
    buffer_load_dwordx4 v223, s[12:15], s38 offen offset:3072 lds
F_nl4:
    s_waitcnt lgkmcnt(0)
    v_readfirstlane_b32 s40, v24
    v_readfirstlane_b32 s41, v25
    v_readfirstlane_b32 s42, v26
    v_readfirstlane_b32 s43, v27
    v_readfirstlane_b32 s44, v28
    v_readfirstlane_b32 s45, v29
    v_readfirstlane_b32 s46, v30
    v_readfirstlane_b32 s47, v31
    v_bfe_u32 v14, v0, 2, 3
    v_lshrrev_b32 v15, 1, v14
    v_xor_b32 v15, 0, v15
    v_lshlrev_b32 v60, 5, v15
    v_lshl_add_u32 v60, v14, 7, v60
    v_and_b32 v14, 3, v0
    v_lshl_add_u32 v60, v14, 3, v60
    v_lshrrev_b32 v14, 5, v0
    v_lshl_add_u32 v60, v14, 10, v60
    v_add_u32 v60, 0x4000, v60
    v_bfe_u32 v14, v0, 2, 3
    v_lshrrev_b32 v15, 1, v14
    v_xor_b32 v15, 1, v15
    v_lshlrev_b32 v61, 5, v15
    v_lshl_add_u32 v61, v14, 7, v61
    v_and_b32 v14, 3, v0
    v_lshl_add_u32 v61, v14, 3, v61
    v_lshrrev_b32 v14, 5, v0
    v_lshl_add_u32 v61, v14, 10, v61
    v_add_u32 v61, 0x4000, v61
    v_bfe_u32 v14, v0, 2, 3
    v_lshrrev_b32 v15, 1, v14
    v_xor_b32 v15, 2, v15
    v_lshlrev_b32 v62, 5, v15
    v_lshl_add_u32 v62, v14, 7, v62
    v_and_b32 v14, 3, v0
    v_lshl_add_u32 v62, v14, 3, v62
    v_lshrrev_b32 v14, 5, v0
    v_lshl_add_u32 v62, v14, 10, v62
    v_add_u32 v62, 0x4000, v62
    v_bfe_u32 v14, v0, 2, 3
    v_lshrrev_b32 v15, 1, v14
    v_xor_b32 v15, 3, v15
    v_lshlrev_b32 v63, 5, v15
    v_lshl_add_u32 v63, v14, 7, v63
    v_and_b32 v14, 3, v0
    v_lshl_add_u32 v63, v14, 3, v63
    v_lshrrev_b32 v14, 5, v0
    v_lshl_add_u32 v63, v14, 10, v63
    v_add_u32 v63, 0x4000, v63
    v_mov_b32 v22, 2048
    v_mov_b32 v23, 2048
    s_mov_b32 s48, 0
    v_and_b32 v14, 15, v0
    v_add_u32 v14, s35, v14
    v_add_u32 v15, 16, v14
    s_and_b32 s49, s40, 0x7ff
    s_sub_u32 s49, 2047, s49
    s_sub_u32 s50, s49, s35
    s_cmp_lt_u32 s50, 32
    s_cselect_b32 s48, 1, s48
    v_mov_b32 v16, 0
    v_cmp_eq_u32 vcc, s49, v14
    v_cmp_eq_u32 s[52:53], s49, v15
    s_nop 0
    v_cndmask_b32 v22, v22, v16, vcc
    v_cndmask_b32 v23, v23, v16, s[52:53]
    s_and_b32 s49, s41, 0x7ff
    s_sub_u32 s49, 2047, s49
    s_sub_u32 s50, s49, s35
    s_cmp_lt_u32 s50, 32
    s_cselect_b32 s48, 1, s48
    v_mov_b32 v16, 256
    v_cmp_eq_u32 vcc, s49, v14
    v_cmp_eq_u32 s[52:53], s49, v15
    s_nop 0
    v_cndmask_b32 v22, v22, v16, vcc
    v_cndmask_b32 v23, v23, v16, s[52:53]
    s_and_b32 s49, s42, 0x7ff
    s_sub_u32 s49, 2047, s49
    s_sub_u32 s50, s49, s35
    s_cmp_lt_u32 s50, 32
    s_cselect_b32 s48, 1, s48
    v_mov_b32 v16, 512
    v_cmp_eq_u32 vcc, s49, v14
    v_cmp_eq_u32 s[52:53], s49, v15
    s_nop 0
    v_cndmask_b32 v22, v22, v16, vcc
    v_cndmask_b32 v23, v23, v16, s[52:53]
    s_and_b32 s49, s43, 0x7ff
    s_sub_u32 s49, 2047, s49
    s_sub_u32 s50, s49, s35
    s_cmp_lt_u32 s50, 32
    s_cselect_b32 s48, 1, s48
    v_mov_b32 v16, 768
    v_cmp_eq_u32 vcc, s49, v14
    v_cmp_eq_u32 s[52:53], s49, v15
    s_nop 0
    v_cndmask_b32 v22, v22, v16, vcc
    v_cndmask_b32 v23, v23, v16, s[52:53]
    s_and_b32 s49, s44, 0x7ff
    s_sub_u32 s49, 2047, s49
    s_sub_u32 s50, s49, s35
    s_cmp_lt_u32 s50, 32
    s_cselect_b32 s48, 1, s48
    v_mov_b32 v16, 1024
    v_cmp_eq_u32 vcc, s49, v14
    v_cmp_eq_u32 s[52:53], s49, v15
    s_nop 0
    v_cndmask_b32 v22, v22, v16, vcc
    v_cndmask_b32 v23, v23, v16, s[52:53]
    s_and_b32 s49, s45, 0x7ff
    s_sub_u32 s49, 2047, s49
    s_sub_u32 s50, s49, s35
    s_cmp_lt_u32 s50, 32
    s_cselect_b32 s48, 1, s48
    v_mov_b32 v16, 1280
    v_cmp_eq_u32 vcc, s49, v14
    v_cmp_eq_u32 s[52:53], s49, v15
    s_nop 0
    v_cndmask_b32 v22, v22, v16, vcc
    v_cndmask_b32 v23, v23, v16, s[52:53]
    s_and_b32 s49, s46, 0x7ff
    s_sub_u32 s49, 2047, s49
    s_sub_u32 s50, s49, s35
    s_cmp_lt_u32 s50, 32
    s_cselect_b32 s48, 1, s48
    v_mov_b32 v16, 1536
    v_cmp_eq_u32 vcc, s49, v14
    v_cmp_eq_u32 s[52:53], s49, v15
    s_nop 0
    v_cndmask_b32 v22, v22, v16, vcc
    v_cndmask_b32 v23, v23, v16, s[52:53]
    s_and_b32 s49, s47, 0x7ff
    s_sub_u32 s49, 2047, s49
    s_sub_u32 s50, s49, s35
    s_cmp_lt_u32 s50, 32
    s_cselect_b32 s48, 1, s48
    v_mov_b32 v16, 1792
    v_cmp_eq_u32 vcc, s49, v14
    v_cmp_eq_u32 s[52:53], s49, v15
    s_nop 0
    v_cndmask_b32 v22, v22, v16, vcc
    v_cndmask_b32 v23, v23, v16, s[52:53]
    v_lshrrev_b32 v16, 4, v0
    v_lshlrev_b32 v16, 4, v16
    v_add_u32 v16, 157184, v16
    v_add_u32 v22, v22, v16
    v_add_u32 v23, v23, v16
    s_cmp_lg_u32 s59, 2
    s_cbranch_scc1 F_nl2
    s_barrier
    s_mul_i32 s49, s3, 12288
    s_lshl_b32 s38, s49, 4
    s_add_u32 s49, s49, 49152
    s_add_u32 s38, s38, 0
    s_add_u32 m0, s49, 0
    s_nop 0
    buffer_load_dwordx4 v220, s[12:15], s38 offen offset:0 lds
    buffer_load_dwordx4 v221, s[12:15], s38 offen offset:1024 lds
    buffer_load_dwordx4 v222, s[12:15], s38 offen offset:2048 lds
    buffer_load_dwordx4 v223, s[12:15], s38 offen offset:3072 lds
    s_add_u32 m0, s49, 4096
    s_add_u32 s38, s38, 0x10000
    buffer_load_dwordx4 v220, s[12:15], s38 offen offset:0 lds
    buffer_load_dwordx4 v221, s[12:15], s38 offen offset:1024 lds
    buffer_load_dwordx4 v222, s[12:15], s38 offen offset:2048 lds
    buffer_load_dwordx4 v223, s[12:15], s38 offen offset:3072 lds
    s_add_u32 m0, s49, 8192
    s_add_u32 s38, s38, 0x10000
    buffer_load_dwordx4 v220, s[12:15], s38 offen offset:0 lds
    buffer_load_dwordx4 v221, s[12:15], s38 offen offset:1024 lds
    buffer_load_dwordx4 v222, s[12:15], s38 offen offset:2048 lds
    buffer_load_dwordx4 v223, s[12:15], s38 offen offset:3072 lds
    s_mul_i32 s49, s3, 12288
    s_lshl_b32 s38, s49, 4
    s_add_u32 s49, s49, 98304
    s_add_u32 s38, s38, 786432
    s_add_u32 m0, s49, 0
    s_nop 0
    buffer_load_dwordx4 v220, s[12:15], s38 offen offset:0 lds
    buffer_load_dwordx4 v221, s[12:15], s38 offen offset:1024 lds
    buffer_load_dwordx4 v222, s[12:15], s38 offen offset:2048 lds
    buffer_load_dwordx4 v223, s[12:15], s38 offen offset:3072 lds
    s_add_u32 m0, s49, 4096
    s_add_u32 s38, s38, 0x10000
    buffer_load_dwordx4 v220, s[12:15], s38 offen offset:0 lds
    buffer_load_dwordx4 v221, s[12:15], s38 offen offset:1024 lds
    buffer_load_dwordx4 v222, s[12:15], s38 offen offset:2048 lds
    buffer_load_dwordx4 v223, s[12:15], s38 offen offset:3072 lds
    s_add_u32 m0, s49, 8192
    s_add_u32 s38, s38, 0x10000
    buffer_load_dwordx4 v220, s[12:15], s38 offen offset:0 lds
    buffer_load_dwordx4 v221, s[12:15], s38 offen offset:1024 lds
    buffer_load_dwordx4 v222, s[12:15], s38 offen offset:2048 lds
    buffer_load_dwordx4 v223, s[12:15], s38 offen offset:3072 lds
F_nl2:
    v_mov_b32 v16, 1
    s_mov_b64 exec, 1
    s_waitcnt vmcnt(0)
    ds_add_u32 v1, v16 offset:24
    s_mov_b64 exec, -1
    s_mov_b32 s54, 0
    s_mov_b32 s55, 0
    s_lshl_b32 s34, s34, 1
    s_mov_b32 s57, 0
    s_lshl_b32 s49, s30, 3
    s_mul_i32 s50, s49, 187
    s_lshr_b32 s50, s50, 11
    s_lshr_b32 s51, s35, 4
    s_mul_i32 s52, s51, 187
    s_lshr_b32 s52, s52, 11
    s_cmp_eq_u32 s50, s52
    s_cselect_b32 s57, 0, 0xffff
    s_add_u32 s49, s49, 7
    s_mul_i32 s50, s49, 187
    s_lshr_b32 s50, s50, 11
    s_add_u32 s51, s51, 1
    s_mul_i32 s52, s51, 187
    s_lshr_b32 s52, s52, 11
    s_cmp_eq_u32 s50, s52
    s_cselect_b32 s50, 0, s39
    s_or_b32 s57, s57, s50
F_sa_7:
    s_andn2_b32 s49, s54, s55
    s_cbranch_scc1 F_sb_8
    ds_read_b32 v8, v1 offset:28
    s_waitcnt lgkmcnt(0)
    v_readfirstlane_b32 s54, v8
    s_nop 0
    s_or_b32 s54, s54, s57
    s_lshr_b32 s50, s54, 16
    s_and_b32 s54, s54, s50
    s_lshr_b32 s50, s54, 1
    s_and_b32 s54, s54, s50
    s_and_b32 s54, s54, 0x5555
    s_branch F_sa_7
F_sb_8:
    s_lshl_b32 s50, s49, 16
    s_or_b32 s49, s49, s50
    s_lshr_b32 s49, s49, s34
    s_ff1_i32_b32 s49, s49
    s_add_u32 s49, s49, s34
    s_and_b32 s49, s49, 15
    s_bitset1_b32 s55, s49
    s_lshl_b32 s38, s49, 11
    s_add_u32 s49, s49, 4
    s_and_b32 s49, s49, 15
    s_lshl_b32 s64, s49, 13
F_sc_9:
    buffer_load_dwordx4 v[96:99], v4, s[20:23], s38 offen offset:0 sc1
    buffer_load_dwordx4 v[100:103], v5, s[20:23], s38 offen offset:0 sc1
    buffer_load_dwordx4 v[104:107], v4, s[20:23], s38 offen offset:1024 sc1
    buffer_load_dwordx4 v[108:111], v5, s[20:23], s38 offen offset:1024 sc1
    buffer_load_dwordx4 v[112:115], v4, s[20:23], s38 offen offset:2048 sc1
    buffer_load_dwordx4 v[116:119], v5, s[20:23], s38 offen offset:2048 sc1
    buffer_load_dwordx4 v[120:123], v4, s[20:23], s38 offen offset:3072 sc1
    buffer_load_dwordx4 v[124:127], v5, s[20:23], s38 offen offset:3072 sc1
F_sa_10:
    s_andn2_b32 s49, s54, s55
    s_cbranch_scc1 F_sb_11
    ds_read_b32 v8, v1 offset:28
    s_waitcnt lgkmcnt(0)
    v_readfirstlane_b32 s54, v8
    s_nop 0
    s_or_b32 s54, s54, s57
    s_lshr_b32 s50, s54, 16
    s_and_b32 s54, s54, s50
    s_lshr_b32 s50, s54, 1
    s_and_b32 s54, s54, s50
    s_and_b32 s54, s54, 0x5555
    s_branch F_sa_10
F_sb_11:
    s_lshl_b32 s50, s49, 16
    s_or_b32 s49, s49, s50
    s_lshr_b32 s49, s49, s34
    s_ff1_i32_b32 s49, s49
    s_add_u32 s49, s49, s34
    s_and_b32 s49, s49, 15
    s_bitset1_b32 s55, s49
    s_lshl_b32 s38, s49, 11
    s_add_u32 s49, s49, 4
    s_and_b32 s49, s49, 15
    s_lshl_b32 s65, s49, 13
F_sc_12:
    buffer_load_dwordx4 v[128:131], v4, s[20:23], s38 offen offset:0 sc1
    buffer_load_dwordx4 v[132:135], v5, s[20:23], s38 offen offset:0 sc1
    buffer_load_dwordx4 v[136:139], v4, s[20:23], s38 offen offset:1024 sc1
    buffer_load_dwordx4 v[140:143], v5, s[20:23], s38 offen offset:1024 sc1
    buffer_load_dwordx4 v[144:147], v4, s[20:23], s38 offen offset:2048 sc1
    buffer_load_dwordx4 v[148:151], v5, s[20:23], s38 offen offset:2048 sc1
    buffer_load_dwordx4 v[152:155], v4, s[20:23], s38 offen offset:3072 sc1
    buffer_load_dwordx4 v[156:159], v5, s[20:23], s38 offen offset:3072 sc1
    v_add_u32 v10, s64, v60
    v_add_u32 v11, s64, v61
    v_add_u32 v12, s64, v62
    v_add_u32 v13, s64, v63
F_sp_13:
    ds_read_b32 v8, v1 offset:24
    s_waitcnt lgkmcnt(0)
    v_readfirstlane_b32 s49, v8
    s_nop 0
    s_cmp_ge_u32 s49, 4
    s_cbranch_scc0 F_sp_13
    ds_read_b64_tr_b16 v[40:41], v10 offset:0
    ds_read_b64_tr_b16 v[42:43], v10 offset:2048
    ds_read_b64_tr_b16 v[44:45], v11 offset:0
    ds_read_b64_tr_b16 v[46:47], v11 offset:2048
    ds_read_b64_tr_b16 v[48:49], v12 offset:0
    ds_read_b64_tr_b16 v[50:51], v12 offset:2048
    ds_read_b64_tr_b16 v[52:53], v13 offset:0
    ds_read_b64_tr_b16 v[54:55], v13 offset:2048
    s_waitcnt lgkmcnt(4)
    ds_read_b64_tr_b16 v[64:65], v10 offset:4096
    ds_read_b64_tr_b16 v[66:67], v10 offset:6144
    ds_read_b64_tr_b16 v[68:69], v11 offset:4096
    ds_read_b64_tr_b16 v[70:71], v11 offset:6144
    ds_read_b64_tr_b16 v[72:73], v12 offset:4096
    ds_read_b64_tr_b16 v[74:75], v12 offset:6144
    ds_read_b64_tr_b16 v[76:77], v13 offset:4096
    ds_read_b64_tr_b16 v[78:79], v13 offset:6144
    v_mov_b32 v9, 1
F_sa_14:
    s_andn2_b32 s49, s54, s55
    s_cbranch_scc0 F_ss_15
    s_lshl_b32 s50, s49, 16
    s_or_b32 s49, s49, s50
    s_lshr_b32 s49, s49, s34
    s_ff1_i32_b32 s49, s49
    s_add_u32 s49, s49, s34
    s_and_b32 s49, s49, 15
    s_bitset1_b32 s55, s49
    s_lshl_b32 s36, s49, 11
    s_add_u32 s49, s49, 4
    s_and_b32 s49, s49, 15
    s_lshl_b32 s66, s49, 13
    s_waitcnt vmcnt(14)
    s_waitcnt lgkmcnt(8)
    v_mfma_f32_16x16x32_bf16 v[224:227], v[40:43], v[96:99], v[224:227]
    ds_read_b64_tr_b16 v[80:81], v10 offset:8192
    v_mfma_f32_16x16x32_bf16 v[240:243], v[40:43], v[100:103], v[240:243]
    ds_read_b64_tr_b16 v[82:83], v10 offset:10240
    v_mfma_f32_16x16x32_bf16 v[228:231], v[44:47], v[96:99], v[228:231]
    ds_read_b64_tr_b16 v[84:85], v11 offset:8192
    buffer_load_dwordx4 v[160:163], v4, s[20:23], s36 offen offset:0 sc1
    v_mfma_f32_16x16x32_bf16 v[244:247], v[44:47], v[100:103], v[244:247]
    ds_read_b64_tr_b16 v[86:87], v11 offset:10240
    v_mfma_f32_16x16x32_bf16 v[232:235], v[48:51], v[96:99], v[232:235]
    ds_read_b64_tr_b16 v[88:89], v12 offset:8192
    v_mfma_f32_16x16x32_bf16 v[248:251], v[48:51], v[100:103], v[248:251]
    ds_read_b64_tr_b16 v[90:91], v12 offset:10240
    v_mfma_f32_16x16x32_bf16 v[236:239], v[52:55], v[96:99], v[236:239]
    ds_read_b64_tr_b16 v[92:93], v13 offset:8192
    buffer_load_dwordx4 v[164:167], v5, s[20:23], s36 offen offset:0 sc1
    v_mfma_f32_16x16x32_bf16 v[252:255], v[52:55], v[100:103], v[252:255]
    ds_read_b64_tr_b16 v[94:95], v13 offset:10240
    s_waitcnt vmcnt(14)
    s_waitcnt lgkmcnt(8)
    v_mfma_f32_16x16x32_bf16 v[224:227], v[64:67], v[104:107], v[224:227]
    ds_read_b64_tr_b16 v[40:41], v10 offset:12288
    v_mfma_f32_16x16x32_bf16 v[240:243], v[64:67], v[108:111], v[240:243]
    ds_read_b64_tr_b16 v[42:43], v10 offset:14336
    v_add_u32 v10, s65, v60
    v_mfma_f32_16x16x32_bf16 v[228:231], v[68:71], v[104:107], v[228:231]
    ds_read_b64_tr_b16 v[44:45], v11 offset:12288
    buffer_load_dwordx4 v[168:171], v4, s[20:23], s36 offen offset:1024 sc1
    v_mfma_f32_16x16x32_bf16 v[244:247], v[68:71], v[108:111], v[244:247]
    ds_read_b64_tr_b16 v[46:47], v11 offset:14336
    v_add_u32 v11, s65, v61
    v_mfma_f32_16x16x32_bf16 v[232:235], v[72:75], v[104:107], v[232:235]
    ds_read_b64_tr_b16 v[48:49], v12 offset:12288
    v_mfma_f32_16x16x32_bf16 v[248:251], v[72:75], v[108:111], v[248:251]
    ds_read_b64_tr_b16 v[50:51], v12 offset:14336
    v_add_u32 v12, s65, v62
    v_mfma_f32_16x16x32_bf16 v[236:239], v[76:79], v[104:107], v[236:239]
    ds_read_b64_tr_b16 v[52:53], v13 offset:12288
    buffer_load_dwordx4 v[172:175], v5, s[20:23], s36 offen offset:1024 sc1
    v_mfma_f32_16x16x32_bf16 v[252:255], v[76:79], v[108:111], v[252:255]
    ds_read_b64_tr_b16 v[54:55], v13 offset:14336
    v_add_u32 v13, s65, v63
    s_waitcnt vmcnt(14)
    s_waitcnt lgkmcnt(8)
    v_mfma_f32_16x16x32_bf16 v[224:227], v[80:83], v[112:115], v[224:227]
    ds_read_b64_tr_b16 v[64:65], v10 offset:0
    v_mfma_f32_16x16x32_bf16 v[240:243], v[80:83], v[116:119], v[240:243]
    ds_read_b64_tr_b16 v[66:67], v10 offset:2048
    v_mfma_f32_16x16x32_bf16 v[228:231], v[84:87], v[112:115], v[228:231]
    ds_read_b64_tr_b16 v[68:69], v11 offset:0
    buffer_load_dwordx4 v[176:179], v4, s[20:23], s36 offen offset:2048 sc1
    v_mfma_f32_16x16x32_bf16 v[244:247], v[84:87], v[116:119], v[244:247]
    ds_read_b64_tr_b16 v[70:71], v11 offset:2048
    v_mfma_f32_16x16x32_bf16 v[232:235], v[88:91], v[112:115], v[232:235]
    ds_read_b64_tr_b16 v[72:73], v12 offset:0
    v_mfma_f32_16x16x32_bf16 v[248:251], v[88:91], v[116:119], v[248:251]
    ds_read_b64_tr_b16 v[74:75], v12 offset:2048
    v_mfma_f32_16x16x32_bf16 v[236:239], v[92:95], v[112:115], v[236:239]
    ds_read_b64_tr_b16 v[76:77], v13 offset:0
    buffer_load_dwordx4 v[180:183], v5, s[20:23], s36 offen offset:2048 sc1
    v_mfma_f32_16x16x32_bf16 v[252:255], v[92:95], v[116:119], v[252:255]
    ds_read_b64_tr_b16 v[78:79], v13 offset:2048
    s_waitcnt vmcnt(14)
    s_waitcnt lgkmcnt(8)
    v_mfma_f32_16x16x32_bf16 v[224:227], v[40:43], v[120:123], v[224:227]
    ds_read_b64_tr_b16 v[80:81], v10 offset:4096
F_sa_16:
    s_andn2_b32 s49, s54, s55
    s_cbranch_scc0 F_ss_17
    v_mfma_f32_16x16x32_bf16 v[240:243], v[40:43], v[124:127], v[240:243]
    ds_read_b64_tr_b16 v[82:83], v10 offset:6144
    s_lshl_b32 s50, s49, 16
    s_or_b32 s49, s49, s50
    v_mfma_f32_16x16x32_bf16 v[228:231], v[44:47], v[120:123], v[228:231]
    ds_read_b64_tr_b16 v[84:85], v11 offset:4096
    buffer_load_dwordx4 v[184:187], v4, s[20:23], s36 offen offset:3072 sc1
    v_mfma_f32_16x16x32_bf16 v[244:247], v[44:47], v[124:127], v[244:247]
    ds_read_b64_tr_b16 v[86:87], v11 offset:6144
    s_lshr_b32 s49, s49, s34
    s_ff1_i32_b32 s49, s49
    v_mfma_f32_16x16x32_bf16 v[232:235], v[48:51], v[120:123], v[232:235]
    ds_read_b64_tr_b16 v[88:89], v12 offset:4096
    s_add_u32 s49, s49, s34
    s_and_b32 s49, s49, 15
    v_mfma_f32_16x16x32_bf16 v[248:251], v[48:51], v[124:127], v[248:251]
    ds_read_b64_tr_b16 v[90:91], v12 offset:6144
    s_bitset1_b32 s55, s49
    s_lshl_b32 s38, s49, 11
    v_mfma_f32_16x16x32_bf16 v[236:239], v[52:55], v[120:123], v[236:239]
    ds_read_b64_tr_b16 v[92:93], v13 offset:4096
    buffer_load_dwordx4 v[188:191], v5, s[20:23], s36 offen offset:3072 sc1
    v_mfma_f32_16x16x32_bf16 v[252:255], v[52:55], v[124:127], v[252:255]
    ds_read_b64_tr_b16 v[94:95], v13 offset:6144
    s_add_u32 s49, s49, 4
    s_and_b32 s49, s49, 15
    s_lshl_b32 s67, s49, 13
    s_waitcnt vmcnt(14)
    s_waitcnt lgkmcnt(8)
    v_mfma_f32_16x16x32_bf16 v[224:227], v[64:67], v[128:131], v[224:227]
    ds_read_b64_tr_b16 v[40:41], v10 offset:8192
    v_mfma_f32_16x16x32_bf16 v[240:243], v[64:67], v[132:135], v[240:243]
    ds_read_b64_tr_b16 v[42:43], v10 offset:10240
    v_mfma_f32_16x16x32_bf16 v[228:231], v[68:71], v[128:131], v[228:231]
    ds_read_b64_tr_b16 v[44:45], v11 offset:8192
    buffer_load_dwordx4 v[192:195], v4, s[20:23], s38 offen offset:0 sc1
    v_mfma_f32_16x16x32_bf16 v[244:247], v[68:71], v[132:135], v[244:247]
    ds_read_b64_tr_b16 v[46:47], v11 offset:10240
    v_mfma_f32_16x16x32_bf16 v[232:235], v[72:75], v[128:131], v[232:235]
    ds_read_b64_tr_b16 v[48:49], v12 offset:8192
    v_mfma_f32_16x16x32_bf16 v[248:251], v[72:75], v[132:135], v[248:251]
    ds_read_b64_tr_b16 v[50:51], v12 offset:10240
    v_mfma_f32_16x16x32_bf16 v[236:239], v[76:79], v[128:131], v[236:239]
    ds_read_b64_tr_b16 v[52:53], v13 offset:8192
    buffer_load_dwordx4 v[196:199], v5, s[20:23], s38 offen offset:0 sc1
    v_mfma_f32_16x16x32_bf16 v[252:255], v[76:79], v[132:135], v[252:255]
    ds_read_b64_tr_b16 v[54:55], v13 offset:10240
    s_waitcnt vmcnt(14)
    s_waitcnt lgkmcnt(8)
    v_mfma_f32_16x16x32_bf16 v[224:227], v[80:83], v[136:139], v[224:227]
    ds_read_b64_tr_b16 v[64:65], v10 offset:12288
    v_mfma_f32_16x16x32_bf16 v[240:243], v[80:83], v[140:143], v[240:243]
    ds_read_b64_tr_b16 v[66:67], v10 offset:14336
    v_add_u32 v10, s66, v60
    v_mfma_f32_16x16x32_bf16 v[228:231], v[84:87], v[136:139], v[228:231]
    ds_read_b64_tr_b16 v[68:69], v11 offset:12288
    buffer_load_dwordx4 v[200:203], v4, s[20:23], s38 offen offset:1024 sc1
    v_mfma_f32_16x16x32_bf16 v[244:247], v[84:87], v[140:143], v[244:247]
    ds_read_b64_tr_b16 v[70:71], v11 offset:14336
    v_add_u32 v11, s66, v61
    v_mfma_f32_16x16x32_bf16 v[232:235], v[88:91], v[136:139], v[232:235]
    ds_read_b64_tr_b16 v[72:73], v12 offset:12288
    v_mfma_f32_16x16x32_bf16 v[248:251], v[88:91], v[140:143], v[248:251]
    ds_read_b64_tr_b16 v[74:75], v12 offset:14336
    v_add_u32 v12, s66, v62
    v_mfma_f32_16x16x32_bf16 v[236:239], v[92:95], v[136:139], v[236:239]
    ds_read_b64_tr_b16 v[76:77], v13 offset:12288
    buffer_load_dwordx4 v[204:207], v5, s[20:23], s38 offen offset:1024 sc1
    v_mfma_f32_16x16x32_bf16 v[252:255], v[92:95], v[140:143], v[252:255]
    ds_read_b64_tr_b16 v[78:79], v13 offset:14336
    v_add_u32 v13, s66, v63
    s_waitcnt vmcnt(14)
    s_waitcnt lgkmcnt(8)
    v_mfma_f32_16x16x32_bf16 v[224:227], v[40:43], v[144:147], v[224:227]
    ds_read_b64_tr_b16 v[80:81], v10 offset:0
    v_mfma_f32_16x16x32_bf16 v[240:243], v[40:43], v[148:151], v[240:243]
    ds_read_b64_tr_b16 v[82:83], v10 offset:2048
    v_mfma_f32_16x16x32_bf16 v[228:231], v[44:47], v[144:147], v[228:231]
    ds_read_b64_tr_b16 v[84:85], v11 offset:0
    buffer_load_dwordx4 v[208:211], v4, s[20:23], s38 offen offset:2048 sc1
    s_mov_b64 exec, 1
    ds_add_u32 v1, v9 offset:0
    s_mov_b64 exec, -1
    v_mfma_f32_16x16x32_bf16 v[244:247], v[44:47], v[148:151], v[244:247]
    ds_read_b64_tr_b16 v[86:87], v11 offset:2048
    v_mfma_f32_16x16x32_bf16 v[232:235], v[48:51], v[144:147], v[232:235]
    ds_read_b64_tr_b16 v[88:89], v12 offset:0
    v_mfma_f32_16x16x32_bf16 v[248:251], v[48:51], v[148:151], v[248:251]
    ds_read_b64_tr_b16 v[90:91], v12 offset:2048
    v_mfma_f32_16x16x32_bf16 v[236:239], v[52:55], v[144:147], v[236:239]
    ds_read_b64_tr_b16 v[92:93], v13 offset:0
    buffer_load_dwordx4 v[212:215], v5, s[20:23], s38 offen offset:2048 sc1
    v_mfma_f32_16x16x32_bf16 v[252:255], v[52:55], v[148:151], v[252:255]
    ds_read_b64_tr_b16 v[94:95], v13 offset:2048
    s_waitcnt vmcnt(14)
    s_waitcnt lgkmcnt(9)
    v_mfma_f32_16x16x32_bf16 v[224:227], v[64:67], v[152:155], v[224:227]
    ds_read_b64_tr_b16 v[40:41], v10 offset:4096
F_sa_18:
    s_andn2_b32 s49, s54, s55
    s_cbranch_scc0 F_ss_19
    v_mfma_f32_16x16x32_bf16 v[240:243], v[64:67], v[156:159], v[240:243]
    ds_read_b64_tr_b16 v[42:43], v10 offset:6144
    s_lshl_b32 s50, s49, 16
    s_or_b32 s49, s49, s50
    v_mfma_f32_16x16x32_bf16 v[228:231], v[68:71], v[152:155], v[228:231]
    ds_read_b64_tr_b16 v[44:45], v11 offset:4096
    buffer_load_dwordx4 v[216:219], v4, s[20:23], s38 offen offset:3072 sc1
    v_mfma_f32_16x16x32_bf16 v[244:247], v[68:71], v[156:159], v[244:247]
    ds_read_b64_tr_b16 v[46:47], v11 offset:6144
    s_lshr_b32 s49, s49, s34
    s_ff1_i32_b32 s49, s49
    v_mfma_f32_16x16x32_bf16 v[232:235], v[72:75], v[152:155], v[232:235]
    ds_read_b64_tr_b16 v[48:49], v12 offset:4096
    s_add_u32 s49, s49, s34
    s_and_b32 s49, s49, 15
    v_mfma_f32_16x16x32_bf16 v[248:251], v[72:75], v[156:159], v[248:251]
    ds_read_b64_tr_b16 v[50:51], v12 offset:6144
    s_bitset1_b32 s55, s49
    s_lshl_b32 s36, s49, 11
    v_mfma_f32_16x16x32_bf16 v[236:239], v[76:79], v[152:155], v[236:239]
    ds_read_b64_tr_b16 v[52:53], v13 offset:4096
    buffer_load_dwordx4 v[220:223], v5, s[20:23], s38 offen offset:3072 sc1
    v_mfma_f32_16x16x32_bf16 v[252:255], v[76:79], v[156:159], v[252:255]
    ds_read_b64_tr_b16 v[54:55], v13 offset:6144
    s_add_u32 s49, s49, 4
    s_and_b32 s49, s49, 15
    s_lshl_b32 s68, s49, 13
    s_waitcnt vmcnt(14)
    s_waitcnt lgkmcnt(8)
    v_mfma_f32_16x16x32_bf16 v[224:227], v[80:83], v[160:163], v[224:227]
    ds_read_b64_tr_b16 v[64:65], v10 offset:8192
    v_mfma_f32_16x16x32_bf16 v[240:243], v[80:83], v[164:167], v[240:243]
    ds_read_b64_tr_b16 v[66:67], v10 offset:10240
    v_mfma_f32_16x16x32_bf16 v[228:231], v[84:87], v[160:163], v[228:231]
    ds_read_b64_tr_b16 v[68:69], v11 offset:8192
    buffer_load_dwordx4 v[96:99], v4, s[20:23], s36 offen offset:0 sc1
    v_mfma_f32_16x16x32_bf16 v[244:247], v[84:87], v[164:167], v[244:247]
    ds_read_b64_tr_b16 v[70:71], v11 offset:10240
    v_mfma_f32_16x16x32_bf16 v[232:235], v[88:91], v[160:163], v[232:235]
    ds_read_b64_tr_b16 v[72:73], v12 offset:8192
    v_mfma_f32_16x16x32_bf16 v[248:251], v[88:91], v[164:167], v[248:251]
    ds_read_b64_tr_b16 v[74:75], v12 offset:10240
    v_mfma_f32_16x16x32_bf16 v[236:239], v[92:95], v[160:163], v[236:239]
    ds_read_b64_tr_b16 v[76:77], v13 offset:8192
    buffer_load_dwordx4 v[100:103], v5, s[20:23], s36 offen offset:0 sc1
    v_mfma_f32_16x16x32_bf16 v[252:255], v[92:95], v[164:167], v[252:255]
    ds_read_b64_tr_b16 v[78:79], v13 offset:10240
    s_waitcnt vmcnt(14)
    s_waitcnt lgkmcnt(8)
    v_mfma_f32_16x16x32_bf16 v[224:227], v[40:43], v[168:171], v[224:227]
    ds_read_b64_tr_b16 v[80:81], v10 offset:12288
    v_mfma_f32_16x16x32_bf16 v[240:243], v[40:43], v[172:175], v[240:243]
    ds_read_b64_tr_b16 v[82:83], v10 offset:14336
    v_add_u32 v10, s67, v60
    v_mfma_f32_16x16x32_bf16 v[228:231], v[44:47], v[168:171], v[228:231]
    ds_read_b64_tr_b16 v[84:85], v11 offset:12288
    buffer_load_dwordx4 v[104:107], v4, s[20:23], s36 offen offset:1024 sc1
    v_mfma_f32_16x16x32_bf16 v[244:247], v[44:47], v[172:175], v[244:247]
    ds_read_b64_tr_b16 v[86:87], v11 offset:14336
    v_add_u32 v11, s67, v61
    v_mfma_f32_16x16x32_bf16 v[232:235], v[48:51], v[168:171], v[232:235]
    ds_read_b64_tr_b16 v[88:89], v12 offset:12288
    v_mfma_f32_16x16x32_bf16 v[248:251], v[48:51], v[172:175], v[248:251]
    ds_read_b64_tr_b16 v[90:91], v12 offset:14336
    v_add_u32 v12, s67, v62
    v_mfma_f32_16x16x32_bf16 v[236:239], v[52:55], v[168:171], v[236:239]
    ds_read_b64_tr_b16 v[92:93], v13 offset:12288
    buffer_load_dwordx4 v[108:111], v5, s[20:23], s36 offen offset:1024 sc1
    v_mfma_f32_16x16x32_bf16 v[252:255], v[52:55], v[172:175], v[252:255]
    ds_read_b64_tr_b16 v[94:95], v13 offset:14336
    v_add_u32 v13, s67, v63
    s_waitcnt vmcnt(14)
    s_waitcnt lgkmcnt(8)
    v_mfma_f32_16x16x32_bf16 v[224:227], v[64:67], v[176:179], v[224:227]
    ds_read_b64_tr_b16 v[40:41], v10 offset:0
    v_mfma_f32_16x16x32_bf16 v[240:243], v[64:67], v[180:183], v[240:243]
    ds_read_b64_tr_b16 v[42:43], v10 offset:2048
    v_mfma_f32_16x16x32_bf16 v[228:231], v[68:71], v[176:179], v[228:231]
    ds_read_b64_tr_b16 v[44:45], v11 offset:0
    buffer_load_dwordx4 v[112:115], v4, s[20:23], s36 offen offset:2048 sc1
    v_mfma_f32_16x16x32_bf16 v[244:247], v[68:71], v[180:183], v[244:247]
    ds_read_b64_tr_b16 v[46:47], v11 offset:2048
    v_mfma_f32_16x16x32_bf16 v[232:235], v[72:75], v[176:179], v[232:235]
    ds_read_b64_tr_b16 v[48:49], v12 offset:0
    v_mfma_f32_16x16x32_bf16 v[248:251], v[72:75], v[180:183], v[248:251]
    ds_read_b64_tr_b16 v[50:51], v12 offset:2048
    v_mfma_f32_16x16x32_bf16 v[236:239], v[76:79], v[176:179], v[236:239]
    ds_read_b64_tr_b16 v[52:53], v13 offset:0
    buffer_load_dwordx4 v[116:119], v5, s[20:23], s36 offen offset:2048 sc1
    v_mfma_f32_16x16x32_bf16 v[252:255], v[76:79], v[180:183], v[252:255]
    ds_read_b64_tr_b16 v[54:55], v13 offset:2048
    s_waitcnt vmcnt(14)
    s_waitcnt lgkmcnt(8)
    v_mfma_f32_16x16x32_bf16 v[224:227], v[80:83], v[184:187], v[224:227]
    ds_read_b64_tr_b16 v[64:65], v10 offset:4096
F_sa_20:
    s_andn2_b32 s49, s54, s55
    s_cbranch_scc0 F_ss_21
    v_mfma_f32_16x16x32_bf16 v[240:243], v[80:83], v[188:191], v[240:243]
    ds_read_b64_tr_b16 v[66:67], v10 offset:6144
    s_lshl_b32 s50, s49, 16
    s_or_b32 s49, s49, s50
    v_mfma_f32_16x16x32_bf16 v[228:231], v[84:87], v[184:187], v[228:231]
    ds_read_b64_tr_b16 v[68:69], v11 offset:4096
    buffer_load_dwordx4 v[120:123], v4, s[20:23], s36 offen offset:3072 sc1
    v_mfma_f32_16x16x32_bf16 v[244:247], v[84:87], v[188:191], v[244:247]
    ds_read_b64_tr_b16 v[70:71], v11 offset:6144
    s_lshr_b32 s49, s49, s34
    s_ff1_i32_b32 s49, s49
    v_mfma_f32_16x16x32_bf16 v[232:235], v[88:91], v[184:187], v[232:235]
    ds_read_b64_tr_b16 v[72:73], v12 offset:4096
    s_add_u32 s49, s49, s34
    s_and_b32 s49, s49, 15
    v_mfma_f32_16x16x32_bf16 v[248:251], v[88:91], v[188:191], v[248:251]
    ds_read_b64_tr_b16 v[74:75], v12 offset:6144
    s_bitset1_b32 s55, s49
    s_lshl_b32 s38, s49, 11
    v_mfma_f32_16x16x32_bf16 v[236:239], v[92:95], v[184:187], v[236:239]
    ds_read_b64_tr_b16 v[76:77], v13 offset:4096
    buffer_load_dwordx4 v[124:127], v5, s[20:23], s36 offen offset:3072 sc1
    v_mfma_f32_16x16x32_bf16 v[252:255], v[92:95], v[188:191], v[252:255]
    ds_read_b64_tr_b16 v[78:79], v13 offset:6144
    s_add_u32 s49, s49, 4
    s_and_b32 s49, s49, 15
    s_lshl_b32 s69, s49, 13
    s_waitcnt vmcnt(14)
    s_waitcnt lgkmcnt(8)
    v_mfma_f32_16x16x32_bf16 v[224:227], v[40:43], v[192:195], v[224:227]
    ds_read_b64_tr_b16 v[80:81], v10 offset:8192
    v_mfma_f32_16x16x32_bf16 v[240:243], v[40:43], v[196:199], v[240:243]
    ds_read_b64_tr_b16 v[82:83], v10 offset:10240
    v_mfma_f32_16x16x32_bf16 v[228:231], v[44:47], v[192:195], v[228:231]
    ds_read_b64_tr_b16 v[84:85], v11 offset:8192
    buffer_load_dwordx4 v[128:131], v4, s[20:23], s38 offen offset:0 sc1
    v_mfma_f32_16x16x32_bf16 v[244:247], v[44:47], v[196:199], v[244:247]
    ds_read_b64_tr_b16 v[86:87], v11 offset:10240
    v_mfma_f32_16x16x32_bf16 v[232:235], v[48:51], v[192:195], v[232:235]
    ds_read_b64_tr_b16 v[88:89], v12 offset:8192
    v_mfma_f32_16x16x32_bf16 v[248:251], v[48:51], v[196:199], v[248:251]
    ds_read_b64_tr_b16 v[90:91], v12 offset:10240
    v_mfma_f32_16x16x32_bf16 v[236:239], v[52:55], v[192:195], v[236:239]
    ds_read_b64_tr_b16 v[92:93], v13 offset:8192
    buffer_load_dwordx4 v[132:135], v5, s[20:23], s38 offen offset:0 sc1
    v_mfma_f32_16x16x32_bf16 v[252:255], v[52:55], v[196:199], v[252:255]
    ds_read_b64_tr_b16 v[94:95], v13 offset:10240
    s_waitcnt vmcnt(14)
    s_waitcnt lgkmcnt(8)
    v_mfma_f32_16x16x32_bf16 v[224:227], v[64:67], v[200:203], v[224:227]
    ds_read_b64_tr_b16 v[40:41], v10 offset:12288
    v_mfma_f32_16x16x32_bf16 v[240:243], v[64:67], v[204:207], v[240:243]
    ds_read_b64_tr_b16 v[42:43], v10 offset:14336
    v_add_u32 v10, s68, v60
    v_mfma_f32_16x16x32_bf16 v[228:231], v[68:71], v[200:203], v[228:231]
    ds_read_b64_tr_b16 v[44:45], v11 offset:12288
    buffer_load_dwordx4 v[136:139], v4, s[20:23], s38 offen offset:1024 sc1
    v_mfma_f32_16x16x32_bf16 v[244:247], v[68:71], v[204:207], v[244:247]
    ds_read_b64_tr_b16 v[46:47], v11 offset:14336
    v_add_u32 v11, s68, v61
    v_mfma_f32_16x16x32_bf16 v[232:235], v[72:75], v[200:203], v[232:235]
    ds_read_b64_tr_b16 v[48:49], v12 offset:12288
    v_mfma_f32_16x16x32_bf16 v[248:251], v[72:75], v[204:207], v[248:251]
    ds_read_b64_tr_b16 v[50:51], v12 offset:14336
    v_add_u32 v12, s68, v62
    v_mfma_f32_16x16x32_bf16 v[236:239], v[76:79], v[200:203], v[236:239]
    ds_read_b64_tr_b16 v[52:53], v13 offset:12288
    buffer_load_dwordx4 v[140:143], v5, s[20:23], s38 offen offset:1024 sc1
    v_mfma_f32_16x16x32_bf16 v[252:255], v[76:79], v[204:207], v[252:255]
    ds_read_b64_tr_b16 v[54:55], v13 offset:14336
    v_add_u32 v13, s68, v63
    s_waitcnt vmcnt(14)
    s_waitcnt lgkmcnt(8)
    v_mfma_f32_16x16x32_bf16 v[224:227], v[80:83], v[208:211], v[224:227]
    ds_read_b64_tr_b16 v[64:65], v10 offset:0
    v_mfma_f32_16x16x32_bf16 v[240:243], v[80:83], v[212:215], v[240:243]
    ds_read_b64_tr_b16 v[66:67], v10 offset:2048
    v_mfma_f32_16x16x32_bf16 v[228:231], v[84:87], v[208:211], v[228:231]
    ds_read_b64_tr_b16 v[68:69], v11 offset:0
    buffer_load_dwordx4 v[144:147], v4, s[20:23], s38 offen offset:2048 sc1
    s_mov_b64 exec, 1
    ds_add_u32 v1, v9 offset:0
    s_mov_b64 exec, -1
    v_mfma_f32_16x16x32_bf16 v[244:247], v[84:87], v[212:215], v[244:247]
    ds_read_b64_tr_b16 v[70:71], v11 offset:2048
    v_mfma_f32_16x16x32_bf16 v[232:235], v[88:91], v[208:211], v[232:235]
    ds_read_b64_tr_b16 v[72:73], v12 offset:0
    v_mfma_f32_16x16x32_bf16 v[248:251], v[88:91], v[212:215], v[248:251]
    ds_read_b64_tr_b16 v[74:75], v12 offset:2048
    v_mfma_f32_16x16x32_bf16 v[236:239], v[92:95], v[208:211], v[236:239]
    ds_read_b64_tr_b16 v[76:77], v13 offset:0
    buffer_load_dwordx4 v[148:151], v5, s[20:23], s38 offen offset:2048 sc1
    v_mfma_f32_16x16x32_bf16 v[252:255], v[92:95], v[212:215], v[252:255]
    ds_read_b64_tr_b16 v[78:79], v13 offset:2048
    s_waitcnt vmcnt(14)
    s_waitcnt lgkmcnt(9)
    v_mfma_f32_16x16x32_bf16 v[224:227], v[40:43], v[216:219], v[224:227]
    ds_read_b64_tr_b16 v[80:81], v10 offset:4096
F_sa_22:
    s_andn2_b32 s49, s54, s55
    s_cbranch_scc0 F_ss_23
    v_mfma_f32_16x16x32_bf16 v[240:243], v[40:43], v[220:223], v[240:243]
    ds_read_b64_tr_b16 v[82:83], v10 offset:6144
    s_lshl_b32 s50, s49, 16
    s_or_b32 s49, s49, s50
    v_mfma_f32_16x16x32_bf16 v[228:231], v[44:47], v[216:219], v[228:231]
    ds_read_b64_tr_b16 v[84:85], v11 offset:4096
    buffer_load_dwordx4 v[152:155], v4, s[20:23], s38 offen offset:3072 sc1
    v_mfma_f32_16x16x32_bf16 v[244:247], v[44:47], v[220:223], v[244:247]
    ds_read_b64_tr_b16 v[86:87], v11 offset:6144
    s_lshr_b32 s49, s49, s34
    s_ff1_i32_b32 s49, s49
    v_mfma_f32_16x16x32_bf16 v[232:235], v[48:51], v[216:219], v[232:235]
    ds_read_b64_tr_b16 v[88:89], v12 offset:4096
    s_add_u32 s49, s49, s34
    s_and_b32 s49, s49, 15
    v_mfma_f32_16x16x32_bf16 v[248:251], v[48:51], v[220:223], v[248:251]
    ds_read_b64_tr_b16 v[90:91], v12 offset:6144
    s_bitset1_b32 s55, s49
    s_lshl_b32 s36, s49, 11
    v_mfma_f32_16x16x32_bf16 v[236:239], v[52:55], v[216:219], v[236:239]
    ds_read_b64_tr_b16 v[92:93], v13 offset:4096
    buffer_load_dwordx4 v[156:159], v5, s[20:23], s38 offen offset:3072 sc1
    v_mfma_f32_16x16x32_bf16 v[252:255], v[52:55], v[220:223], v[252:255]
    ds_read_b64_tr_b16 v[94:95], v13 offset:6144
    s_add_u32 s49, s49, 4
    s_and_b32 s49, s49, 15
    s_lshl_b32 s70, s49, 13
    s_waitcnt vmcnt(14)
    s_waitcnt lgkmcnt(8)
    v_mfma_f32_16x16x32_bf16 v[224:227], v[64:67], v[96:99], v[224:227]
    ds_read_b64_tr_b16 v[40:41], v10 offset:8192
    v_mfma_f32_16x16x32_bf16 v[240:243], v[64:67], v[100:103], v[240:243]
    ds_read_b64_tr_b16 v[42:43], v10 offset:10240
    v_mfma_f32_16x16x32_bf16 v[228:231], v[68:71], v[96:99], v[228:231]
    ds_read_b64_tr_b16 v[44:45], v11 offset:8192
    buffer_load_dwordx4 v[160:163], v4, s[20:23], s36 offen offset:0 sc1
    v_mfma_f32_16x16x32_bf16 v[244:247], v[68:71], v[100:103], v[244:247]
    ds_read_b64_tr_b16 v[46:47], v11 offset:10240
    v_mfma_f32_16x16x32_bf16 v[232:235], v[72:75], v[96:99], v[232:235]
    ds_read_b64_tr_b16 v[48:49], v12 offset:8192
    v_mfma_f32_16x16x32_bf16 v[248:251], v[72:75], v[100:103], v[248:251]
    ds_read_b64_tr_b16 v[50:51], v12 offset:10240
    v_mfma_f32_16x16x32_bf16 v[236:239], v[76:79], v[96:99], v[236:239]
    ds_read_b64_tr_b16 v[52:53], v13 offset:8192
    buffer_load_dwordx4 v[164:167], v5, s[20:23], s36 offen offset:0 sc1
    v_mfma_f32_16x16x32_bf16 v[252:255], v[76:79], v[100:103], v[252:255]
    ds_read_b64_tr_b16 v[54:55], v13 offset:10240
    s_waitcnt vmcnt(14)
    s_waitcnt lgkmcnt(8)
    v_mfma_f32_16x16x32_bf16 v[224:227], v[80:83], v[104:107], v[224:227]
    ds_read_b64_tr_b16 v[64:65], v10 offset:12288
    v_mfma_f32_16x16x32_bf16 v[240:243], v[80:83], v[108:111], v[240:243]
    ds_read_b64_tr_b16 v[66:67], v10 offset:14336
    v_add_u32 v10, s69, v60
    v_mfma_f32_16x16x32_bf16 v[228:231], v[84:87], v[104:107], v[228:231]
    ds_read_b64_tr_b16 v[68:69], v11 offset:12288
    buffer_load_dwordx4 v[168:171], v4, s[20:23], s36 offen offset:1024 sc1
    v_mfma_f32_16x16x32_bf16 v[244:247], v[84:87], v[108:111], v[244:247]
    ds_read_b64_tr_b16 v[70:71], v11 offset:14336
    v_add_u32 v11, s69, v61
    v_mfma_f32_16x16x32_bf16 v[232:235], v[88:91], v[104:107], v[232:235]
    ds_read_b64_tr_b16 v[72:73], v12 offset:12288
    v_mfma_f32_16x16x32_bf16 v[248:251], v[88:91], v[108:111], v[248:251]
    ds_read_b64_tr_b16 v[74:75], v12 offset:14336
    v_add_u32 v12, s69, v62
    v_mfma_f32_16x16x32_bf16 v[236:239], v[92:95], v[104:107], v[236:239]
    ds_read_b64_tr_b16 v[76:77], v13 offset:12288
    buffer_load_dwordx4 v[172:175], v5, s[20:23], s36 offen offset:1024 sc1
    v_mfma_f32_16x16x32_bf16 v[252:255], v[92:95], v[108:111], v[252:255]
    ds_read_b64_tr_b16 v[78:79], v13 offset:14336
    v_add_u32 v13, s69, v63
    s_waitcnt vmcnt(14)
    s_waitcnt lgkmcnt(8)
    v_mfma_f32_16x16x32_bf16 v[224:227], v[40:43], v[112:115], v[224:227]
    ds_read_b64_tr_b16 v[80:81], v10 offset:0
    v_mfma_f32_16x16x32_bf16 v[240:243], v[40:43], v[116:119], v[240:243]
    ds_read_b64_tr_b16 v[82:83], v10 offset:2048
    v_mfma_f32_16x16x32_bf16 v[228:231], v[44:47], v[112:115], v[228:231]
    ds_read_b64_tr_b16 v[84:85], v11 offset:0
    buffer_load_dwordx4 v[176:179], v4, s[20:23], s36 offen offset:2048 sc1
    v_mfma_f32_16x16x32_bf16 v[244:247], v[44:47], v[116:119], v[244:247]
    ds_read_b64_tr_b16 v[86:87], v11 offset:2048
    v_mfma_f32_16x16x32_bf16 v[232:235], v[48:51], v[112:115], v[232:235]
    ds_read_b64_tr_b16 v[88:89], v12 offset:0
    v_mfma_f32_16x16x32_bf16 v[248:251], v[48:51], v[116:119], v[248:251]
    ds_read_b64_tr_b16 v[90:91], v12 offset:2048
    v_mfma_f32_16x16x32_bf16 v[236:239], v[52:55], v[112:115], v[236:239]
    ds_read_b64_tr_b16 v[92:93], v13 offset:0
    buffer_load_dwordx4 v[180:183], v5, s[20:23], s36 offen offset:2048 sc1
    v_mfma_f32_16x16x32_bf16 v[252:255], v[52:55], v[116:119], v[252:255]
    ds_read_b64_tr_b16 v[94:95], v13 offset:2048
    s_waitcnt vmcnt(14)
    s_waitcnt lgkmcnt(8)
    v_mfma_f32_16x16x32_bf16 v[224:227], v[64:67], v[120:123], v[224:227]
    ds_read_b64_tr_b16 v[40:41], v10 offset:4096
F_sa_24:
    s_andn2_b32 s49, s54, s55
    s_cbranch_scc0 F_ss_25
    v_mfma_f32_16x16x32_bf16 v[240:243], v[64:67], v[124:127], v[240:243]
    ds_read_b64_tr_b16 v[42:43], v10 offset:6144
    s_lshl_b32 s50, s49, 16
    s_or_b32 s49, s49, s50
    v_mfma_f32_16x16x32_bf16 v[228:231], v[68:71], v[120:123], v[228:231]
    ds_read_b64_tr_b16 v[44:45], v11 offset:4096
    buffer_load_dwordx4 v[184:187], v4, s[20:23], s36 offen offset:3072 sc1
    v_mfma_f32_16x16x32_bf16 v[244:247], v[68:71], v[124:127], v[244:247]
    ds_read_b64_tr_b16 v[46:47], v11 offset:6144
    s_lshr_b32 s49, s49, s34
    s_ff1_i32_b32 s49, s49
    v_mfma_f32_16x16x32_bf16 v[232:235], v[72:75], v[120:123], v[232:235]
    ds_read_b64_tr_b16 v[48:49], v12 offset:4096
    s_add_u32 s49, s49, s34
    s_and_b32 s49, s49, 15
    v_mfma_f32_16x16x32_bf16 v[248:251], v[72:75], v[124:127], v[248:251]
    ds_read_b64_tr_b16 v[50:51], v12 offset:6144
    s_bitset1_b32 s55, s49
    s_lshl_b32 s38, s49, 11
    v_mfma_f32_16x16x32_bf16 v[236:239], v[76:79], v[120:123], v[236:239]
    ds_read_b64_tr_b16 v[52:53], v13 offset:4096
    buffer_load_dwordx4 v[188:191], v5, s[20:23], s36 offen offset:3072 sc1
    v_mfma_f32_16x16x32_bf16 v[252:255], v[76:79], v[124:127], v[252:255]
    ds_read_b64_tr_b16 v[54:55], v13 offset:6144
    s_add_u32 s49, s49, 4
    s_and_b32 s49, s49, 15
    s_lshl_b32 s71, s49, 13
    s_waitcnt vmcnt(14)
    s_waitcnt lgkmcnt(8)
    v_mfma_f32_16x16x32_bf16 v[224:227], v[80:83], v[128:131], v[224:227]
    ds_read_b64_tr_b16 v[64:65], v10 offset:8192
    v_mfma_f32_16x16x32_bf16 v[240:243], v[80:83], v[132:135], v[240:243]
    ds_read_b64_tr_b16 v[66:67], v10 offset:10240
    v_mfma_f32_16x16x32_bf16 v[228:231], v[84:87], v[128:131], v[228:231]
    ds_read_b64_tr_b16 v[68:69], v11 offset:8192
    buffer_load_dwordx4 v[192:195], v4, s[20:23], s38 offen offset:0 sc1
    v_mfma_f32_16x16x32_bf16 v[244:247], v[84:87], v[132:135], v[244:247]
    ds_read_b64_tr_b16 v[70:71], v11 offset:10240
    v_mfma_f32_16x16x32_bf16 v[232:235], v[88:91], v[128:131], v[232:235]
    ds_read_b64_tr_b16 v[72:73], v12 offset:8192
    v_mfma_f32_16x16x32_bf16 v[248:251], v[88:91], v[132:135], v[248:251]
    ds_read_b64_tr_b16 v[74:75], v12 offset:10240
    v_mfma_f32_16x16x32_bf16 v[236:239], v[92:95], v[128:131], v[236:239]
    ds_read_b64_tr_b16 v[76:77], v13 offset:8192
    buffer_load_dwordx4 v[196:199], v5, s[20:23], s38 offen offset:0 sc1
    v_mfma_f32_16x16x32_bf16 v[252:255], v[92:95], v[132:135], v[252:255]
    ds_read_b64_tr_b16 v[78:79], v13 offset:10240
    s_waitcnt vmcnt(14)
    s_waitcnt lgkmcnt(8)
    v_mfma_f32_16x16x32_bf16 v[224:227], v[40:43], v[136:139], v[224:227]
    ds_read_b64_tr_b16 v[80:81], v10 offset:12288
    v_mfma_f32_16x16x32_bf16 v[240:243], v[40:43], v[140:143], v[240:243]
    ds_read_b64_tr_b16 v[82:83], v10 offset:14336
    v_add_u32 v10, s70, v60
    v_mfma_f32_16x16x32_bf16 v[228:231], v[44:47], v[136:139], v[228:231]
    ds_read_b64_tr_b16 v[84:85], v11 offset:12288
    buffer_load_dwordx4 v[200:203], v4, s[20:23], s38 offen offset:1024 sc1
    v_mfma_f32_16x16x32_bf16 v[244:247], v[44:47], v[140:143], v[244:247]
    ds_read_b64_tr_b16 v[86:87], v11 offset:14336
    v_add_u32 v11, s70, v61
    v_mfma_f32_16x16x32_bf16 v[232:235], v[48:51], v[136:139], v[232:235]
    ds_read_b64_tr_b16 v[88:89], v12 offset:12288
    v_mfma_f32_16x16x32_bf16 v[248:251], v[48:51], v[140:143], v[248:251]
    ds_read_b64_tr_b16 v[90:91], v12 offset:14336
    v_add_u32 v12, s70, v62
    v_mfma_f32_16x16x32_bf16 v[236:239], v[52:55], v[136:139], v[236:239]
    ds_read_b64_tr_b16 v[92:93], v13 offset:12288
    buffer_load_dwordx4 v[204:207], v5, s[20:23], s38 offen offset:1024 sc1
    v_mfma_f32_16x16x32_bf16 v[252:255], v[52:55], v[140:143], v[252:255]
    ds_read_b64_tr_b16 v[94:95], v13 offset:14336
    v_add_u32 v13, s70, v63
    s_waitcnt vmcnt(14)
    s_waitcnt lgkmcnt(8)
    v_mfma_f32_16x16x32_bf16 v[224:227], v[64:67], v[144:147], v[224:227]
    ds_read_b64_tr_b16 v[40:41], v10 offset:0
    v_mfma_f32_16x16x32_bf16 v[240:243], v[64:67], v[148:151], v[240:243]
    ds_read_b64_tr_b16 v[42:43], v10 offset:2048
    v_mfma_f32_16x16x32_bf16 v[228:231], v[68:71], v[144:147], v[228:231]
    ds_read_b64_tr_b16 v[44:45], v11 offset:0
    buffer_load_dwordx4 v[208:211], v4, s[20:23], s38 offen offset:2048 sc1
    v_mfma_f32_16x16x32_bf16 v[244:247], v[68:71], v[148:151], v[244:247]
    ds_read_b64_tr_b16 v[46:47], v11 offset:2048
    v_mfma_f32_16x16x32_bf16 v[232:235], v[72:75], v[144:147], v[232:235]
    ds_read_b64_tr_b16 v[48:49], v12 offset:0
    v_mfma_f32_16x16x32_bf16 v[248:251], v[72:75], v[148:151], v[248:251]
    ds_read_b64_tr_b16 v[50:51], v12 offset:2048
    v_mfma_f32_16x16x32_bf16 v[236:239], v[76:79], v[144:147], v[236:239]
    ds_read_b64_tr_b16 v[52:53], v13 offset:0
    buffer_load_dwordx4 v[212:215], v5, s[20:23], s38 offen offset:2048 sc1
    v_mfma_f32_16x16x32_bf16 v[252:255], v[76:79], v[148:151], v[252:255]
    ds_read_b64_tr_b16 v[54:55], v13 offset:2048
    s_waitcnt vmcnt(14)
    s_waitcnt lgkmcnt(8)
    v_mfma_f32_16x16x32_bf16 v[224:227], v[80:83], v[152:155], v[224:227]
    ds_read_b64_tr_b16 v[64:65], v10 offset:4096
    v_mfma_f32_16x16x32_bf16 v[240:243], v[80:83], v[156:159], v[240:243]
    ds_read_b64_tr_b16 v[66:67], v10 offset:6144
    v_mfma_f32_16x16x32_bf16 v[228:231], v[84:87], v[152:155], v[228:231]
    ds_read_b64_tr_b16 v[68:69], v11 offset:4096
    buffer_load_dwordx4 v[216:219], v4, s[20:23], s38 offen offset:3072 sc1
    v_mfma_f32_16x16x32_bf16 v[244:247], v[84:87], v[156:159], v[244:247]
    ds_read_b64_tr_b16 v[70:71], v11 offset:6144
    v_mfma_f32_16x16x32_bf16 v[232:235], v[88:91], v[152:155], v[232:235]
    ds_read_b64_tr_b16 v[72:73], v12 offset:4096
    v_mfma_f32_16x16x32_bf16 v[248:251], v[88:91], v[156:159], v[248:251]
    ds_read_b64_tr_b16 v[74:75], v12 offset:6144
    v_mfma_f32_16x16x32_bf16 v[236:239], v[92:95], v[152:155], v[236:239]
    ds_read_b64_tr_b16 v[76:77], v13 offset:4096
    buffer_load_dwordx4 v[220:223], v5, s[20:23], s38 offen offset:3072 sc1
    v_mfma_f32_16x16x32_bf16 v[252:255], v[92:95], v[156:159], v[252:255]
    ds_read_b64_tr_b16 v[78:79], v13 offset:6144
    s_waitcnt vmcnt(14)
    s_waitcnt lgkmcnt(8)
    v_mfma_f32_16x16x32_bf16 v[224:227], v[40:43], v[160:163], v[224:227]
    ds_read_b64_tr_b16 v[80:81], v10 offset:8192
    v_mfma_f32_16x16x32_bf16 v[240:243], v[40:43], v[164:167], v[240:243]
    ds_read_b64_tr_b16 v[82:83], v10 offset:10240
    v_mfma_f32_16x16x32_bf16 v[228:231], v[44:47], v[160:163], v[228:231]
    ds_read_b64_tr_b16 v[84:85], v11 offset:8192
    v_mfma_f32_16x16x32_bf16 v[244:247], v[44:47], v[164:167], v[244:247]
    ds_read_b64_tr_b16 v[86:87], v11 offset:10240
    v_mfma_f32_16x16x32_bf16 v[232:235], v[48:51], v[160:163], v[232:235]
    ds_read_b64_tr_b16 v[88:89], v12 offset:8192
    v_mfma_f32_16x16x32_bf16 v[248:251], v[48:51], v[164:167], v[248:251]
    ds_read_b64_tr_b16 v[90:91], v12 offset:10240
    v_mfma_f32_16x16x32_bf16 v[236:239], v[52:55], v[160:163], v[236:239]
    ds_read_b64_tr_b16 v[92:93], v13 offset:8192
    v_mfma_f32_16x16x32_bf16 v[252:255], v[52:55], v[164:167], v[252:255]
    ds_read_b64_tr_b16 v[94:95], v13 offset:10240
    s_waitcnt vmcnt(12)
    s_waitcnt lgkmcnt(8)
    v_mfma_f32_16x16x32_bf16 v[224:227], v[64:67], v[168:171], v[224:227]
    ds_read_b64_tr_b16 v[40:41], v10 offset:12288
    v_mfma_f32_16x16x32_bf16 v[240:243], v[64:67], v[172:175], v[240:243]
    ds_read_b64_tr_b16 v[42:43], v10 offset:14336
    v_add_u32 v10, s71, v60
    v_mfma_f32_16x16x32_bf16 v[228:231], v[68:71], v[168:171], v[228:231]
    ds_read_b64_tr_b16 v[44:45], v11 offset:12288
    v_mfma_f32_16x16x32_bf16 v[244:247], v[68:71], v[172:175], v[244:247]
    ds_read_b64_tr_b16 v[46:47], v11 offset:14336
    v_add_u32 v11, s71, v61
    v_mfma_f32_16x16x32_bf16 v[232:235], v[72:75], v[168:171], v[232:235]
    ds_read_b64_tr_b16 v[48:49], v12 offset:12288
    v_mfma_f32_16x16x32_bf16 v[248:251], v[72:75], v[172:175], v[248:251]
    ds_read_b64_tr_b16 v[50:51], v12 offset:14336
    v_add_u32 v12, s71, v62
    v_mfma_f32_16x16x32_bf16 v[236:239], v[76:79], v[168:171], v[236:239]
    ds_read_b64_tr_b16 v[52:53], v13 offset:12288
    v_mfma_f32_16x16x32_bf16 v[252:255], v[76:79], v[172:175], v[252:255]
    ds_read_b64_tr_b16 v[54:55], v13 offset:14336
    v_add_u32 v13, s71, v63
    s_waitcnt vmcnt(10)
    s_waitcnt lgkmcnt(8)
    v_mfma_f32_16x16x32_bf16 v[224:227], v[80:83], v[176:179], v[224:227]
    ds_read_b64_tr_b16 v[64:65], v10 offset:0
    v_mfma_f32_16x16x32_bf16 v[240:243], v[80:83], v[180:183], v[240:243]
    ds_read_b64_tr_b16 v[66:67], v10 offset:2048
    v_mfma_f32_16x16x32_bf16 v[228:231], v[84:87], v[176:179], v[228:231]
    ds_read_b64_tr_b16 v[68:69], v11 offset:0
    v_mfma_f32_16x16x32_bf16 v[244:247], v[84:87], v[180:183], v[244:247]
    ds_read_b64_tr_b16 v[70:71], v11 offset:2048
    v_mfma_f32_16x16x32_bf16 v[232:235], v[88:91], v[176:179], v[232:235]
    ds_read_b64_tr_b16 v[72:73], v12 offset:0
    v_mfma_f32_16x16x32_bf16 v[248:251], v[88:91], v[180:183], v[248:251]
    ds_read_b64_tr_b16 v[74:75], v12 offset:2048
    v_mfma_f32_16x16x32_bf16 v[236:239], v[92:95], v[176:179], v[236:239]
    ds_read_b64_tr_b16 v[76:77], v13 offset:0
    v_mfma_f32_16x16x32_bf16 v[252:255], v[92:95], v[180:183], v[252:255]
    ds_read_b64_tr_b16 v[78:79], v13 offset:2048
    s_waitcnt vmcnt(8)
    s_waitcnt lgkmcnt(8)
    v_mfma_f32_16x16x32_bf16 v[224:227], v[40:43], v[184:187], v[224:227]
    ds_read_b64_tr_b16 v[80:81], v10 offset:4096
    v_mfma_f32_16x16x32_bf16 v[240:243], v[40:43], v[188:191], v[240:243]
    ds_read_b64_tr_b16 v[82:83], v10 offset:6144
    v_mfma_f32_16x16x32_bf16 v[228:231], v[44:47], v[184:187], v[228:231]
    ds_read_b64_tr_b16 v[84:85], v11 offset:4096
    v_mfma_f32_16x16x32_bf16 v[244:247], v[44:47], v[188:191], v[244:247]
    ds_read_b64_tr_b16 v[86:87], v11 offset:6144
    v_mfma_f32_16x16x32_bf16 v[232:235], v[48:51], v[184:187], v[232:235]
    ds_read_b64_tr_b16 v[88:89], v12 offset:4096
    v_mfma_f32_16x16x32_bf16 v[248:251], v[48:51], v[188:191], v[248:251]
    ds_read_b64_tr_b16 v[90:91], v12 offset:6144
    v_mfma_f32_16x16x32_bf16 v[236:239], v[52:55], v[184:187], v[236:239]
    ds_read_b64_tr_b16 v[92:93], v13 offset:4096
    v_mfma_f32_16x16x32_bf16 v[252:255], v[52:55], v[188:191], v[252:255]
    ds_read_b64_tr_b16 v[94:95], v13 offset:6144
    s_waitcnt vmcnt(6)
    s_waitcnt lgkmcnt(8)
    v_mfma_f32_16x16x32_bf16 v[224:227], v[64:67], v[192:195], v[224:227]
    ds_read_b64_tr_b16 v[40:41], v10 offset:8192
    v_mfma_f32_16x16x32_bf16 v[240:243], v[64:67], v[196:199], v[240:243]
    ds_read_b64_tr_b16 v[42:43], v10 offset:10240
    v_mfma_f32_16x16x32_bf16 v[228:231], v[68:71], v[192:195], v[228:231]
    ds_read_b64_tr_b16 v[44:45], v11 offset:8192
    v_mfma_f32_16x16x32_bf16 v[244:247], v[68:71], v[196:199], v[244:247]
    ds_read_b64_tr_b16 v[46:47], v11 offset:10240
    v_mfma_f32_16x16x32_bf16 v[232:235], v[72:75], v[192:195], v[232:235]
    ds_read_b64_tr_b16 v[48:49], v12 offset:8192
    v_mfma_f32_16x16x32_bf16 v[248:251], v[72:75], v[196:199], v[248:251]
    ds_read_b64_tr_b16 v[50:51], v12 offset:10240
    v_mfma_f32_16x16x32_bf16 v[236:239], v[76:79], v[192:195], v[236:239]
    ds_read_b64_tr_b16 v[52:53], v13 offset:8192
    v_mfma_f32_16x16x32_bf16 v[252:255], v[76:79], v[196:199], v[252:255]
    ds_read_b64_tr_b16 v[54:55], v13 offset:10240
    s_waitcnt vmcnt(4)
    s_waitcnt lgkmcnt(8)
    v_mfma_f32_16x16x32_bf16 v[224:227], v[80:83], v[200:203], v[224:227]
    ds_read_b64_tr_b16 v[64:65], v10 offset:12288
    ds_read_b32 v8, v1 offset:32
    v_mfma_f32_16x16x32_bf16 v[240:243], v[80:83], v[204:207], v[240:243]
    ds_read_b64_tr_b16 v[66:67], v10 offset:14336
    v_mfma_f32_16x16x32_bf16 v[228:231], v[84:87], v[200:203], v[228:231]
    ds_read_b64_tr_b16 v[68:69], v11 offset:12288
    v_mfma_f32_16x16x32_bf16 v[244:247], v[84:87], v[204:207], v[244:247]
    ds_read_b64_tr_b16 v[70:71], v11 offset:14336
    v_mfma_f32_16x16x32_bf16 v[232:235], v[88:91], v[200:203], v[232:235]
    ds_read_b64_tr_b16 v[72:73], v12 offset:12288
    v_mfma_f32_16x16x32_bf16 v[248:251], v[88:91], v[204:207], v[248:251]
    ds_read_b64_tr_b16 v[74:75], v12 offset:14336
    v_mfma_f32_16x16x32_bf16 v[236:239], v[92:95], v[200:203], v[236:239]
    ds_read_b64_tr_b16 v[76:77], v13 offset:12288
    v_mfma_f32_16x16x32_bf16 v[252:255], v[92:95], v[204:207], v[252:255]
    ds_read_b64_tr_b16 v[78:79], v13 offset:14336
    s_waitcnt vmcnt(2)
    s_waitcnt lgkmcnt(9)
    v_mfma_f32_16x16x32_bf16 v[224:227], v[40:43], v[208:211], v[224:227]
    v_mfma_f32_16x16x32_bf16 v[240:243], v[40:43], v[212:215], v[240:243]
    s_waitcnt lgkmcnt(7)
    v_readfirstlane_b32 s49, v8
    v_mfma_f32_16x16x32_bf16 v[228:231], v[44:47], v[208:211], v[228:231]
    v_mfma_f32_16x16x32_bf16 v[244:247], v[44:47], v[212:215], v[244:247]
    s_mul_i32 s49, s49, s48
    s_cmp_ge_u32 s49, 3
    v_mfma_f32_16x16x32_bf16 v[232:235], v[48:51], v[208:211], v[232:235]
    s_cbranch_scc0 F_upn
    ds_read_b128 v[96:99], v22 offset:0
    ds_read_b128 v[100:103], v22 offset:64
    ds_read_b128 v[104:107], v22 offset:128
    ds_read_b128 v[108:111], v22 offset:192
    ds_read_b128 v[112:115], v23 offset:0
    ds_read_b128 v[116:119], v23 offset:64
    ds_read_b128 v[120:123], v23 offset:128
    ds_read_b128 v[124:127], v23 offset:192
    s_lshl_b32 s48, s48, 1
F_upn:
    v_mfma_f32_16x16x32_bf16 v[248:251], v[48:51], v[212:215], v[248:251]
    v_mfma_f32_16x16x32_bf16 v[236:239], v[52:55], v[208:211], v[236:239]
    v_mfma_f32_16x16x32_bf16 v[252:255], v[52:55], v[212:215], v[252:255]
    s_waitcnt vmcnt(0)
    s_waitcnt lgkmcnt(0)
    v_mfma_f32_16x16x32_bf16 v[224:227], v[64:67], v[216:219], v[224:227]
    v_mfma_f32_16x16x32_bf16 v[240:243], v[64:67], v[220:223], v[240:243]
    v_mfma_f32_16x16x32_bf16 v[228:231], v[68:71], v[216:219], v[228:231]
    v_mfma_f32_16x16x32_bf16 v[244:247], v[68:71], v[220:223], v[244:247]
    v_mfma_f32_16x16x32_bf16 v[232:235], v[72:75], v[216:219], v[232:235]
    v_mfma_f32_16x16x32_bf16 v[248:251], v[72:75], v[220:223], v[248:251]
    v_mfma_f32_16x16x32_bf16 v[236:239], v[76:79], v[216:219], v[236:239]
    v_mfma_f32_16x16x32_bf16 v[252:255], v[76:79], v[220:223], v[252:255]
    s_cmp_eq_u32 s48, 0
    s_cbranch_scc1 F_noupd
    s_cmp_eq_u32 s48, 2
    s_cbranch_scc1 F_upr
F_sp_26:
    ds_read_b32 v8, v1 offset:32
    s_waitcnt lgkmcnt(0)
    v_readfirstlane_b32 s49, v8
    s_nop 0
    s_cmp_ge_u32 s49, 3
    s_cbranch_scc0 F_sp_26
    ds_read_b128 v[96:99], v22 offset:0
    ds_read_b128 v[100:103], v22 offset:64
    ds_read_b128 v[104:107], v22 offset:128
    ds_read_b128 v[108:111], v22 offset:192
    ds_read_b128 v[112:115], v23 offset:0
    ds_read_b128 v[116:119], v23 offset:64
    ds_read_b128 v[120:123], v23 offset:128
    ds_read_b128 v[124:127], v23 offset:192
F_upr:
    s_nop 7
    s_waitcnt lgkmcnt(0)
    v_pk_add_f32 v[224:225], v[224:225], v[96:97]
    v_pk_add_f32 v[226:227], v[226:227], v[98:99]
    v_pk_add_f32 v[228:229], v[228:229], v[100:101]
    v_pk_add_f32 v[230:231], v[230:231], v[102:103]
    v_pk_add_f32 v[232:233], v[232:233], v[104:105]
    v_pk_add_f32 v[234:235], v[234:235], v[106:107]
    v_pk_add_f32 v[236:237], v[236:237], v[108:109]
    v_pk_add_f32 v[238:239], v[238:239], v[110:111]
    v_pk_add_f32 v[240:241], v[240:241], v[112:113]
    v_pk_add_f32 v[242:243], v[242:243], v[114:115]
    v_pk_add_f32 v[244:245], v[244:245], v[116:117]
    v_pk_add_f32 v[246:247], v[246:247], v[118:119]
    v_pk_add_f32 v[248:249], v[248:249], v[120:121]
    v_pk_add_f32 v[250:251], v[250:251], v[122:123]
    v_pk_add_f32 v[252:253], v[252:253], v[124:125]
    v_pk_add_f32 v[254:255], v[254:255], v[126:127]
F_noupd:
    s_nop 7
    v_cvt_pk_bf16_f32 v200, v224, v225
    v_cvt_pk_bf16_f32 v201, v226, v227
    v_cvt_pk_bf16_f32 v202, v228, v229
    v_cvt_pk_bf16_f32 v203, v230, v231
    v_cvt_pk_bf16_f32 v204, v232, v233
    v_cvt_pk_bf16_f32 v205, v234, v235
    v_cvt_pk_bf16_f32 v206, v236, v237
    v_cvt_pk_bf16_f32 v207, v238, v239
    v_cvt_pk_bf16_f32 v208, v240, v241
    v_cvt_pk_bf16_f32 v209, v242, v243
    v_cvt_pk_bf16_f32 v210, v244, v245
    v_cvt_pk_bf16_f32 v211, v246, v247
    v_cvt_pk_bf16_f32 v212, v248, v249
    v_cvt_pk_bf16_f32 v213, v250, v251
    v_cvt_pk_bf16_f32 v214, v252, v253
    v_cvt_pk_bf16_f32 v215, v254, v255
    v_permlane16_swap_b32 v200, v202
    v_permlane16_swap_b32 v201, v203
    buffer_store_dwordx4 v[200:203], v6, s[16:19], 0 offen offset:0 sc1
    v_permlane16_swap_b32 v204, v206
    v_permlane16_swap_b32 v205, v207
    buffer_store_dwordx4 v[204:207], v6, s[16:19], 0 offen offset:64 sc1
    v_permlane16_swap_b32 v208, v210
    v_permlane16_swap_b32 v209, v211
    buffer_store_dwordx4 v[208:211], v6, s[16:19], s37 offen offset:0 sc1
    v_permlane16_swap_b32 v212, v214
    v_permlane16_swap_b32 v213, v215
    buffer_store_dwordx4 v[212:215], v6, s[16:19], s37 offen offset:64 sc1
    s_endpgm
F_ss_15:
    ds_read_b32 v8, v1 offset:28
    s_waitcnt lgkmcnt(0)
    v_readfirstlane_b32 s54, v8
    s_nop 0
    s_or_b32 s54, s54, s57
    s_lshr_b32 s50, s54, 16
    s_and_b32 s54, s54, s50
    s_lshr_b32 s50, s54, 1
    s_and_b32 s54, s54, s50
    s_and_b32 s54, s54, 0x5555
    s_branch F_sa_14
F_ss_17:
    ds_read_b32 v8, v1 offset:28
    s_waitcnt lgkmcnt(0)
    v_readfirstlane_b32 s54, v8
    s_nop 0
    s_or_b32 s54, s54, s57
    s_lshr_b32 s50, s54, 16
    s_and_b32 s54, s54, s50
    s_lshr_b32 s50, s54, 1
    s_and_b32 s54, s54, s50
    s_and_b32 s54, s54, 0x5555
    s_branch F_sa_16
F_ss_19:
    ds_read_b32 v8, v1 offset:28
    s_waitcnt lgkmcnt(0)
    v_readfirstlane_b32 s54, v8
    s_nop 0
    s_or_b32 s54, s54, s57
    s_lshr_b32 s50, s54, 16
    s_and_b32 s54, s54, s50
    s_lshr_b32 s50, s54, 1
    s_and_b32 s54, s54, s50
    s_and_b32 s54, s54, 0x5555
    s_branch F_sa_18
F_ss_21:
    ds_read_b32 v8, v1 offset:28
    s_waitcnt lgkmcnt(0)
    v_readfirstlane_b32 s54, v8
    s_nop 0
    s_or_b32 s54, s54, s57
    s_lshr_b32 s50, s54, 16
    s_and_b32 s54, s54, s50
    s_lshr_b32 s50, s54, 1
    s_and_b32 s54, s54, s50
    s_and_b32 s54, s54, 0x5555
    s_branch F_sa_20
F_ss_23:
    ds_read_b32 v8, v1 offset:28
    s_waitcnt lgkmcnt(0)
    v_readfirstlane_b32 s54, v8
    s_nop 0
    s_or_b32 s54, s54, s57
    s_lshr_b32 s50, s54, 16
    s_and_b32 s54, s54, s50
    s_lshr_b32 s50, s54, 1
    s_and_b32 s54, s54, s50
    s_and_b32 s54, s54, 0x5555
    s_branch F_sa_22
F_ss_25:
    ds_read_b32 v8, v1 offset:28
    s_waitcnt lgkmcnt(0)
    v_readfirstlane_b32 s54, v8
    s_nop 0
    s_or_b32 s54, s54, s57
    s_lshr_b32 s50, s54, 16
    s_and_b32 s54, s54, s50
    s_lshr_b32 s50, s54, 1
    s_and_b32 s54, s54, s50
    s_and_b32 s54, s54, 0x5555
    s_branch F_sa_24
F_cons:
    v_lshl_add_u32 v2, v0, 2, v1
    v_mov_b32 v3, 0x3f803f80
    v_cmp_gt_u32 vcc, 16, v0
    v_mov_b32 v4, 0
    s_nop 0
    v_cndmask_b32 v3, v3, 0, vcc
    ds_write_b32 v2, v3
    ds_write_b32 v2, v4 offset:256
    ds_write_b32 v2, v4 offset:11776
    s_and_b32 s40, s3, 1
    s_lshr_b32 s41, s3, 1
    s_waitcnt lgkmcnt(0)
    s_mov_b32 s64, 0
    s_mov_b32 s20, s74
    s_mov_b32 s21, s75
    s_mov_b32 s22, 0x1000000
    s_mov_b32 s23, 0x20000
    v_and_b32 v38, 15, v0
    v_lshrrev_b32 v39, 4, v0
    v_lshrrev_b32 v34, 1, v38
    v_xor_b32 v34, v39, v34
    v_lshlrev_b32 v34, 4, v34
    v_lshl_add_u32 v2, v38, 7, v34
    s_mul_i32 s42, s41, 12288
    v_add_u32 v2, s42, v2
    v_xor_b32 v3, 64, v2
    v_or_b32 v34, s41, v38
    v_cmp_eq_u32 vcc, 0, v34
    v_mov_b32 v35, 147520
    s_nop 0
    v_cndmask_b32 v4, v2, v35, vcc
    v_cndmask_b32 v5, v3, v35, vcc
    v_cndmask_b32 v8, 1, 0, vcc
    s_lshl_b32 s42, s40, 9
    s_add_u32 s42, s42, 152064
    v_lshl_add_u32 v28, v39, 4, s42
    v_lshl_add_u32 v29, v38, 2, s42
    v_lshlrev_b32 v36, 4, v0
    v_add_u32 v36, 159488, v36
    v_cndmask_b32 v13, v36, v28, vcc
    v_or_b32 v34, s41, v39
    v_cmp_eq_u32 vcc, 0, v34
    s_lshl_b32 s43, s40, 3
    v_add_u32 v31, s43, v1
    v_cndmask_b32 v14, v36, v29, vcc
    v_or_b32 v34, s41, v0
    v_cmp_eq_u32 vcc, 0, v34
    v_mov_b32 v16, 1
    s_nop 0
    v_cndmask_b32 v15, v36, v31, vcc
    s_lshl_b32 s42, s40, 11
    s_add_u32 s42, s42, 153088
    v_lshl_add_u32 v19, v0, 4, s42
    s_cmp_eq_u32 s41, 0
    s_cselect_b64 vcc, -1, 0
    v_cndmask_b32 v32, v36, v19, vcc
    s_mul_i32 s42, s41, 96
    v_add_u32 v34, s42, v38
    v_lshlrev_b32 v17, 3, v34
    v_add_u32 v17, 150528, v17
    v_lshlrev_b32 v30, 2, v34
    v_add_u32 v30, 149760, v30
    v_lshlrev_b32 v18, 2, v39
    v_add_u32 v18, s42, v18
    v_lshlrev_b32 v18, 2, v18
    v_add_u32 v18, 148992, v18
    v_and_b32 v34, 1, v38
    v_lshl_add_u32 v35, v39, 2, v34
    v_add_u32 v36, 2, v35
    v_cmp_eq_u32 s[50:51], 1, v34
    v_cmp_le_u32 s[52:53], v35, v38
    v_cmp_le_u32 s[54:55], v36, v38
    s_lshl_b32 s42, s42, 2
    s_add_u32 s42, s42, 149760
    v_lshl_add_u32 v35, v35, 2, s42
    v_lshl_add_u32 v36, v36, 2, s42
    v_subrev_u32 v34, 64, v35
    v_subrev_u32 v37, 64, v36
    v_cndmask_b32 v26, v34, v35, s[52:53]
    v_cndmask_b32 v27, v37, v36, s[54:55]
    v_mov_b32 v34, 0x0c0c0504
    v_mov_b32 v35, 0x05040c0c
    v_cndmask_b32 v34, v34, v35, s[50:51]
    v_mov_b32 v35, 0x0c0c0706
    v_mov_b32 v36, 0x07060c0c
    v_cndmask_b32 v35, v35, v36, s[50:51]
    v_mov_b32 v36, 0x0c0c0c0c
    v_cndmask_b32 v20, v34, v36, s[52:53]
    v_cndmask_b32 v21, v35, v36, s[54:55]
    v_cndmask_b32 v22, v36, v34, s[52:53]
    v_cndmask_b32 v23, v36, v35, s[54:55]
    s_or_b32 s42, s30, s41
    s_cmp_eq_u32 s42, 0
    s_cselect_b64 s[56:57], -1, 0
    s_andn2_b64 s[58:59], s[56:57], s[54:55]
    s_andn2_b64 s[56:57], s[56:57], s[52:53]
    v_mov_b32 v24, 0xf149f2ca
    s_mov_b32 s61, 0x3e8293ee
    s_mul_i32 s42, s30, 11
    s_mul_i32 s43, s41, 6
    s_add_u32 s42, s42, s43
    s_lshl_b32 s42, s42, 15
    s_lshl_b32 s43, s31, 1
    s_add_u32 s43, s43, s40
    s_lshl_b32 s43, s43, 10
    s_add_u32 s42, s42, s43
    s_add_u32 s42, s42, 0xf8000
    v_lshl_add_u32 v25, v0, 4, s42
    s_lshl_b32 s42, s30, 11
    s_lshl_b32 s43, s31, 7
    s_add_u32 s42, s42, s43
    s_add_u32 s42, s42, 0x10000
    v_mov_b32 v33, s42
    s_mov_b32 s66, 32768
    s_mov_b32 s67, 65536
    s_mov_b32 s68, 98304
    s_mov_b32 s69, 131072
    s_mov_b32 s70, 163840
    s_lshl_b32 s42, s40, 1
    s_add_u32 s43, s42, 1
    v_bfe_u32 v34, v0, 2, 3
    v_lshrrev_b32 v35, 1, v34
    v_xor_b32 v35, s42, v35
    v_lshlrev_b32 v6, 5, v35
    v_lshl_add_u32 v6, v34, 7, v6
    v_and_b32 v34, 3, v0
    v_lshl_add_u32 v6, v34, 3, v6
    v_lshrrev_b32 v34, 5, v0
    v_lshl_add_u32 v6, v34, 11, v6
    v_bfe_u32 v34, v0, 2, 3
    v_lshrrev_b32 v35, 1, v34
    v_xor_b32 v35, s43, v35
    v_lshlrev_b32 v7, 5, v35
    v_lshl_add_u32 v7, v34, 7, v7
    v_and_b32 v34, 3, v0
    v_lshl_add_u32 v7, v34, 3, v7
    v_lshrrev_b32 v34, 5, v0
    v_lshl_add_u32 v7, v34, 11, v7
    s_mov_b32 s44, 0
    s_mov_b32 s45, 0
    s_mov_b32 s62, 49152
    s_mov_b32 s63, -98304
    s_setprio 2
    v_mov_b64 v[112:113], 0
    v_mov_b64 v[114:115], 0
    v_mov_b64 v[116:117], 0
    v_mov_b64 v[118:119], 0
    v_mov_b64 v[120:121], 0
    v_mov_b64 v[122:123], 0
    v_mov_b64 v[124:125], 0
    v_mov_b64 v[126:127], 0
    v_mov_b64 v[128:129], 0
    v_mov_b64 v[130:131], 0
    v_mov_b64 v[132:133], 0
    v_mov_b64 v[134:135], 0
    v_mov_b64 v[136:137], 0
    v_mov_b64 v[138:139], 0
    v_mov_b64 v[140:141], 0
    v_mov_b64 v[142:143], 0
    v_mov_b64 v[144:145], 0
    v_mov_b64 v[146:147], 0
    v_mov_b64 v[148:149], 0
    v_mov_b64 v[150:151], 0
    v_mov_b64 v[152:153], 0
    v_mov_b64 v[154:155], 0
    v_mov_b64 v[156:157], 0
    v_mov_b64 v[158:159], 0
    v_mov_b64 v[160:161], 0
    v_mov_b64 v[162:163], 0
    v_mov_b64 v[164:165], 0
    v_mov_b64 v[166:167], 0
    v_mov_b64 v[168:169], 0
    v_mov_b64 v[170:171], 0
    v_mov_b64 v[172:173], 0
    v_mov_b64 v[174:175], 0
    v_mov_b64 v[176:177], 0
    v_mov_b64 v[178:179], 0
    v_mov_b64 v[180:181], 0
    v_mov_b64 v[182:183], 0
    v_mov_b64 v[184:185], 0
    v_mov_b64 v[186:187], 0
    v_mov_b64 v[188:189], 0
    v_mov_b64 v[190:191], 0
    v_mov_b64 v[192:193], 0
    v_mov_b64 v[194:195], 0
    v_mov_b64 v[196:197], 0
    v_mov_b64 v[198:199], 0
    v_mov_b64 v[200:201], 0
    v_mov_b64 v[202:203], 0
    v_mov_b64 v[204:205], 0
    v_mov_b64 v[206:207], 0
    v_mov_b64 v[208:209], 0
    v_mov_b64 v[210:211], 0
    v_mov_b64 v[212:213], 0
    v_mov_b64 v[214:215], 0
    v_mov_b64 v[216:217], 0
    v_mov_b64 v[218:219], 0
    v_mov_b64 v[220:221], 0
    v_mov_b64 v[222:223], 0
    v_mov_b64 v[224:225], 0
    v_mov_b64 v[226:227], 0
    v_mov_b64 v[228:229], 0
    v_mov_b64 v[230:231], 0
    v_mov_b64 v[232:233], 0
    v_mov_b64 v[234:235], 0
    v_mov_b64 v[236:237], 0
    v_mov_b64 v[238:239], 0
    v_mov_b64 v[240:241], 0
    v_mov_b64 v[242:243], 0
    v_mov_b64 v[244:245], 0
    v_mov_b64 v[246:247], 0
    v_mov_b64 v[248:249], 0
    v_mov_b64 v[250:251], 0
    v_mov_b64 v[252:253], 0
    v_mov_b64 v[254:255], 0
    s_barrier
    ds_read_b64_tr_b16 v[40:41], v6 offset:24576
    ds_read_b64_tr_b16 v[42:43], v6 offset:25600
    ds_read_b64_tr_b16 v[44:45], v6 offset:28672
    ds_read_b64_tr_b16 v[46:47], v6 offset:29696
    ds_read_b128 v[64:67], v4 offset:0
    ds_read_b128 v[68:71], v5 offset:0
    ds_read_b64_tr_b16 v[48:49], v7 offset:24576
    ds_read_b128 v[72:75], v2 offset:2048
    ds_read_b128 v[76:79], v3 offset:2048
    ds_read_b64_tr_b16 v[50:51], v7 offset:25600
    ds_read_b128 v[80:83], v2 offset:4096
    ds_read_b128 v[84:87], v3 offset:4096
    ds_read_b64_tr_b16 v[52:53], v7 offset:28672
    s_waitcnt lgkmcnt(6)
    ds_read_b128 v[88:91], v2 offset:6144
    ds_read_b128 v[92:95], v3 offset:6144
    ds_read_b64_tr_b16 v[54:55], v7 offset:29696
    ds_read_b128 v[96:99], v2 offset:8192
    ds_read_b128 v[100:103], v3 offset:8192
    ds_read_b128 v[104:107], v2 offset:10240
    ds_read_b128 v[108:111], v3 offset:10240
    s_branch F_loop
F_sp2:
    ds_read_b32 v12, v1 offset:256
    s_waitcnt lgkmcnt(0)
    v_cmp_ne_u32 vcc, 0, v12
    s_nop 0
    s_cmp_eq_u64 vcc, 0
    s_cbranch_scc0 F_ok2
    s_branch F_sp2
F_sp3:
    ds_read_b32 v12, v31 offset:40
    s_waitcnt lgkmcnt(0)
    v_cmp_ne_u32 vcc, 0, v12
    s_nop 0
    s_cmp_eq_u64 vcc, 0
    s_cbranch_scc0 F_ok3
    s_branch F_sp3
F_sp4:
    ds_read_b32 v12, v31 offset:44
    s_waitcnt lgkmcnt(0)
    v_cmp_ne_u32 vcc, 0, v12
    s_nop 0
    s_cmp_eq_u64 vcc, 0
    s_cbranch_scc0 F_ok4
    s_branch F_sp4
F_loop:
    s_waitcnt lgkmcnt(14)
    v_mfma_f32_16x16x32_bf16 v[112:115], v[40:43], v[64:67], v[112:115]
    s_cmp_eq_u32 s45, 2
    s_cselect_b32 s47, s63, s62
    v_mfma_f32_16x16x32_bf16 v[112:115], v[44:47], v[68:71], v[112:115]
    ds_read_b64_tr_b16 v[56:57], v6 offset:32768
    s_waitcnt lgkmcnt(12)
    v_mfma_f32_16x16x32_bf16 v[136:139], v[44:47], v[76:79], v[136:139]
    s_cselect_b32 s45, -1, s45
    s_add_u32 s45, s45, 1
    v_mfma_f32_16x16x32_bf16 v[136:139], v[40:43], v[72:75], v[136:139]
    ds_read_b64_tr_b16 v[58:59], v6 offset:33792
    s_waitcnt lgkmcnt(10)
    v_mfma_f32_16x16x32_bf16 v[160:163], v[40:43], v[80:83], v[160:163]
    v_mfma_f32_16x16x32_bf16 v[160:163], v[44:47], v[84:87], v[160:163]
    ds_read_b64_tr_b16 v[60:61], v6 offset:36864
    s_waitcnt lgkmcnt(8)
    v_mfma_f32_16x16x32_bf16 v[184:187], v[44:47], v[92:95], v[184:187]
    v_mfma_f32_16x16x32_bf16 v[184:187], v[40:43], v[88:91], v[184:187]
    ds_read_b64_tr_b16 v[62:63], v6 offset:37888
    s_waitcnt lgkmcnt(6)
    v_mfma_f32_16x16x32_bf16 v[208:211], v[40:43], v[96:99], v[208:211]
    v_mfma_f32_16x16x32_bf16 v[208:211], v[44:47], v[100:103], v[208:211]
    s_waitcnt lgkmcnt(4)
    v_mfma_f32_16x16x32_bf16 v[232:235], v[44:47], v[108:111], v[232:235]
    v_mfma_f32_16x16x32_bf16 v[232:235], v[40:43], v[104:107], v[232:235]
    v_mfma_f32_16x16x32_bf16 v[116:119], v[48:51], v[64:67], v[116:119]
    s_add_u32 s44, s44, 1
    v_add_u32 v2, s47, v2
    v_mfma_f32_16x16x32_bf16 v[116:119], v[52:55], v[68:71], v[116:119]
    ds_read_b64_tr_b16 v[40:41], v7 offset:32768
    v_mfma_f32_16x16x32_bf16 v[140:143], v[52:55], v[76:79], v[140:143]
    v_mad_i32_i24 v4, v8, s47, v4
    v_mfma_f32_16x16x32_bf16 v[140:143], v[48:51], v[72:75], v[140:143]
    ds_read_b64_tr_b16 v[42:43], v7 offset:33792
    v_mfma_f32_16x16x32_bf16 v[164:167], v[48:51], v[80:83], v[164:167]
    v_add_u32 v3, s47, v3
    v_mfma_f32_16x16x32_bf16 v[164:167], v[52:55], v[84:87], v[164:167]
    ds_read_b64_tr_b16 v[44:45], v7 offset:36864
    v_mfma_f32_16x16x32_bf16 v[188:191], v[52:55], v[92:95], v[188:191]
    v_mad_i32_i24 v5, v8, s47, v5
    v_mfma_f32_16x16x32_bf16 v[188:191], v[48:51], v[88:91], v[188:191]
    ds_read_b64_tr_b16 v[46:47], v7 offset:37888
    v_mfma_f32_16x16x32_bf16 v[212:215], v[48:51], v[96:99], v[212:215]
    v_mfma_f32_16x16x32_bf16 v[212:215], v[52:55], v[100:103], v[212:215]
    v_mfma_f32_16x16x32_bf16 v[236:239], v[52:55], v[108:111], v[236:239]
    v_mfma_f32_16x16x32_bf16 v[236:239], v[48:51], v[104:107], v[236:239]
    s_waitcnt lgkmcnt(4)
    v_mfma_f32_16x16x32_bf16 v[120:123], v[56:59], v[64:67], v[120:123]
    v_mfma_f32_16x16x32_bf16 v[120:123], v[60:63], v[68:71], v[120:123]
    ds_read_b64_tr_b16 v[48:49], v6 offset:40960
    v_mfma_f32_16x16x32_bf16 v[144:147], v[60:63], v[76:79], v[144:147]
    v_mfma_f32_16x16x32_bf16 v[144:147], v[56:59], v[72:75], v[144:147]
    ds_read_b64_tr_b16 v[50:51], v6 offset:41984
    v_mfma_f32_16x16x32_bf16 v[168:171], v[56:59], v[80:83], v[168:171]
    v_mfma_f32_16x16x32_bf16 v[168:171], v[60:63], v[84:87], v[168:171]
    ds_read_b64_tr_b16 v[52:53], v6 offset:45056
    v_mfma_f32_16x16x32_bf16 v[192:195], v[60:63], v[92:95], v[192:195]
    v_mfma_f32_16x16x32_bf16 v[192:195], v[56:59], v[88:91], v[192:195]
    ds_read_b64_tr_b16 v[54:55], v6 offset:46080
    v_mfma_f32_16x16x32_bf16 v[216:219], v[56:59], v[96:99], v[216:219]
    v_mfma_f32_16x16x32_bf16 v[216:219], v[60:63], v[100:103], v[216:219]
    v_mfma_f32_16x16x32_bf16 v[240:243], v[60:63], v[108:111], v[240:243]
    ds_read_b32 v12, v1 offset:256
    v_mfma_f32_16x16x32_bf16 v[240:243], v[56:59], v[104:107], v[240:243]
    s_waitcnt lgkmcnt(5)
    v_mfma_f32_16x16x32_bf16 v[124:127], v[40:43], v[64:67], v[124:127]
    v_mfma_f32_16x16x32_bf16 v[124:127], v[44:47], v[68:71], v[124:127]
    ds_read_b64_tr_b16 v[56:57], v7 offset:40960
    v_mfma_f32_16x16x32_bf16 v[148:151], v[44:47], v[76:79], v[148:151]
    v_mfma_f32_16x16x32_bf16 v[148:151], v[40:43], v[72:75], v[148:151]
    ds_read_b64_tr_b16 v[58:59], v7 offset:41984
    v_mfma_f32_16x16x32_bf16 v[172:175], v[40:43], v[80:83], v[172:175]
    v_mfma_f32_16x16x32_bf16 v[172:175], v[44:47], v[84:87], v[172:175]
    ds_read_b64_tr_b16 v[60:61], v7 offset:45056
    v_mfma_f32_16x16x32_bf16 v[196:199], v[44:47], v[92:95], v[196:199]
    v_mfma_f32_16x16x32_bf16 v[196:199], v[40:43], v[88:91], v[196:199]
    ds_read_b64_tr_b16 v[62:63], v7 offset:46080
    v_mfma_f32_16x16x32_bf16 v[220:223], v[40:43], v[96:99], v[220:223]
    v_add_u32 v6, s47, v6
    v_add_u32 v7, s47, v7
    v_mfma_f32_16x16x32_bf16 v[220:223], v[44:47], v[100:103], v[220:223]
    v_mfma_f32_16x16x32_bf16 v[244:247], v[44:47], v[108:111], v[244:247]
    s_cmp_eq_u32 s44, 16
    v_mfma_f32_16x16x32_bf16 v[244:247], v[40:43], v[104:107], v[244:247]
    s_cbranch_scc1 F_last
    s_waitcnt lgkmcnt(5)
    v_mfma_f32_16x16x32_bf16 v[128:131], v[64:67], v[48:51], v[128:131]
    v_mfma_f32_16x16x32_bf16 v[128:131], v[68:71], v[52:55], v[128:131]
    v_mfma_f32_16x16x32_bf16 v[152:155], v[76:79], v[52:55], v[152:155]
    s_waitcnt lgkmcnt(0)
    s_barrier
    v_mfma_f32_16x16x32_bf16 v[152:155], v[72:75], v[48:51], v[152:155]
    ds_read_b64_tr_b16 v[40:41], v6 offset:24576
    v_mfma_f32_16x16x32_bf16 v[176:179], v[80:83], v[48:51], v[176:179]
    v_mfma_f32_16x16x32_bf16 v[176:179], v[84:87], v[52:55], v[176:179]
    ds_read_b64_tr_b16 v[42:43], v6 offset:25600
    v_mfma_f32_16x16x32_bf16 v[200:203], v[92:95], v[52:55], v[200:203]
    v_mfma_f32_16x16x32_bf16 v[200:203], v[88:91], v[48:51], v[200:203]
    ds_read_b64_tr_b16 v[44:45], v6 offset:28672
    v_mfma_f32_16x16x32_bf16 v[224:227], v[96:99], v[48:51], v[224:227]
    v_mfma_f32_16x16x32_bf16 v[224:227], v[100:103], v[52:55], v[224:227]
    ds_read_b64_tr_b16 v[46:47], v6 offset:29696
    v_mfma_f32_16x16x32_bf16 v[248:251], v[108:111], v[52:55], v[248:251]
    v_mfma_f32_16x16x32_bf16 v[248:251], v[104:107], v[48:51], v[248:251]
    v_mfma_f32_16x16x32_bf16 v[132:135], v[64:67], v[56:59], v[132:135]
    ds_read_b128 v[64:67], v4 offset:0
    v_mfma_f32_16x16x32_bf16 v[132:135], v[68:71], v[60:63], v[132:135]
    ds_read_b128 v[68:71], v5 offset:0
    ds_read_b64_tr_b16 v[48:49], v7 offset:24576
    v_mfma_f32_16x16x32_bf16 v[156:159], v[76:79], v[60:63], v[156:159]
    ds_read_b128 v[76:79], v3 offset:2048
    v_mfma_f32_16x16x32_bf16 v[156:159], v[72:75], v[56:59], v[156:159]
    ds_read_b128 v[72:75], v2 offset:2048
    ds_read_b64_tr_b16 v[50:51], v7 offset:25600
    v_mfma_f32_16x16x32_bf16 v[180:183], v[80:83], v[56:59], v[180:183]
    ds_read_b128 v[80:83], v2 offset:4096
    v_mfma_f32_16x16x32_bf16 v[180:183], v[84:87], v[60:63], v[180:183]
    ds_read_b128 v[84:87], v3 offset:4096
    ds_read_b64_tr_b16 v[52:53], v7 offset:28672
    v_mfma_f32_16x16x32_bf16 v[204:207], v[92:95], v[60:63], v[204:207]
    ds_read_b128 v[92:95], v3 offset:6144
    v_mfma_f32_16x16x32_bf16 v[204:207], v[88:91], v[56:59], v[204:207]
    ds_read_b128 v[88:91], v2 offset:6144
    ds_read_b64_tr_b16 v[54:55], v7 offset:29696
    v_mfma_f32_16x16x32_bf16 v[228:231], v[96:99], v[56:59], v[228:231]
    ds_read_b128 v[96:99], v2 offset:8192
    v_mfma_f32_16x16x32_bf16 v[228:231], v[100:103], v[60:63], v[228:231]
    ds_read_b128 v[100:103], v3 offset:8192
    v_mfma_f32_16x16x32_bf16 v[252:255], v[108:111], v[60:63], v[252:255]
    ds_read_b128 v[108:111], v3 offset:10240
    v_mfma_f32_16x16x32_bf16 v[252:255], v[104:107], v[56:59], v[252:255]
    ds_read_b128 v[104:107], v2 offset:10240
    s_branch F_loop
F_last:
    s_waitcnt lgkmcnt(5)
    v_mfma_f32_16x16x32_bf16 v[128:131], v[64:67], v[48:51], v[128:131]
    s_waitcnt lgkmcnt(4)
    v_cmp_ne_u32 vcc, 0, v12
    s_waitcnt lgkmcnt(0)
    s_barrier
    v_mfma_f32_16x16x32_bf16 v[128:131], v[68:71], v[52:55], v[128:131]
    s_cmp_eq_u64 vcc, 0
    s_cbranch_scc1 F_sp2
F_ok2:
    v_mfma_f32_16x16x32_bf16 v[132:135], v[64:67], v[56:59], v[132:135]
    ds_write_b128 v13, v[112:115] offset:0
    ds_read2_b32 v[2:3], v30 offset0:0 offset1:16
    v_mfma_f32_16x16x32_bf16 v[132:135], v[68:71], v[60:63], v[132:135]
    ds_write_b128 v13, v[116:119] offset:64
    ds_read2_b32 v[4:5], v30 offset0:32 offset1:48
    v_mfma_f32_16x16x32_bf16 v[152:155], v[76:79], v[52:55], v[152:155]
    ds_write_b128 v13, v[120:123] offset:128
    ds_read2_b32 v[6:7], v30 offset0:64 offset1:80
    v_mfma_f32_16x16x32_bf16 v[152:155], v[72:75], v[48:51], v[152:155]
    ds_write_b128 v13, v[124:127] offset:192
    ds_read2_b64 v[64:67], v17 offset0:64 offset1:80
    v_mfma_f32_16x16x32_bf16 v[176:179], v[80:83], v[48:51], v[176:179]
    ds_read2_b64 v[68:71], v17 offset0:32 offset1:48
    ds_write_b32 v14, v128 offset:256
    v_mfma_f32_16x16x32_bf16 v[176:179], v[84:87], v[52:55], v[176:179]
    ds_write_b32 v14, v132 offset:320
    ds_write_b32 v15, v16 offset:40
    v_mfma_f32_16x16x32_bf16 v[200:203], v[92:95], v[52:55], v[200:203]
    ds_read_b32 v40, v26 offset:0
    ds_read_b32 v41, v27 offset:0
    v_mfma_f32_16x16x32_bf16 v[200:203], v[88:91], v[48:51], v[200:203]
    ds_read_b32 v42, v26 offset:64
    ds_read_b32 v43, v27 offset:64
    v_mfma_f32_16x16x32_bf16 v[224:227], v[96:99], v[48:51], v[224:227]
    ds_read_b32 v44, v26 offset:128
    ds_read_b32 v45, v27 offset:128
    v_mfma_f32_16x16x32_bf16 v[224:227], v[100:103], v[52:55], v[224:227]
    ds_read_b32 v12, v31 offset:40
    v_mfma_f32_16x16x32_bf16 v[248:251], v[108:111], v[52:55], v[248:251]
    ds_read_b32 v46, v26 offset:192
    ds_read_b32 v47, v27 offset:192
    v_mfma_f32_16x16x32_bf16 v[248:251], v[104:107], v[48:51], v[248:251]
    ds_read_b32 v8, v26 offset:256
    ds_read_b32 v9, v27 offset:256
    v_mfma_f32_16x16x32_bf16 v[156:159], v[76:79], v[60:63], v[156:159]
    ds_read_b32 v10, v26 offset:320
    ds_read_b32 v11, v27 offset:320
    v_mfma_f32_16x16x32_bf16 v[156:159], v[72:75], v[56:59], v[156:159]
    s_waitcnt lgkmcnt(6)
    v_cmp_eq_u32 vcc, 1, v12
    v_mul_f32 v2, s61, v2
    v_mfma_f32_16x16x32_bf16 v[180:183], v[80:83], v[56:59], v[180:183]
    ds_read2_b64 v[72:75], v17 offset0:0 offset1:16
    s_cmp_eq_u64 vcc, 0
    s_cbranch_scc1 F_sp3
F_ok3:
    v_mfma_f32_16x16x32_bf16 v[180:183], v[84:87], v[60:63], v[180:183]
    ds_read_b128 v[48:51], v28 offset:128
    v_mul_f32 v3, s61, v3
    v_mfma_f32_16x16x32_bf16 v[204:207], v[92:95], v[60:63], v[204:207]
    ds_read_b128 v[52:55], v28 offset:192
    v_mul_f32 v4, s61, v4
    v_mfma_f32_16x16x32_bf16 v[204:207], v[88:91], v[56:59], v[204:207]
    ds_read_b128 v[76:79], v28 offset:0
    v_mul_f32 v5, s61, v5
    v_mfma_f32_16x16x32_bf16 v[228:231], v[96:99], v[56:59], v[228:231]
    ds_read_b128 v[80:83], v28 offset:64
    v_mul_f32 v6, s61, v6
    v_mfma_f32_16x16x32_bf16 v[228:231], v[100:103], v[60:63], v[228:231]
    ds_read2_b32 v[34:35], v29 offset0:64 offset1:64
    v_mul_f32 v7, s61, v7
    v_mfma_f32_16x16x32_bf16 v[252:255], v[108:111], v[60:63], v[252:255]
    ds_read2_b32 v[36:37], v29 offset0:80 offset1:80
    v_mfma_f32_16x16x32_bf16 v[252:255], v[104:107], v[56:59], v[252:255]
    ds_read_b128 v[108:111], v18 offset:320
    ds_read_b128 v[104:107], v18 offset:256
    ds_read_b128 v[100:103], v18 offset:192
    ds_read_b128 v[96:99], v18 offset:128
    ds_read_b128 v[92:95], v18 offset:64
    ds_read_b128 v[88:91], v18 offset:0
    s_waitcnt lgkmcnt(10)
    v_pk_fma_f32 v[216:217], v[48:49], v[64:65], v[216:217] neg_lo:[0,1,0] neg_hi:[0,1,0]
    v_pk_fma_f32 v[218:219], v[50:51], v[64:65], v[218:219] neg_lo:[0,1,0] neg_hi:[0,1,0]
    v_pk_fma_f32 v[220:221], v[52:53], v[64:65], v[220:221] neg_lo:[0,1,0] neg_hi:[0,1,0]
    v_pk_fma_f32 v[222:223], v[54:55], v[64:65], v[222:223] neg_lo:[0,1,0] neg_hi:[0,1,0]
    v_cvt_pk_bf16_f32 v216, v216, v217
    v_cvt_pk_bf16_f32 v217, v218, v219
    v_cvt_pk_bf16_f32 v218, v220, v221
    v_cvt_pk_bf16_f32 v219, v222, v223
    v_pk_fma_f32 v[240:241], v[48:49], v[66:67], v[240:241] neg_lo:[0,1,0] neg_hi:[0,1,0]
    v_pk_fma_f32 v[242:243], v[50:51], v[66:67], v[242:243] neg_lo:[0,1,0] neg_hi:[0,1,0]
    v_pk_fma_f32 v[244:245], v[52:53], v[66:67], v[244:245] neg_lo:[0,1,0] neg_hi:[0,1,0]
    v_pk_fma_f32 v[246:247], v[54:55], v[66:67], v[246:247] neg_lo:[0,1,0] neg_hi:[0,1,0]
    v_cvt_pk_bf16_f32 v240, v240, v241
    v_cvt_pk_bf16_f32 v241, v242, v243
    v_cvt_pk_bf16_f32 v242, v244, v245
    v_cvt_pk_bf16_f32 v243, v246, v247
    s_waitcnt lgkmcnt(5)
    v_pk_fma_f32 v[248:249], v[108:109], v[34:35], v[248:249] neg_lo:[0,1,0] neg_hi:[0,1,0]
    v_pk_fma_f32 v[250:251], v[110:111], v[34:35], v[250:251] neg_lo:[0,1,0] neg_hi:[0,1,0]
    v_pk_fma_f32 v[252:253], v[108:109], v[36:37], v[252:253] neg_lo:[0,1,0] neg_hi:[0,1,0]
    v_pk_fma_f32 v[254:255], v[110:111], v[36:37], v[254:255] neg_lo:[0,1,0] neg_hi:[0,1,0]
    v_cvt_pk_bf16_f32 v248, v248, v249
    v_cvt_pk_bf16_f32 v249, v250, v251
    v_cvt_pk_bf16_f32 v250, v252, v253
    v_cvt_pk_bf16_f32 v251, v254, v255
    ds_write_b128 v32, v[240:243]
    ds_write_b128 v32, v[248:251] offset:1024
    ds_write_b32 v15, v16 offset:44
    v_pk_fma_f32 v[232:233], v[76:77], v[66:67], v[232:233] neg_lo:[0,1,0] neg_hi:[0,1,0]
    v_pk_fma_f32 v[234:235], v[78:79], v[66:67], v[234:235] neg_lo:[0,1,0] neg_hi:[0,1,0]
    v_pk_fma_f32 v[236:237], v[80:81], v[66:67], v[236:237] neg_lo:[0,1,0] neg_hi:[0,1,0]
    v_pk_fma_f32 v[238:239], v[82:83], v[66:67], v[238:239] neg_lo:[0,1,0] neg_hi:[0,1,0]
    v_cvt_pk_bf16_f32 v232, v232, v233
    v_cvt_pk_bf16_f32 v233, v234, v235
    v_cvt_pk_bf16_f32 v234, v236, v237
    v_cvt_pk_bf16_f32 v235, v238, v239
    v_pk_fma_f32 v[192:193], v[48:49], v[70:71], v[192:193] neg_lo:[0,1,0] neg_hi:[0,1,0]
    v_pk_fma_f32 v[194:195], v[50:51], v[70:71], v[194:195] neg_lo:[0,1,0] neg_hi:[0,1,0]
    v_pk_fma_f32 v[196:197], v[52:53], v[70:71], v[196:197] neg_lo:[0,1,0] neg_hi:[0,1,0]
    v_pk_fma_f32 v[198:199], v[54:55], v[70:71], v[198:199] neg_lo:[0,1,0] neg_hi:[0,1,0]
    v_cvt_pk_bf16_f32 v192, v192, v193
    v_cvt_pk_bf16_f32 v193, v194, v195
    v_cvt_pk_bf16_f32 v194, v196, v197
    v_cvt_pk_bf16_f32 v195, v198, v199
    v_mfma_f32_16x16x32_bf16 v[236:239], v[216:219], v[232:235], 0
    v_mfma_f32_16x16x32_bf16 v[244:247], v[240:243], v[232:235], 0
    v_pk_fma_f32 v[208:209], v[76:77], v[64:65], v[208:209] neg_lo:[0,1,0] neg_hi:[0,1,0]
    v_pk_fma_f32 v[210:211], v[78:79], v[64:65], v[210:211] neg_lo:[0,1,0] neg_hi:[0,1,0]
    v_pk_fma_f32 v[212:213], v[80:81], v[64:65], v[212:213] neg_lo:[0,1,0] neg_hi:[0,1,0]
    v_pk_fma_f32 v[214:215], v[82:83], v[64:65], v[214:215] neg_lo:[0,1,0] neg_hi:[0,1,0]
    v_cvt_pk_bf16_f32 v208, v208, v209
    v_cvt_pk_bf16_f32 v209, v210, v211
    v_cvt_pk_bf16_f32 v210, v212, v213
    v_cvt_pk_bf16_f32 v211, v214, v215
    v_pk_fma_f32 v[168:169], v[48:49], v[68:69], v[168:169] neg_lo:[0,1,0] neg_hi:[0,1,0]
    v_pk_fma_f32 v[170:171], v[50:51], v[68:69], v[170:171] neg_lo:[0,1,0] neg_hi:[0,1,0]
    v_pk_fma_f32 v[172:173], v[52:53], v[68:69], v[172:173] neg_lo:[0,1,0] neg_hi:[0,1,0]
    v_pk_fma_f32 v[174:175], v[54:55], v[68:69], v[174:175] neg_lo:[0,1,0] neg_hi:[0,1,0]
    v_cvt_pk_bf16_f32 v168, v168, v169
    v_cvt_pk_bf16_f32 v169, v170, v171
    v_cvt_pk_bf16_f32 v170, v172, v173
    v_cvt_pk_bf16_f32 v171, v174, v175
    v_mfma_f32_16x16x32_bf16 v[212:215], v[192:195], v[208:211], 0
    v_mfma_f32_16x16x32_bf16 v[220:223], v[216:219], v[208:211], 0
    v_pk_fma_f32 v[184:185], v[76:77], v[70:71], v[184:185] neg_lo:[0,1,0] neg_hi:[0,1,0]
    v_pk_fma_f32 v[186:187], v[78:79], v[70:71], v[186:187] neg_lo:[0,1,0] neg_hi:[0,1,0]
    v_pk_fma_f32 v[188:189], v[80:81], v[70:71], v[188:189] neg_lo:[0,1,0] neg_hi:[0,1,0]
    v_pk_fma_f32 v[190:191], v[82:83], v[70:71], v[190:191] neg_lo:[0,1,0] neg_hi:[0,1,0]
    v_cvt_pk_bf16_f32 v184, v184, v185
    v_cvt_pk_bf16_f32 v185, v186, v187
    v_cvt_pk_bf16_f32 v186, v188, v189
    v_cvt_pk_bf16_f32 v187, v190, v191
    v_pk_fma_f32 v[144:145], v[48:49], v[74:75], v[144:145] neg_lo:[0,1,0] neg_hi:[0,1,0]
    v_pk_fma_f32 v[146:147], v[50:51], v[74:75], v[146:147] neg_lo:[0,1,0] neg_hi:[0,1,0]
    v_pk_fma_f32 v[148:149], v[52:53], v[74:75], v[148:149] neg_lo:[0,1,0] neg_hi:[0,1,0]
    v_pk_fma_f32 v[150:151], v[54:55], v[74:75], v[150:151] neg_lo:[0,1,0] neg_hi:[0,1,0]
    v_cvt_pk_bf16_f32 v144, v144, v145
    v_cvt_pk_bf16_f32 v145, v146, v147
    v_cvt_pk_bf16_f32 v146, v148, v149
    v_cvt_pk_bf16_f32 v147, v150, v151
    v_mfma_f32_16x16x32_bf16 v[188:191], v[168:171], v[184:187], 0
    v_mfma_f32_16x16x32_bf16 v[196:199], v[192:195], v[184:187], 0
    v_pk_fma_f32 v[160:161], v[76:77], v[68:69], v[160:161] neg_lo:[0,1,0] neg_hi:[0,1,0]
    v_pk_fma_f32 v[162:163], v[78:79], v[68:69], v[162:163] neg_lo:[0,1,0] neg_hi:[0,1,0]
    v_pk_fma_f32 v[164:165], v[80:81], v[68:69], v[164:165] neg_lo:[0,1,0] neg_hi:[0,1,0]
    v_pk_fma_f32 v[166:167], v[82:83], v[68:69], v[166:167] neg_lo:[0,1,0] neg_hi:[0,1,0]
    v_cvt_pk_bf16_f32 v160, v160, v161
    v_cvt_pk_bf16_f32 v161, v162, v163
    v_cvt_pk_bf16_f32 v162, v164, v165
    v_cvt_pk_bf16_f32 v163, v166, v167
    ds_read_b32 v12, v31 offset:44
    v_pk_fma_f32 v[120:121], v[48:49], v[72:73], v[120:121] neg_lo:[0,1,0] neg_hi:[0,1,0]
    v_pk_fma_f32 v[122:123], v[50:51], v[72:73], v[122:123] neg_lo:[0,1,0] neg_hi:[0,1,0]
    v_pk_fma_f32 v[124:125], v[52:53], v[72:73], v[124:125] neg_lo:[0,1,0] neg_hi:[0,1,0]
    v_pk_fma_f32 v[126:127], v[54:55], v[72:73], v[126:127] neg_lo:[0,1,0] neg_hi:[0,1,0]
    v_cvt_pk_bf16_f32 v120, v120, v121
    v_cvt_pk_bf16_f32 v121, v122, v123
    v_cvt_pk_bf16_f32 v122, v124, v125
    v_cvt_pk_bf16_f32 v123, v126, v127
    v_mfma_f32_16x16x32_bf16 v[164:167], v[144:147], v[160:163], 0
    v_mfma_f32_16x16x32_bf16 v[172:175], v[168:171], v[160:163], 0
    v_pk_fma_f32 v[136:137], v[76:77], v[74:75], v[136:137] neg_lo:[0,1,0] neg_hi:[0,1,0]
    v_pk_fma_f32 v[138:139], v[78:79], v[74:75], v[138:139] neg_lo:[0,1,0] neg_hi:[0,1,0]
    v_pk_fma_f32 v[140:141], v[80:81], v[74:75], v[140:141] neg_lo:[0,1,0] neg_hi:[0,1,0]
    v_pk_fma_f32 v[142:143], v[82:83], v[74:75], v[142:143] neg_lo:[0,1,0] neg_hi:[0,1,0]
    v_cvt_pk_bf16_f32 v136, v136, v137
    v_cvt_pk_bf16_f32 v137, v138, v139
    v_cvt_pk_bf16_f32 v138, v140, v141
    v_cvt_pk_bf16_f32 v139, v142, v143
    s_waitcnt lgkmcnt(0)
    v_cmp_eq_u32 vcc, 1, v12
    v_pk_fma_f32 v[112:113], v[76:77], v[72:73], v[112:113] neg_lo:[0,1,0] neg_hi:[0,1,0]
    v_pk_fma_f32 v[114:115], v[78:79], v[72:73], v[114:115] neg_lo:[0,1,0] neg_hi:[0,1,0]
    v_pk_fma_f32 v[116:117], v[80:81], v[72:73], v[116:117] neg_lo:[0,1,0] neg_hi:[0,1,0]
    v_pk_fma_f32 v[118:119], v[82:83], v[72:73], v[118:119] neg_lo:[0,1,0] neg_hi:[0,1,0]
    s_cmp_eq_u64 vcc, 0
    s_cbranch_scc1 F_sp4
F_ok4:
    ds_read_b128 v[56:59], v19
    ds_read_b128 v[60:63], v19 offset:1024
    v_mfma_f32_16x16x32_bf16 v[140:143], v[120:123], v[136:139], 0
    v_mfma_f32_16x16x32_bf16 v[148:151], v[144:147], v[136:139], 0
    v_cvt_pk_bf16_f32 v112, v112, v113
    v_cvt_pk_bf16_f32 v113, v114, v115
    v_cvt_pk_bf16_f32 v114, v116, v117
    v_cvt_pk_bf16_f32 v115, v118, v119
    v_cndmask_b32 v236, v236, v237, s[50:51]
    v_cndmask_b32 v238, v238, v239, s[50:51]
    v_cndmask_b32 v244, v244, v245, s[50:51]
    v_cndmask_b32 v246, v246, v247, s[50:51]
    v_cndmask_b32 v236, v236, v244, s[52:53]
    v_cndmask_b32 v237, v238, v246, s[54:55]
    v_pk_mul_f32 v[236:237], v[236:237], v[10:11]
    v_max_f32 v238, v236, v237
    v_cndmask_b32 v212, v212, v213, s[50:51]
    v_cndmask_b32 v214, v214, v215, s[50:51]
    v_cndmask_b32 v220, v220, v221, s[50:51]
    v_cndmask_b32 v222, v222, v223, s[50:51]
    v_cndmask_b32 v212, v212, v220, s[52:53]
    v_cndmask_b32 v213, v214, v222, s[54:55]
    v_pk_mul_f32 v[212:213], v[212:213], v[8:9]
    v_max_f32 v214, v212, v213
    s_waitcnt lgkmcnt(0)
    v_mfma_f32_16x16x32_bf16 v[116:119], v[56:59], v[112:115], 0
    v_mfma_f32_16x16x32_bf16 v[124:127], v[120:123], v[112:115], 0
    v_cndmask_b32 v188, v188, v189, s[50:51]
    v_cndmask_b32 v190, v190, v191, s[50:51]
    v_cndmask_b32 v196, v196, v197, s[50:51]
    v_cndmask_b32 v198, v198, v199, s[50:51]
    v_cndmask_b32 v188, v188, v196, s[52:53]
    v_cndmask_b32 v189, v190, v198, s[54:55]
    v_pk_mul_f32 v[188:189], v[188:189], v[46:47]
    v_max_f32 v190, v188, v189
    v_cndmask_b32 v164, v164, v165, s[50:51]
    v_cndmask_b32 v166, v166, v167, s[50:51]
    v_cndmask_b32 v172, v172, v173, s[50:51]
    v_cndmask_b32 v174, v174, v175, s[50:51]
    v_cndmask_b32 v164, v164, v172, s[52:53]
    v_cndmask_b32 v165, v166, v174, s[54:55]
    v_pk_mul_f32 v[164:165], v[164:165], v[44:45]
    v_max_f32 v166, v164, v165
    v_cndmask_b32 v140, v140, v141, s[50:51]
    v_cndmask_b32 v142, v142, v143, s[50:51]
    v_cndmask_b32 v148, v148, v149, s[50:51]
    v_cndmask_b32 v150, v150, v151, s[50:51]
    v_cndmask_b32 v140, v140, v148, s[52:53]
    v_cndmask_b32 v141, v142, v150, s[54:55]
    v_pk_mul_f32 v[140:141], v[140:141], v[42:43]
    v_cndmask_b32 v140, v140, v24, s[56:57]
    v_cndmask_b32 v141, v141, v24, s[58:59]
    v_max_f32 v142, v140, v141
    v_cndmask_b32 v116, v116, v117, s[50:51]
    v_cndmask_b32 v118, v118, v119, s[50:51]
    v_cndmask_b32 v124, v124, v125, s[50:51]
    v_cndmask_b32 v126, v126, v127, s[50:51]
    v_cndmask_b32 v116, v116, v124, s[52:53]
    v_cndmask_b32 v117, v118, v126, s[54:55]
    v_pk_mul_f32 v[116:117], v[116:117], v[40:41]
    v_max_f32 v118, v116, v117
    v_pk_fma_f32 v[224:225], v[104:105], v[34:35], v[224:225] neg_lo:[0,1,0] neg_hi:[0,1,0]
    v_pk_fma_f32 v[226:227], v[106:107], v[34:35], v[226:227] neg_lo:[0,1,0] neg_hi:[0,1,0]
    v_permlane32_swap_b32 v214, v238
    v_permlane32_swap_b32 v166, v190
    v_permlane32_swap_b32 v118, v142
    v_max_f32 v214, v214, v238
    v_max_f32 v166, v166, v190
    v_max_f32 v118, v118, v142
    v_mov_b32 v119, v118
    v_permlane16_swap_b32 v166, v214
    v_pk_fma_f32 v[228:229], v[104:105], v[36:37], v[228:229] neg_lo:[0,1,0] neg_hi:[0,1,0]
    v_permlane16_swap_b32 v118, v119
    v_max_f32 v166, v166, v214
    v_max_f32 v118, v118, v119
    v_mov_b32 v214, v166
    v_mov_b32 v142, v118
    v_pk_fma_f32 v[230:231], v[106:107], v[36:37], v[230:231] neg_lo:[0,1,0] neg_hi:[0,1,0]
    v_permlane16_swap_b32 v166, v214
    v_permlane32_swap_b32 v118, v142
    v_mov_b32 v190, v166
    v_mov_b32 v238, v214
    v_cvt_pk_bf16_f32 v224, v224, v225
    v_permlane32_swap_b32 v166, v190
    v_permlane32_swap_b32 v214, v238
    v_mul_f32 v118, v118, v2
    v_fma_f32 v116, v116, v2, -v118
    v_fma_f32 v117, v117, v2, -v118
    v_mul_f32 v142, v142, v3
    v_fma_f32 v140, v140, v3, -v142
    v_fma_f32 v141, v141, v3, -v142
    v_mul_f32 v166, v166, v4
    v_fma_f32 v164, v164, v4, -v166
    v_fma_f32 v165, v165, v4, -v166
    v_mul_f32 v190, v190, v5
    v_fma_f32 v188, v188, v5, -v190
    v_fma_f32 v189, v189, v5, -v190
    v_mul_f32 v214, v214, v6
    v_fma_f32 v212, v212, v6, -v214
    v_fma_f32 v213, v213, v6, -v214
    v_mul_f32 v238, v238, v7
    v_fma_f32 v236, v236, v7, -v238
    v_fma_f32 v237, v237, v7, -v238
    v_exp_f32 v236, v236
    v_exp_f32 v237, v237
    v_exp_f32 v212, v212
    v_exp_f32 v213, v213
    v_exp_f32 v188, v188
    v_exp_f32 v189, v189
    v_exp_f32 v164, v164
    v_exp_f32 v165, v165
    v_exp_f32 v140, v140
    v_exp_f32 v141, v141
    v_exp_f32 v116, v116
    v_exp_f32 v117, v117
    v_add_f32 v238, v236, v237
    v_add_f32 v214, v212, v213
    v_add_f32 v190, v188, v189
    v_add_f32 v166, v164, v165
    v_add_f32 v142, v140, v141
    v_add_f32 v118, v116, v117
    v_pk_mul_f32 v[236:237], v[236:237], v[10:11]
    v_pk_mul_f32 v[212:213], v[212:213], v[8:9]
    v_permlane32_swap_b32 v214, v238
    v_permlane32_swap_b32 v166, v190
    v_permlane32_swap_b32 v118, v142
    v_add_f32 v214, v214, v238
    v_add_f32 v166, v166, v190
    v_add_f32 v118, v118, v142
    v_mov_b32 v119, v118
    v_permlane16_swap_b32 v166, v214
    v_pk_mul_f32 v[188:189], v[188:189], v[46:47]
    v_permlane16_swap_b32 v118, v119
    v_add_f32 v166, v166, v214
    v_add_f32 v118, v118, v119
    v_rcp_f32 v166, v166
    v_rcp_f32 v118, v118
    v_pk_mul_f32 v[164:165], v[164:165], v[44:45]
    v_mov_b32 v214, v166
    v_mov_b32 v142, v118
    v_pk_mul_f32 v[140:141], v[140:141], v[42:43]
    v_permlane16_swap_b32 v166, v214
    v_permlane32_swap_b32 v118, v142
    v_mov_b32 v190, v166
    v_mov_b32 v238, v214
    v_pk_mul_f32 v[116:117], v[116:117], v[40:41]
    v_permlane32_swap_b32 v166, v190
    v_permlane32_swap_b32 v214, v238
    v_cvt_pk_bf16_f32 v225, v226, v227
    v_cvt_pk_bf16_f32 v226, v228, v229
    v_cvt_pk_bf16_f32 v227, v230, v231
    v_pk_fma_f32 v[200:201], v[100:101], v[34:35], v[200:201] neg_lo:[0,1,0] neg_hi:[0,1,0]
    v_pk_fma_f32 v[202:203], v[102:103], v[34:35], v[202:203] neg_lo:[0,1,0] neg_hi:[0,1,0]
    v_pk_fma_f32 v[204:205], v[100:101], v[36:37], v[204:205] neg_lo:[0,1,0] neg_hi:[0,1,0]
    v_pk_fma_f32 v[206:207], v[102:103], v[36:37], v[206:207] neg_lo:[0,1,0] neg_hi:[0,1,0]
    v_cvt_pk_bf16_f32 v200, v200, v201
    v_cvt_pk_bf16_f32 v201, v202, v203
    v_cvt_pk_bf16_f32 v202, v204, v205
    v_cvt_pk_bf16_f32 v203, v206, v207
    v_pk_fma_f32 v[176:177], v[96:97], v[34:35], v[176:177] neg_lo:[0,1,0] neg_hi:[0,1,0]
    v_pk_fma_f32 v[178:179], v[98:99], v[34:35], v[178:179] neg_lo:[0,1,0] neg_hi:[0,1,0]
    v_pk_fma_f32 v[180:181], v[96:97], v[36:37], v[180:181] neg_lo:[0,1,0] neg_hi:[0,1,0]
    v_pk_fma_f32 v[182:183], v[98:99], v[36:37], v[182:183] neg_lo:[0,1,0] neg_hi:[0,1,0]
    v_cvt_pk_bf16_f32 v176, v176, v177
    v_cvt_pk_bf16_f32 v177, v178, v179
    v_cvt_pk_bf16_f32 v178, v180, v181
    v_cvt_pk_bf16_f32 v179, v182, v183
    v_pk_fma_f32 v[152:153], v[92:93], v[34:35], v[152:153] neg_lo:[0,1,0] neg_hi:[0,1,0]
    v_pk_fma_f32 v[154:155], v[94:95], v[34:35], v[154:155] neg_lo:[0,1,0] neg_hi:[0,1,0]
    v_pk_fma_f32 v[156:157], v[92:93], v[36:37], v[156:157] neg_lo:[0,1,0] neg_hi:[0,1,0]
    v_pk_fma_f32 v[158:159], v[94:95], v[36:37], v[158:159] neg_lo:[0,1,0] neg_hi:[0,1,0]
    v_cvt_pk_bf16_f32 v152, v152, v153
    v_cvt_pk_bf16_f32 v153, v154, v155
    v_cvt_pk_bf16_f32 v154, v156, v157
    v_cvt_pk_bf16_f32 v155, v158, v159
    v_pk_fma_f32 v[128:129], v[88:89], v[34:35], v[128:129] neg_lo:[0,1,0] neg_hi:[0,1,0]
    v_pk_fma_f32 v[130:131], v[90:91], v[34:35], v[130:131] neg_lo:[0,1,0] neg_hi:[0,1,0]
    v_pk_fma_f32 v[132:133], v[88:89], v[36:37], v[132:133] neg_lo:[0,1,0] neg_hi:[0,1,0]
    v_pk_fma_f32 v[134:135], v[90:91], v[36:37], v[134:135] neg_lo:[0,1,0] neg_hi:[0,1,0]
    v_cvt_pk_bf16_f32 v128, v128, v129
    v_cvt_pk_bf16_f32 v129, v130, v131
    v_cvt_pk_bf16_f32 v130, v132, v133
    v_cvt_pk_bf16_f32 v131, v134, v135
    v_mul_f32 v140, v140, v142
    v_mul_f32 v141, v141, v142
    v_cvt_pk_bf16_f32 v140, v140, v141
    v_perm_b32 v136, v140, v140, v20
    v_perm_b32 v137, v140, v140, v21
    v_perm_b32 v138, v140, v140, v22
    v_perm_b32 v139, v140, v140, v23
    v_mul_f32 v164, v164, v166
    v_mul_f32 v165, v165, v166
    v_cvt_pk_bf16_f32 v164, v164, v165
    v_perm_b32 v160, v164, v164, v20
    v_perm_b32 v161, v164, v164, v21
    v_perm_b32 v162, v164, v164, v22
    v_perm_b32 v163, v164, v164, v23
    v_mfma_f32_16x16x16_bf16 v[148:151], v[128:129], v[136:137], 0
    v_mfma_f32_16x16x16_bf16 v[156:159], v[130:131], v[136:137], 0
    v_mfma_f32_16x16x16_bf16 v[148:151], v[152:153], v[138:139], v[148:151]
    v_mfma_f32_16x16x16_bf16 v[156:159], v[154:155], v[138:139], v[156:159]
    v_mul_f32 v188, v188, v190
    v_mul_f32 v189, v189, v190
    v_cvt_pk_bf16_f32 v188, v188, v189
    v_perm_b32 v184, v188, v188, v20
    v_perm_b32 v185, v188, v188, v21
    v_perm_b32 v186, v188, v188, v22
    v_perm_b32 v187, v188, v188, v23
    v_mfma_f32_16x16x16_bf16 v[172:175], v[152:153], v[160:161], 0
    v_mfma_f32_16x16x16_bf16 v[180:183], v[154:155], v[160:161], 0
    v_mfma_f32_16x16x16_bf16 v[172:175], v[176:177], v[162:163], v[172:175]
    v_mfma_f32_16x16x16_bf16 v[180:183], v[178:179], v[162:163], v[180:183]
    v_mul_f32 v212, v212, v214
    v_mul_f32 v213, v213, v214
    v_cvt_pk_bf16_f32 v212, v212, v213
    v_perm_b32 v208, v212, v212, v20
    v_perm_b32 v209, v212, v212, v21
    v_perm_b32 v210, v212, v212, v22
    v_perm_b32 v211, v212, v212, v23
    v_mfma_f32_16x16x16_bf16 v[196:199], v[176:177], v[184:185], 0
    v_mfma_f32_16x16x16_bf16 v[204:207], v[178:179], v[184:185], 0
    v_mfma_f32_16x16x16_bf16 v[196:199], v[200:201], v[186:187], v[196:199]
    v_mfma_f32_16x16x16_bf16 v[204:207], v[202:203], v[186:187], v[204:207]
    v_cvt_pk_bf16_f32 v140, v148, v149
    v_cvt_pk_bf16_f32 v141, v150, v151
    v_cvt_pk_bf16_f32 v142, v156, v157
    v_cvt_pk_bf16_f32 v143, v158, v159
    buffer_store_dwordx4 v[140:143], v25, s[20:23], s66 offen sc1
    v_mul_f32 v236, v236, v238
    v_mul_f32 v237, v237, v238
    v_cvt_pk_bf16_f32 v236, v236, v237
    v_perm_b32 v232, v236, v236, v20
    v_perm_b32 v233, v236, v236, v21
    v_perm_b32 v234, v236, v236, v22
    v_perm_b32 v235, v236, v236, v23
    v_mfma_f32_16x16x16_bf16 v[220:223], v[200:201], v[208:209], 0
    v_mfma_f32_16x16x16_bf16 v[228:231], v[202:203], v[208:209], 0
    v_mfma_f32_16x16x16_bf16 v[220:223], v[224:225], v[210:211], v[220:223]
    v_mfma_f32_16x16x16_bf16 v[228:231], v[226:227], v[210:211], v[228:231]
    v_cvt_pk_bf16_f32 v164, v172, v173
    v_cvt_pk_bf16_f32 v165, v174, v175
    v_cvt_pk_bf16_f32 v166, v180, v181
    v_cvt_pk_bf16_f32 v167, v182, v183
    buffer_store_dwordx4 v[164:167], v25, s[20:23], s67 offen sc1
    v_mul_f32 v116, v116, v118
    v_mul_f32 v117, v117, v118
    v_cvt_pk_bf16_f32 v116, v116, v117
    v_perm_b32 v112, v116, v116, v20
    v_perm_b32 v113, v116, v116, v21
    v_perm_b32 v114, v116, v116, v22
    v_perm_b32 v115, v116, v116, v23
    v_mfma_f32_16x16x16_bf16 v[244:247], v[224:225], v[232:233], 0
    v_mfma_f32_16x16x16_bf16 v[252:255], v[226:227], v[232:233], 0
    v_mfma_f32_16x16x16_bf16 v[244:247], v[248:249], v[234:235], v[244:247]
    v_mfma_f32_16x16x16_bf16 v[252:255], v[250:251], v[234:235], v[252:255]
    v_cvt_pk_bf16_f32 v188, v196, v197
    v_cvt_pk_bf16_f32 v189, v198, v199
    v_cvt_pk_bf16_f32 v190, v204, v205
    v_cvt_pk_bf16_f32 v191, v206, v207
    buffer_store_dwordx4 v[188:191], v25, s[20:23], s68 offen sc1
    v_mfma_f32_16x16x16_bf16 v[124:127], v[60:61], v[112:113], 0
    v_mfma_f32_16x16x16_bf16 v[132:135], v[62:63], v[112:113], 0
    v_mfma_f32_16x16x16_bf16 v[124:127], v[128:129], v[114:115], v[124:127]
    v_mfma_f32_16x16x16_bf16 v[132:135], v[130:131], v[114:115], v[132:135]
    v_cvt_pk_bf16_f32 v212, v220, v221
    v_cvt_pk_bf16_f32 v213, v222, v223
    v_cvt_pk_bf16_f32 v214, v228, v229
    v_cvt_pk_bf16_f32 v215, v230, v231
    buffer_store_dwordx4 v[212:215], v25, s[20:23], s69 offen sc1
    v_cvt_pk_bf16_f32 v236, v244, v245
    v_cvt_pk_bf16_f32 v237, v246, v247
    v_cvt_pk_bf16_f32 v238, v252, v253
    v_cvt_pk_bf16_f32 v239, v254, v255
    buffer_store_dwordx4 v[236:239], v25, s[20:23], s70 offen sc1
    s_cmp_eq_u32 s41, 0
    s_cbranch_scc1 F_cdone
    v_cvt_pk_bf16_f32 v116, v124, v125
    v_cvt_pk_bf16_f32 v117, v126, v127
    v_cvt_pk_bf16_f32 v118, v132, v133
    v_cvt_pk_bf16_f32 v119, v134, v135
    buffer_store_dwordx4 v[116:119], v25, s[20:23], 0 offen sc1
F_cdone:
    s_mov_b64 exec, 1
    s_waitcnt vmcnt(0)
    ds_add_rtn_u32 v3, v1, v16 offset:20
    s_waitcnt lgkmcnt(0)
    v_readfirstlane_b32 s42, v3
    s_nop 0
    s_cmp_lg_u32 s42, 3
    s_cbranch_scc1 F_nfl
    buffer_store_dword v16, v33, s[20:23], 0 offen sc1
F_nfl:
    s_mov_b64 exec, -1
    s_setprio 0
F_help2:
    s_and_b32 s30, s28, 1
    s_lshl_b32 s30, s30, 3
    s_and_b32 s31, s28, 2
    s_lshl_b32 s31, s31, 1
    s_add_u32 s30, s30, s31
    s_lshr_b32 s31, s29, 3
    s_add_u32 s30, s30, s31
    s_and_b32 s34, s29, 7
    s_add_u32 s32, s28, 3
    s_and_b32 s32, s32, 7
    s_cmp_eq_u32 s29, 27
    s_cselect_b32 s34, s32, s34
    s_add_u32 s32, s32, 24
    s_cmp_eq_u32 s29, s32
    s_cselect_b32 s34, 3, s34
    s_and_b32 s32, s28, 4
    s_lshl_b32 s32, s32, 1
    s_add_u32 s32, s32, s34
    s_mov_b32 s20, s74
    s_mov_b32 s21, s75
    s_mov_b32 s22, 0x1000000
    s_mov_b32 s23, 0x20000
    s_branch F_sp_27_e
F_sp_27:
    s_sleep 1
F_sp_27_e:
    ds_read_b32 v16, v1 offset:24
    s_waitcnt lgkmcnt(0)
    v_readfirstlane_b32 s49, v16
    s_nop 0
    s_cmp_ge_u32 s49, 1
    s_cbranch_scc0 F_sp_27
    s_cmp_lg_u32 s3, 0
    s_cbranch_scc1 F_h2t
F_h2p:
    s_lshl_b32 s49, s30, 3
    s_mul_i32 s50, s49, 187
    s_lshr_b32 s50, s50, 11
    s_add_u32 s49, s49, 7
    s_mul_i32 s49, s49, 187
    s_lshr_b32 s49, s49, 11
    v_mov_b32 v16, s50
    v_mov_b32 v17, s49
    v_cmp_gt_u32 vcc, 16, v0
    s_nop 1
    v_cndmask_b32 v16, v17, v16, vcc
    v_and_b32 v17, 15, v0
    v_lshlrev_b32 v17, 7, v17
    v_lshl_add_u32 v8, v16, 11, v17
    v_add_u32 v8, 0x10000, v8
    s_mov_b32 s49, 0
    s_mov_b32 exec_hi, 0
    s_mov_b32 s52, -1
    s_mov_b32 s53, 0
F_opl_28:
    buffer_load_dword v16, v8, s[20:23], 0 offen sc1
    s_add_u32 s49, s49, 1
    s_waitcnt vmcnt(0)
    v_cmp_ne_u32 vcc, 0, v16
    s_nop 0
    s_or_b32 s53, s53, vcc_lo
    s_cmp_lt_u32 s49, 0x8000
    s_cselect_b32 s50, s53, s52
    s_mov_b32 exec_lo, 1
    v_mov_b32 v17, s50
    ds_or_b32 v1, v17 offset:28
    s_cmp_eq_u32 s50, s52
    s_cbranch_scc1 F_h2e
    s_not_b32 exec_lo, s53
    s_cmp_eq_u32 s53, 0
    s_cbranch_scc0 F_ops_29
    s_sleep 12
F_ops_29:
    s_sleep 8
    s_branch F_opl_28
F_h2t:
    s_lshl_b32 s35, s30, 7
    s_lshl_b32 s36, s3, 2
    v_add_u32 v2, s36, v1
    ds_read_b32 v10, v2 offset:276
    ds_read2_b32 v[2:3], v2 offset0:63 offset1:66
    v_lshrrev_b32 v4, 4, v0
    v_lshlrev_b32 v4, 15, v4
    v_and_b32 v5, 15, v0
    v_lshl_add_u32 v4, v5, 4, v4
    s_lshl_b32 s36, s32, 8
    s_add_u32 s36, s36, 0x600000
    v_add_u32 v4, s36, v4
    v_lshlrev_b32 v5, 4, v5
    v_add_u32 v5, 157184, v5
    v_min_u32 v7, 55, v0
    v_lshlrev_b32 v7, 7, v7
    v_add_u32 v7, 0x16000, v7
    s_waitcnt lgkmcnt(0)
    v_readfirstlane_b32 s60, v2
    v_readfirstlane_b32 s61, v3
    v_readfirstlane_b32 s62, v10
    s_sub_u32 s36, s3, 1
F_hl:
    s_and_b32 s49, s60, 0x7ff
    s_sub_u32 s49, 2047, s49
    s_sub_u32 s49, s49, s35
    s_cmp_lt_u32 s49, 128
    s_cbranch_scc0 F_hn
    s_mov_b32 s24, s72
    s_mov_b32 s25, s73
    s_mov_b32 s26, 0x100
    s_mov_b32 s27, 0x20000
    s_branch F_sp_31_e
F_sp_31:
    s_sleep 2
F_sp_31_e:
    ds_read_b32 v8, v1 offset:0
    s_waitcnt lgkmcnt(0)
    v_readfirstlane_b32 s49, v8
    s_nop 0
    s_cmp_ge_u32 s49, 4
    s_cbranch_scc0 F_sp_31
    v_mov_b32 v7, 64
    s_mov_b32 s49, 0
F_pl_32:
    buffer_load_dword v8, v7, s[24:27], 0 offen sc1
    s_waitcnt vmcnt(0)
F_pc_33:
    v_cmp_ne_u32 vcc, 0, v8
    s_nop 0
    s_cmp_eq_u64 vcc, -1
    s_cbranch_scc1 F_pd_34
    s_add_u32 s49, s49, 1
    s_cmp_lt_u32 s49, 0x8000
    s_cbranch_scc0 F_pd_34
    s_sleep 12
    s_branch F_pl_32
F_pd_34:
    s_branch F_sp_35_e
F_sp_35:
    s_sleep 2
F_sp_35_e:
    ds_read_b32 v8, v1 offset:0
    s_waitcnt lgkmcnt(0)
    v_readfirstlane_b32 s49, v8
    s_nop 0
    s_cmp_ge_u32 s49, 8
    s_cbranch_scc0 F_sp_35
    s_lshl_b32 s37, s36, 12
    buffer_load_dwordx4 v[16:19], v4, s[20:23], s37 offen sc1
    s_add_u32 s37, s37, 0x20000
    buffer_load_dwordx4 v[20:23], v4, s[20:23], s37 offen sc1
    s_add_u32 s37, s37, 0x20000
    buffer_load_dwordx4 v[24:27], v4, s[20:23], s37 offen sc1
    s_add_u32 s37, s37, 0x20000
    buffer_load_dwordx4 v[28:31], v4, s[20:23], s37 offen sc1
    s_add_u32 s37, s37, 0x20000
    buffer_load_dwordx4 v[32:35], v4, s[20:23], s37 offen sc1
    s_add_u32 s37, s37, 0x20000
    buffer_load_dwordx4 v[36:39], v4, s[20:23], s37 offen sc1
    s_add_u32 s37, s37, 0x20000
    buffer_load_dwordx4 v[40:43], v4, s[20:23], s37 offen sc1
    s_add_u32 s37, s37, 0x20000
    buffer_load_dwordx4 v[44:47], v4, s[20:23], s37 offen sc1
    s_add_u32 s37, s37, 0x20000
    buffer_load_dwordx4 v[48:51], v4, s[20:23], s37 offen sc1
    s_add_u32 s37, s37, 0x20000
    buffer_load_dwordx4 v[52:55], v4, s[20:23], s37 offen sc1
    s_add_u32 s37, s37, 0x20000
    buffer_load_dwordx4 v[56:59], v4, s[20:23], s37 offen sc1
    s_add_u32 s37, s37, 0x20000
    buffer_load_dwordx4 v[60:63], v4, s[20:23], s37 offen sc1
    s_add_u32 s37, s37, 0x20000
    buffer_load_dwordx4 v[64:67], v4, s[20:23], s37 offen sc1
    s_add_u32 s37, s37, 0x20000
    buffer_load_dwordx4 v[68:71], v4, s[20:23], s37 offen sc1
    s_lshr_b32 s50, s60, 16
    s_xor_b32 s51, s50, 0x8000
    s_xor_b32 s52, s50, 0xffff
    s_bitcmp1_b32 s50, 15
    s_cselect_b32 s50, s51, s52
    s_lshl_b32 s50, s50, 16
    v_mov_b32 v8, s50
    v_mul_f32 v8, 0xbfb8aa3b, v8
    v_exp_f32 v8, v8
    s_nop 0
    v_add_f32 v8, 1.0, v8
    v_rcp_f32 v8, v8
    s_nop 0
    v_cvt_pk_bf16_f32 v8, v8, v8
    v_and_b32 v8, s39, v8
    s_waitcnt vmcnt(12)
    v_pk_add_f32 v[16:17], v[16:17], v[20:21]
    v_pk_add_f32 v[18:19], v[18:19], v[22:23]
    s_waitcnt vmcnt(11)
    v_pk_add_f32 v[16:17], v[16:17], v[24:25]
    v_pk_add_f32 v[18:19], v[18:19], v[26:27]
    s_waitcnt vmcnt(10)
    v_pk_add_f32 v[16:17], v[16:17], v[28:29]
    v_pk_add_f32 v[18:19], v[18:19], v[30:31]
    s_waitcnt vmcnt(9)
    v_pk_add_f32 v[16:17], v[16:17], v[32:33]
    v_pk_add_f32 v[18:19], v[18:19], v[34:35]
    s_waitcnt vmcnt(8)
    v_pk_add_f32 v[16:17], v[16:17], v[36:37]
    v_pk_add_f32 v[18:19], v[18:19], v[38:39]
    s_waitcnt vmcnt(7)
    v_pk_add_f32 v[16:17], v[16:17], v[40:41]
    v_pk_add_f32 v[18:19], v[18:19], v[42:43]
    s_waitcnt vmcnt(6)
    v_pk_add_f32 v[16:17], v[16:17], v[44:45]
    v_pk_add_f32 v[18:19], v[18:19], v[46:47]
    s_waitcnt vmcnt(5)
    v_pk_add_f32 v[16:17], v[16:17], v[48:49]
    v_pk_add_f32 v[18:19], v[18:19], v[50:51]
    s_waitcnt vmcnt(4)
    v_pk_add_f32 v[16:17], v[16:17], v[52:53]
    v_pk_add_f32 v[18:19], v[18:19], v[54:55]
    s_waitcnt vmcnt(3)
    v_pk_add_f32 v[16:17], v[16:17], v[56:57]
    v_pk_add_f32 v[18:19], v[18:19], v[58:59]
    s_waitcnt vmcnt(2)
    v_pk_add_f32 v[16:17], v[16:17], v[60:61]
    v_pk_add_f32 v[18:19], v[18:19], v[62:63]
    s_waitcnt vmcnt(1)
    v_pk_add_f32 v[16:17], v[16:17], v[64:65]
    v_pk_add_f32 v[18:19], v[18:19], v[66:67]
    s_waitcnt vmcnt(0)
    v_pk_add_f32 v[16:17], v[16:17], v[68:69]
    v_pk_add_f32 v[18:19], v[18:19], v[70:71]
    v_mov_b32 v20, v16
    v_mov_b32 v21, v17
    v_mov_b32 v22, v18
    v_mov_b32 v23, v19
    v_permlane32_swap_b32 v16, v20
    v_permlane32_swap_b32 v17, v21
    v_permlane32_swap_b32 v18, v22
    v_permlane32_swap_b32 v19, v23
    v_pk_add_f32 v[16:17], v[16:17], v[20:21]
    v_pk_add_f32 v[18:19], v[18:19], v[22:23]
    v_mov_b32 v20, v16
    v_mov_b32 v21, v17
    v_mov_b32 v22, v18
    v_mov_b32 v23, v19
    v_permlane16_swap_b32 v16, v20
    v_permlane16_swap_b32 v17, v21
    v_permlane16_swap_b32 v18, v22
    v_permlane16_swap_b32 v19, v23
    v_pk_add_f32 v[16:17], v[16:17], v[20:21]
    v_pk_add_f32 v[18:19], v[18:19], v[22:23]
    v_cvt_pk_bf16_f32 v20, v16, v17
    v_cvt_pk_bf16_f32 v21, v18, v19
    v_lshlrev_b32 v16, 16, v20
    v_and_b32 v17, s39, v20
    v_lshlrev_b32 v18, 16, v21
    v_and_b32 v19, s39, v21
    v_mul_f32 v16, v16, v8
    v_mul_f32 v17, v17, v8
    v_mul_f32 v18, v18, v8
    v_mul_f32 v19, v19, v8
    v_cvt_pk_bf16_f32 v20, v16, v17
    v_cvt_pk_bf16_f32 v21, v18, v19
    v_lshlrev_b32 v16, 16, v20
    v_and_b32 v17, s39, v20
    v_lshlrev_b32 v18, 16, v21
    v_and_b32 v19, s39, v21
    s_lshl_b32 s37, s36, 8
    v_add_u32 v6, s37, v5
    ds_write_b128 v6, v[16:19]
F_hn:
    s_mov_b32 s60, s61
    s_mov_b32 s61, s62
    s_add_u32 s36, s36, 3
    s_cmp_lt_u32 s36, 8
    s_cbranch_scc1 F_hl
    v_mov_b32 v9, 1
    s_mov_b64 exec, 1
    s_waitcnt lgkmcnt(0)
    ds_add_u32 v1, v9 offset:32
F_h2e:
    s_endpgm
F_moe:
    s_load_dwordx8 s[64:71], s[0:1], 32
    s_mov_b32 s60, 0x3a800000
    v_lshlrev_b32 v13, 2, v0
    v_add_u32 v13, 147456, v13
    v_mov_b32 v14, 0
    v_cmp_lt_u32 vcc, 10, v0
    ds_write_b32 v13, v14 offset:11776
    ds_write_b32 v13, v14 offset:256
    v_cndmask_b32 v15, 0, 4, vcc
    ds_write_b32 v13, v15
    s_and_b32 s33, s28, 1
    s_lshl_b32 s33, s33, 10
    s_lshr_b32 s36, s28, 1
    s_lshl_b32 s36, s36, 8
    s_add_u32 s33, s33, s36
    s_sub_u32 s36, s29, 24
    s_lshl_b32 s36, s36, 5
    s_add_u32 s33, s33, s36
    s_lshl_b32 s36, s3, 2
    s_add_u32 s33, s33, s36
    s_mul_i32 s30, s28, 7
    s_add_u32 s30, s30, s29
    s_sub_u32 s30, s30, 24
    s_cmp_eq_u32 s29, 31
    s_cselect_b32 s30, 0, s30
    s_lshl_b32 s45, s3, 14
    v_bfe_u32 v13, v0, 2, 3
    v_lshrrev_b32 v14, 1, v13
    v_xor_b32 v14, 0, v14
    v_lshlrev_b32 v1, 5, v14
    v_lshl_add_u32 v1, v13, 7, v1
    v_and_b32 v13, 3, v0
    v_lshl_add_u32 v1, v13, 3, v1
    v_lshrrev_b32 v13, 5, v0
    v_lshl_add_u32 v1, v13, 11, v1
    v_add_u32 v1, s45, v1
    v_bfe_u32 v13, v0, 2, 3
    v_lshrrev_b32 v14, 1, v13
    v_xor_b32 v14, 1, v14
    v_lshlrev_b32 v2, 5, v14
    v_lshl_add_u32 v2, v13, 7, v2
    v_and_b32 v13, 3, v0
    v_lshl_add_u32 v2, v13, 3, v2
    v_lshrrev_b32 v13, 5, v0
    v_lshl_add_u32 v2, v13, 11, v2
    v_add_u32 v2, s45, v2
    v_bfe_u32 v13, v0, 2, 3
    v_lshrrev_b32 v14, 1, v13
    v_xor_b32 v14, 2, v14
    v_lshlrev_b32 v3, 5, v14
    v_lshl_add_u32 v3, v13, 7, v3
    v_and_b32 v13, 3, v0
    v_lshl_add_u32 v3, v13, 3, v3
    v_lshrrev_b32 v13, 5, v0
    v_lshl_add_u32 v3, v13, 11, v3
    v_add_u32 v3, s45, v3
    v_bfe_u32 v13, v0, 2, 3
    v_lshrrev_b32 v14, 1, v13
    v_xor_b32 v14, 3, v14
    v_lshlrev_b32 v4, 5, v14
    v_lshl_add_u32 v4, v13, 7, v4
    v_and_b32 v13, 3, v0
    v_lshl_add_u32 v4, v13, 3, v4
    v_lshrrev_b32 v13, 5, v0
    v_lshl_add_u32 v4, v13, 11, v4
    v_add_u32 v4, s45, v4
    s_mov_b32 s36, 7168
    v_lshrrev_b32 v13, 3, v0
    v_and_b32 v14, 6, v13
    v_and_b32 v5, 7, v0
    v_xor_b32 v5, v5, v14
    v_lshlrev_b32 v5, 4, v5
    v_and_b32 v14, 4, v13
    v_add_u32 v13, v13, v14
    v_mul_lo_u32 v13, v13, s36
    v_add_u32 v5, v5, v13
    s_lshl_b32 s36, s30, 7
    s_mul_i32 s37, s3, 917504
    s_add_u32 s36, s36, s37
    v_add_u32 v5, s36, v5
    v_add_u32 v6, 27648, v5
    v_add_u32 v7, 112640, v5
    v_add_u32 v8, 140288, v5
    s_mov_b32 s36, 2048
    v_lshrrev_b32 v13, 3, v0
    v_and_b32 v14, 6, v13
    v_and_b32 v9, 7, v0
    v_xor_b32 v9, v9, v14
    v_lshlrev_b32 v9, 4, v9
    v_mul_lo_u32 v13, v13, s36
    v_add_u32 v9, v9, v13
    s_lshl_b32 s36, s30, 17
    s_lshl_b32 s37, s3, 8
    s_add_u32 s36, s36, s37
    v_add_u32 v9, s36, v9
    v_add_u32 v10, 31744, v9
    v_add_u32 v11, 14336, v9
    v_add_u32 v12, 46080, v9
    s_waitcnt lgkmcnt(0)
    s_mov_b32 s76, s4
    s_mov_b32 s77, s5
    s_mov_b32 s78, 0x400000
    s_mov_b32 s79, 0x20000
    s_mov_b32 s80, s64
    s_mov_b32 s81, s65
    s_mov_b32 s82, 0x800
    s_mov_b32 s83, 0x20000
    s_mov_b32 s20, s74
    s_mov_b32 s21, s75
    s_mov_b32 s22, 0x1000000
    s_mov_b32 s23, 0x20000
    s_cmp_lg_u32 s2, 252
    s_cbranch_scc1 F_nz
    s_mov_b32 s24, s72
    s_mov_b32 s25, s73
    s_mov_b32 s26, 0x100
    s_mov_b32 s27, 0x20000
    s_lshl_b32 s36, s3, 10
    s_add_u32 s36, s36, 0x18000
    v_lshlrev_b32 v13, 4, v0
    v_mov_b64 v[144:145], 0
    v_mov_b64 v[146:147], 0
    buffer_store_dwordx4 v[144:147], v13, s[20:23], s36 offen sc1
    v_mov_b32 v14, 1
    s_waitcnt vmcnt(0)
    s_barrier
    s_cmp_lg_u32 s3, 0
    s_cbranch_scc1 F_nz1
    s_mov_b64 exec, 1
    buffer_store_dword v14, v145, s[24:27], 0 offen sc1
    s_mov_b64 exec, -1
F_nz1:
    s_lshl_b32 s36, s3, 12
    s_add_u32 s36, s36, 0x10000
    v_lshlrev_b32 v13, 7, v0
    v_mov_b32 v15, 0
    s_mov_b32 exec_hi, 0
    buffer_store_dword v15, v13, s[20:23], s36 offen sc1
    s_mov_b32 exec_hi, -1
F_nz:
    s_mov_b32 s8, s6
    s_mov_b32 s9, s7
    s_mov_b32 s10, 0x600000
    s_mov_b32 s11, 0x20000
    s_sub_u32 s36, s29, 24
    s_lshl_b32 s36, s36, 3
    s_add_u32 s36, s36, s3
    s_lshl_b32 s36, s36, 1
    s_and_b32 s37, s28, 1
    s_add_u32 s36, s36, s37
    s_mul_i32 s36, s36, 16384
    s_lshr_b32 s37, s28, 1
    s_lshl_b32 s37, s37, 9
    s_add_u32 s36, s36, s37
    s_add_u32 s36, s36, 393216
    v_lshrrev_b32 v13, 2, v0
    v_lshlrev_b32 v13, 11, v13
    v_and_b32 v14, 3, v0
    v_lshl_add_u32 v13, v14, 7, v13
    s_mov_b32 exec_hi, 0x0
    buffer_load_dword v15, v13, s[8:11], s36 offen
    s_mov_b64 exec, -1
    v_lshlrev_b32 v16, 4, v0
    s_lshl_b32 s54, s33, 11
    s_add_u32 s55, s54, 0x1000
    buffer_load_dwordx4 v[24:27], v16, s[76:79], s54 offen offset:0
    buffer_load_dwordx4 v[32:35], v16, s[76:79], s54 offen offset:2048
    buffer_load_dwordx4 v[40:43], v16, s[76:79], s55 offen offset:0
    buffer_load_dwordx4 v[48:51], v16, s[76:79], s55 offen offset:2048
    buffer_load_dwordx4 v[28:31], v16, s[76:79], s54 offen offset:1024
    buffer_load_dwordx4 v[36:39], v16, s[76:79], s54 offen offset:3072
    buffer_load_dwordx4 v[44:47], v16, s[76:79], s55 offen offset:1024
    buffer_load_dwordx4 v[52:55], v16, s[76:79], s55 offen offset:3072
    buffer_load_dwordx4 v[56:59], v16, s[80:83], 0 offen offset:0
    buffer_load_dwordx4 v[60:63], v16, s[80:83], 0 offen offset:1024
    s_mov_b32 s8, s66
    s_mov_b32 s9, s67
    s_mov_b32 s10, 0x700000
    s_mov_b32 s11, 0x20000
    s_mov_b32 s12, s68
    s_mov_b32 s13, s69
    s_mov_b32 s14, 0x700000
    s_mov_b32 s15, 0x20000
    s_mov_b32 s16, s70
    s_mov_b32 s17, s71
    s_mov_b32 s18, 0x700000
    s_mov_b32 s19, 0x20000
    s_mov_b32 s24, s72
    s_mov_b32 s25, s73
    s_mov_b32 s26, 0x100
    s_mov_b32 s27, 0x20000
    v_mov_b32 v145, 0
    v_mov_b32 v144, 0
    s_cmp_eq_u32 s29, 31
    s_cselect_b32 s18, 0, s18
    s_mov_b32 s52, 0x3f803f80
    s_waitcnt vmcnt(5)
    v_dot2_f32_bf16 v64, v24, s52, 0
    v_dot2_f32_bf16 v68, v24, v24, 0
    v_dot2_f32_bf16 v64, v25, s52, v64
    v_dot2_f32_bf16 v68, v25, v25, v68
    v_dot2_f32_bf16 v64, v26, s52, v64
    v_dot2_f32_bf16 v68, v26, v26, v68
    v_dot2_f32_bf16 v64, v27, s52, v64
    v_dot2_f32_bf16 v68, v27, v27, v68
    v_dot2_f32_bf16 v64, v28, s52, v64
    v_dot2_f32_bf16 v68, v28, v28, v68
    v_dot2_f32_bf16 v64, v29, s52, v64
    v_dot2_f32_bf16 v68, v29, v29, v68
    v_dot2_f32_bf16 v64, v30, s52, v64
    v_dot2_f32_bf16 v68, v30, v30, v68
    v_dot2_f32_bf16 v64, v31, s52, v64
    v_dot2_f32_bf16 v68, v31, v31, v68
    s_waitcnt vmcnt(4)
    v_dot2_f32_bf16 v65, v32, s52, 0
    v_dot2_f32_bf16 v69, v32, v32, 0
    v_dot2_f32_bf16 v65, v33, s52, v65
    v_dot2_f32_bf16 v69, v33, v33, v69
    v_dot2_f32_bf16 v65, v34, s52, v65
    v_dot2_f32_bf16 v69, v34, v34, v69
    v_dot2_f32_bf16 v65, v35, s52, v65
    v_dot2_f32_bf16 v69, v35, v35, v69
    v_dot2_f32_bf16 v65, v36, s52, v65
    v_dot2_f32_bf16 v69, v36, v36, v69
    v_dot2_f32_bf16 v65, v37, s52, v65
    v_dot2_f32_bf16 v69, v37, v37, v69
    v_dot2_f32_bf16 v65, v38, s52, v65
    v_dot2_f32_bf16 v69, v38, v38, v69
    v_dot2_f32_bf16 v65, v39, s52, v65
    v_dot2_f32_bf16 v69, v39, v39, v69
    s_waitcnt vmcnt(3)
    v_dot2_f32_bf16 v66, v40, s52, 0
    v_dot2_f32_bf16 v70, v40, v40, 0
    v_dot2_f32_bf16 v66, v41, s52, v66
    v_dot2_f32_bf16 v70, v41, v41, v70
    v_dot2_f32_bf16 v66, v42, s52, v66
    v_dot2_f32_bf16 v70, v42, v42, v70
    v_dot2_f32_bf16 v66, v43, s52, v66
    v_dot2_f32_bf16 v70, v43, v43, v70
    v_dot2_f32_bf16 v66, v44, s52, v66
    v_dot2_f32_bf16 v70, v44, v44, v70
    v_dot2_f32_bf16 v66, v45, s52, v66
    v_dot2_f32_bf16 v70, v45, v45, v70
    v_dot2_f32_bf16 v66, v46, s52, v66
    v_dot2_f32_bf16 v70, v46, v46, v70
    v_dot2_f32_bf16 v66, v47, s52, v66
    v_dot2_f32_bf16 v70, v47, v47, v70
    s_waitcnt vmcnt(2)
    v_dot2_f32_bf16 v67, v48, s52, 0
    v_dot2_f32_bf16 v71, v48, v48, 0
    v_dot2_f32_bf16 v67, v49, s52, v67
    v_dot2_f32_bf16 v71, v49, v49, v71
    v_dot2_f32_bf16 v67, v50, s52, v67
    v_dot2_f32_bf16 v71, v50, v50, v71
    v_dot2_f32_bf16 v67, v51, s52, v67
    v_dot2_f32_bf16 v71, v51, v51, v71
    v_dot2_f32_bf16 v67, v52, s52, v67
    v_dot2_f32_bf16 v71, v52, v52, v71
    v_dot2_f32_bf16 v67, v53, s52, v67
    v_dot2_f32_bf16 v71, v53, v53, v71
    v_dot2_f32_bf16 v67, v54, s52, v67
    v_dot2_f32_bf16 v71, v54, v54, v71
    v_dot2_f32_bf16 v67, v55, s52, v67
    v_dot2_f32_bf16 v71, v55, v55, v71
    s_waitcnt vmcnt(0)
    v_dot2_f32_bf16 v72, v24, v56, 0
    v_dot2_f32_bf16 v73, v32, v56, 0
    v_dot2_f32_bf16 v74, v40, v56, 0
    v_dot2_f32_bf16 v75, v48, v56, 0
    v_dot2_f32_bf16 v76, v56, s52, 0
    v_dot2_f32_bf16 v72, v25, v57, v72
    v_dot2_f32_bf16 v73, v33, v57, v73
    v_dot2_f32_bf16 v74, v41, v57, v74
    v_dot2_f32_bf16 v75, v49, v57, v75
    v_dot2_f32_bf16 v76, v57, s52, v76
    v_dot2_f32_bf16 v72, v26, v58, v72
    v_dot2_f32_bf16 v73, v34, v58, v73
    v_dot2_f32_bf16 v74, v42, v58, v74
    v_dot2_f32_bf16 v75, v50, v58, v75
    v_dot2_f32_bf16 v76, v58, s52, v76
    v_dot2_f32_bf16 v72, v27, v59, v72
    v_dot2_f32_bf16 v73, v35, v59, v73
    v_dot2_f32_bf16 v74, v43, v59, v74
    v_dot2_f32_bf16 v75, v51, v59, v75
    v_dot2_f32_bf16 v76, v59, s52, v76
    v_dot2_f32_bf16 v72, v28, v60, v72
    v_dot2_f32_bf16 v73, v36, v60, v73
    v_dot2_f32_bf16 v74, v44, v60, v74
    v_dot2_f32_bf16 v75, v52, v60, v75
    v_dot2_f32_bf16 v76, v60, s52, v76
    v_dot2_f32_bf16 v72, v29, v61, v72
    v_dot2_f32_bf16 v73, v37, v61, v73
    v_dot2_f32_bf16 v74, v45, v61, v74
    v_dot2_f32_bf16 v75, v53, v61, v75
    v_dot2_f32_bf16 v76, v61, s52, v76
    v_dot2_f32_bf16 v72, v30, v62, v72
    v_dot2_f32_bf16 v73, v38, v62, v73
    v_dot2_f32_bf16 v74, v46, v62, v74
    v_dot2_f32_bf16 v75, v54, v62, v75
    v_dot2_f32_bf16 v76, v62, s52, v76
    v_dot2_f32_bf16 v72, v31, v63, v72
    v_dot2_f32_bf16 v73, v39, v63, v73
    v_dot2_f32_bf16 v74, v47, v63, v74
    v_dot2_f32_bf16 v75, v55, v63, v75
    v_dot2_f32_bf16 v76, v63, s52, v76
    v_bfe_u32 v23, v0, 4, 1
    v_lshrrev_b32 v22, 5, v0
    v_lshl_add_u32 v23, v23, 1, v22
    v_add_u32 v23, s33, v23
    v_mov_b32 v77, v76
    v_mov_b32 v78, v76
    v_mov_b32 v79, v76
    v_permlane32_swap_b32 v64, v65
    v_permlane32_swap_b32 v68, v69
    v_permlane32_swap_b32 v72, v73
    v_permlane32_swap_b32 v76, v77
    v_permlane32_swap_b32 v66, v67
    v_permlane32_swap_b32 v70, v71
    v_permlane32_swap_b32 v74, v75
    v_permlane32_swap_b32 v78, v79
    v_add_f32 v64, v64, v65
    v_add_f32 v68, v68, v69
    v_add_f32 v72, v72, v73
    v_add_f32 v76, v76, v77
    v_add_f32 v66, v66, v67
    v_add_f32 v70, v70, v71
    v_add_f32 v74, v74, v75
    v_add_f32 v78, v78, v79
    v_permlane16_swap_b32 v64, v66
    v_permlane16_swap_b32 v68, v70
    v_permlane16_swap_b32 v72, v74
    v_permlane16_swap_b32 v76, v78
    v_add_f32 v64, v64, v66
    v_add_f32 v68, v68, v70
    v_add_f32 v72, v72, v74
    v_add_f32 v76, v76, v78
    v_add_f32_dpp v64, v64, v64 quad_perm:[1,0,3,2] row_mask:0xf bank_mask:0xf
    v_add_f32_dpp v68, v68, v68 quad_perm:[1,0,3,2] row_mask:0xf bank_mask:0xf
    v_add_f32_dpp v72, v72, v72 quad_perm:[1,0,3,2] row_mask:0xf bank_mask:0xf
    v_add_f32_dpp v76, v76, v76 quad_perm:[1,0,3,2] row_mask:0xf bank_mask:0xf
    v_add_f32_dpp v64, v64, v64 quad_perm:[2,3,0,1] row_mask:0xf bank_mask:0xf
    v_add_f32_dpp v68, v68, v68 quad_perm:[2,3,0,1] row_mask:0xf bank_mask:0xf
    v_add_f32_dpp v72, v72, v72 quad_perm:[2,3,0,1] row_mask:0xf bank_mask:0xf
    v_add_f32_dpp v76, v76, v76 quad_perm:[2,3,0,1] row_mask:0xf bank_mask:0xf
    v_add_f32_dpp v64, v64, v64 row_half_mirror row_mask:0xf bank_mask:0xf
    v_add_f32_dpp v68, v68, v68 row_half_mirror row_mask:0xf bank_mask:0xf
    v_add_f32_dpp v72, v72, v72 row_half_mirror row_mask:0xf bank_mask:0xf
    v_add_f32_dpp v76, v76, v76 row_half_mirror row_mask:0xf bank_mask:0xf
    v_add_f32_dpp v64, v64, v64 row_mirror row_mask:0xf bank_mask:0xf
    v_add_f32_dpp v68, v68, v68 row_mirror row_mask:0xf bank_mask:0xf
    v_add_f32_dpp v72, v72, v72 row_mirror row_mask:0xf bank_mask:0xf
    v_add_f32_dpp v76, v76, v76 row_mirror row_mask:0xf bank_mask:0xf
    v_mul_f32 v16, s60, v64
    v_cvt_pk_bf16_f32 v20, v16, v16
    v_and_b32 v20, s39, v20
    v_mul_f32 v16, v16, v16
    v_fma_f32 v16, v68, s60, -v16
    v_max_f32 v16, 0, v16
    v_fma_f32 v17, -v20, v76, v72
    v_cvt_pk_bf16_f32 v16, v16, v16
    v_and_b32 v16, s39, v16
    v_add_f32 v16, 0x3727c5ac, v16
    v_cvt_pk_bf16_f32 v16, v16, v16
    v_and_b32 v16, s39, v16
    v_sqrt_f32 v16, v16
    s_nop 0
    v_cvt_pk_bf16_f32 v16, v16, v16
    v_and_b32 v16, s39, v16
    v_rcp_f32 v21, v16
    s_nop 0
    v_mul_f32 v16, v17, v21
    v_cvt_pk_bf16_f32 v16, v16, v16
    v_and_b32 v16, s39, v16
    v_ashrrev_i32 v17, 31, v16
    v_or_b32 v17, 0x80000000, v17
    v_xor_b32 v16, v16, v17
    v_and_b32 v16, s39, v16
    v_sub_u32 v17, 0x7ff, v23
    v_or_b32 v22, v16, v17
    s_cmp_lg_u32 s3, 0
    s_cbranch_scc1 F_nzl
    buffer_load_dword v144, v145, s[24:27], 0 offen sc1
F_nzl:
    v_lshlrev_b32 v16, 2, v23
    v_lshlrev_b32 v17, 3, v23
    s_mov_b32 s46, 0x4000
    s_mov_b32 exec_lo, 0x10001
    s_mov_b32 exec_hi, 0x10001
    buffer_store_dword v22, v16, s[20:23], 0 offen sc1
    buffer_store_dwordx2 v[20:21], v17, s[20:23], s46 offen sc1
    s_mov_b64 exec, -1
    s_add_u32 m0, s45, 0
    s_mov_b32 s46, 0
    buffer_load_dwordx4 v9, s[16:19], s46 offen offset:0 nt lds
    buffer_load_dwordx4 v10, s[16:19], s46 offen offset:1024 nt lds
    buffer_load_dwordx4 v11, s[16:19], s46 offen offset:2048 nt lds
    buffer_load_dwordx4 v12, s[16:19], s46 offen offset:3072 nt lds
    s_add_u32 m0, s45, 4096
    s_mov_b32 s46, 65536
    buffer_load_dwordx4 v9, s[16:19], s46 offen offset:0 nt lds
    buffer_load_dwordx4 v10, s[16:19], s46 offen offset:1024 nt lds
    buffer_load_dwordx4 v11, s[16:19], s46 offen offset:2048 nt lds
    buffer_load_dwordx4 v12, s[16:19], s46 offen offset:3072 nt lds
    s_sub_u32 s47, s2, 192
    s_lshl_b32 s47, s47, 1
    v_mov_b32 v13, s47
    v_mov_b32 v15, 1
    s_waitcnt vmcnt(8)
    s_barrier
    s_cmp_lg_u32 s3, 0
    s_cbranch_scc1 F_na
    s_mov_b32 s47, 0
    s_branch F_pc_37
F_pl_36:
    buffer_load_dword v144, v145, s[24:27], 0 offen sc1
    s_waitcnt vmcnt(0)
F_pc_37:
    v_cmp_ne_u32 vcc, 0, v144
    s_nop 0
    s_cmp_eq_u64 vcc, -1
    s_cbranch_scc1 F_pd_38
    s_add_u32 s47, s47, 1
    s_cmp_lt_u32 s47, 0x8000
    s_cbranch_scc0 F_pd_38
    s_sleep 8
    s_branch F_pl_36
F_pd_38:
    v_lshlrev_b32 v13, 6, v13
    v_add_u32 v13, 0x18000, v13
    s_mov_b64 exec, 1
    buffer_store_dword v15, v13, s[20:23], 0 offen sc1
    s_mov_b64 exec, -1
F_na:
    s_add_u32 m0, s45, 8192
    s_mov_b32 s46, 128
    buffer_load_dwordx4 v9, s[16:19], s46 offen offset:0 nt lds
    buffer_load_dwordx4 v10, s[16:19], s46 offen offset:1024 nt lds
    buffer_load_dwordx4 v11, s[16:19], s46 offen offset:2048 nt lds
    buffer_load_dwordx4 v12, s[16:19], s46 offen offset:3072 nt lds
    s_add_u32 m0, s45, 12288
    s_mov_b32 s46, 65664
    buffer_load_dwordx4 v9, s[16:19], s46 offen offset:0 nt lds
    buffer_load_dwordx4 v10, s[16:19], s46 offen offset:1024 nt lds
    buffer_load_dwordx4 v11, s[16:19], s46 offen offset:2048 nt lds
    buffer_load_dwordx4 v12, s[16:19], s46 offen offset:3072 nt lds
    s_cmp_eq_u32 s28, 4
    s_cselect_b32 s36, 30, 31
    s_cmp_lg_u32 s29, s36
    s_cbranch_scc1 F_sc0
    s_add_u32 s36, s3, 32
    s_mov_b32 s80, s6
    s_mov_b32 s81, s7
    s_mov_b32 s82, 0x600000
    s_mov_b32 s83, 0x20000
    s_lshl_b32 s37, s36, 1
    s_and_b32 s38, s28, 1
    s_add_u32 s37, s37, s38
    s_lshl_b32 s37, s37, 15
    s_lshr_b32 s38, s28, 1
    s_lshl_b32 s38, s38, 9
    s_add_u32 s37, s37, s38
    s_add_u32 s37, s37, 393216
    v_lshrrev_b32 v13, 2, v0
    v_lshlrev_b32 v13, 11, v13
    v_and_b32 v14, 3, v0
    v_lshl_add_u32 v13, v14, 7, v13
    buffer_load_dword v200, v13, s[80:83], s37 offen
F_sc0:
    s_cmp_lg_u32 s28, 4
    s_cbranch_scc1 F_nuc
    s_cmp_ge_u32 s29, 30
    s_cbranch_scc1 F_nuc
    s_sub_u32 s36, 7, s3
    s_mul_i32 s36, s36, 6
    s_add_u32 s36, s36, s29
    s_add_u32 s36, s36, 40
    s_cmp_ge_u32 s36, 78
    s_cbranch_scc1 F_nuc
    s_mov_b32 s80, s6
    s_mov_b32 s81, s7
    s_mov_b32 s82, 0x600000
    s_mov_b32 s83, 0x20000
    s_lshl_b32 s37, s36, 1
    s_and_b32 s38, s28, 1
    s_add_u32 s37, s37, s38
    s_lshl_b32 s37, s37, 15
    s_lshr_b32 s38, s28, 1
    s_lshl_b32 s38, s38, 9
    s_add_u32 s37, s37, s38
    s_add_u32 s37, s37, 393216
    v_lshrrev_b32 v13, 2, v0
    v_lshlrev_b32 v13, 11, v13
    v_and_b32 v14, 3, v0
    v_lshl_add_u32 v13, v14, 7, v13
    buffer_load_dword v15, v13, s[80:83], s37 offen
F_nuc:
    v_and_b32 v13, 7, v0
    v_lshlrev_b32 v13, 2, v13
    s_cmp_eq_u32 s29, 31
    s_cbranch_scc1 F_spare
    s_waitcnt vmcnt(8)
    ds_read_b64_tr_b16 v[64:65], v1 offset:0
    ds_read_b64_tr_b16 v[66:67], v1 offset:1024
    ds_read_b64_tr_b16 v[68:69], v2 offset:0
    ds_read_b64_tr_b16 v[70:71], v2 offset:1024
    ds_read_b64_tr_b16 v[72:73], v3 offset:0
    ds_read_b64_tr_b16 v[74:75], v3 offset:1024
    ds_read_b64_tr_b16 v[76:77], v4 offset:0
    ds_read_b64_tr_b16 v[78:79], v4 offset:1024
    ds_read_b64_tr_b16 v[96:97], v1 offset:4096
    ds_read_b64_tr_b16 v[98:99], v1 offset:5120
    ds_read_b64_tr_b16 v[100:101], v2 offset:4096
    ds_read_b64_tr_b16 v[102:103], v2 offset:5120
    s_waitcnt lgkmcnt(8)
    ds_read_b64_tr_b16 v[104:105], v3 offset:4096
    ds_read_b64_tr_b16 v[106:107], v3 offset:5120
    ds_read_b64_tr_b16 v[108:109], v4 offset:4096
    ds_read_b64_tr_b16 v[110:111], v4 offset:5120
    s_waitcnt lgkmcnt(0)
    s_add_u32 m0, s45, 0
    s_mov_b32 s46, 0
    buffer_load_dwordx4 v5, s[8:11], s46 offen offset:0 nt lds
    buffer_load_dwordx4 v6, s[8:11], s46 offen offset:1024 nt lds
    buffer_load_dwordx4 v7, s[8:11], s46 offen offset:2048 nt lds
    buffer_load_dwordx4 v8, s[8:11], s46 offen offset:3072 nt lds
    s_add_u32 m0, s45, 4096
    s_mov_b32 s46, 229376
    buffer_load_dwordx4 v5, s[8:11], s46 offen offset:0 nt lds
    buffer_load_dwordx4 v6, s[8:11], s46 offen offset:1024 nt lds
    buffer_load_dwordx4 v7, s[8:11], s46 offen offset:2048 nt lds
    buffer_load_dwordx4 v8, s[8:11], s46 offen offset:3072 nt lds
    s_waitcnt vmcnt(8)
    ds_read_b64_tr_b16 v[80:81], v1 offset:8192
    ds_read_b64_tr_b16 v[82:83], v1 offset:9216
    ds_read_b64_tr_b16 v[84:85], v2 offset:8192
    ds_read_b64_tr_b16 v[86:87], v2 offset:9216
    ds_read_b64_tr_b16 v[88:89], v3 offset:8192
    ds_read_b64_tr_b16 v[90:91], v3 offset:9216
    ds_read_b64_tr_b16 v[92:93], v4 offset:8192
    ds_read_b64_tr_b16 v[94:95], v4 offset:9216
    ds_read_b64_tr_b16 v[112:113], v1 offset:12288
    ds_read_b64_tr_b16 v[114:115], v1 offset:13312
    ds_read_b64_tr_b16 v[116:117], v2 offset:12288
    ds_read_b64_tr_b16 v[118:119], v2 offset:13312
    s_waitcnt lgkmcnt(8)
    ds_read_b64_tr_b16 v[120:121], v3 offset:12288
    ds_read_b64_tr_b16 v[122:123], v3 offset:13312
    ds_read_b64_tr_b16 v[124:125], v4 offset:12288
    ds_read_b64_tr_b16 v[126:127], v4 offset:13312
    s_waitcnt lgkmcnt(0)
    s_add_u32 m0, s45, 8192
    s_mov_b32 s46, 458752
    buffer_load_dwordx4 v5, s[8:11], s46 offen offset:0 nt lds
    buffer_load_dwordx4 v6, s[8:11], s46 offen offset:1024 nt lds
    buffer_load_dwordx4 v7, s[8:11], s46 offen offset:2048 nt lds
    buffer_load_dwordx4 v8, s[8:11], s46 offen offset:3072 nt lds
    s_add_u32 m0, s45, 12288
    s_mov_b32 s46, 688128
    buffer_load_dwordx4 v5, s[8:11], s46 offen offset:0 nt lds
    buffer_load_dwordx4 v6, s[8:11], s46 offen offset:1024 nt lds
    buffer_load_dwordx4 v7, s[8:11], s46 offen offset:2048 nt lds
    buffer_load_dwordx4 v8, s[8:11], s46 offen offset:3072 nt lds
    s_waitcnt vmcnt(8)
    ds_read_b64_tr_b16 v[128:129], v1 offset:0
    ds_read_b64_tr_b16 v[130:131], v1 offset:1024
    ds_read_b64_tr_b16 v[132:133], v2 offset:0
    ds_read_b64_tr_b16 v[134:135], v2 offset:1024
    ds_read_b64_tr_b16 v[136:137], v3 offset:0
    ds_read_b64_tr_b16 v[138:139], v3 offset:1024
    ds_read_b64_tr_b16 v[140:141], v4 offset:0
    ds_read_b64_tr_b16 v[142:143], v4 offset:1024
    ds_read_b64_tr_b16 v[144:145], v1 offset:4096
    ds_read_b64_tr_b16 v[146:147], v1 offset:5120
    ds_read_b64_tr_b16 v[148:149], v2 offset:4096
    ds_read_b64_tr_b16 v[150:151], v2 offset:5120
    s_waitcnt lgkmcnt(8)
    ds_read_b64_tr_b16 v[152:153], v3 offset:4096
    ds_read_b64_tr_b16 v[154:155], v3 offset:5120
    ds_read_b64_tr_b16 v[156:157], v4 offset:4096
    ds_read_b64_tr_b16 v[158:159], v4 offset:5120
    s_waitcnt lgkmcnt(0)
    s_add_u32 m0, s45, 0
    s_mov_b32 s46, 0
    buffer_load_dwordx4 v5, s[12:15], s46 offen offset:0 nt lds
    buffer_load_dwordx4 v6, s[12:15], s46 offen offset:1024 nt lds
    buffer_load_dwordx4 v7, s[12:15], s46 offen offset:2048 nt lds
    buffer_load_dwordx4 v8, s[12:15], s46 offen offset:3072 nt lds
    s_add_u32 m0, s45, 4096
    s_mov_b32 s46, 229376
    buffer_load_dwordx4 v5, s[12:15], s46 offen offset:0 nt lds
    buffer_load_dwordx4 v6, s[12:15], s46 offen offset:1024 nt lds
    buffer_load_dwordx4 v7, s[12:15], s46 offen offset:2048 nt lds
    buffer_load_dwordx4 v8, s[12:15], s46 offen offset:3072 nt lds
    s_waitcnt vmcnt(8)
    ds_read_b64_tr_b16 v[160:161], v1 offset:8192
    ds_read_b64_tr_b16 v[162:163], v1 offset:9216
    ds_read_b64_tr_b16 v[164:165], v2 offset:8192
    ds_read_b64_tr_b16 v[166:167], v2 offset:9216
    ds_read_b64_tr_b16 v[168:169], v3 offset:8192
    ds_read_b64_tr_b16 v[170:171], v3 offset:9216
    ds_read_b64_tr_b16 v[172:173], v4 offset:8192
    ds_read_b64_tr_b16 v[174:175], v4 offset:9216
    ds_read_b64_tr_b16 v[176:177], v1 offset:12288
    ds_read_b64_tr_b16 v[178:179], v1 offset:13312
    ds_read_b64_tr_b16 v[180:181], v2 offset:12288
    ds_read_b64_tr_b16 v[182:183], v2 offset:13312
    s_waitcnt lgkmcnt(8)
    ds_read_b64_tr_b16 v[184:185], v3 offset:12288
    ds_read_b64_tr_b16 v[186:187], v3 offset:13312
    ds_read_b64_tr_b16 v[188:189], v4 offset:12288
    ds_read_b64_tr_b16 v[190:191], v4 offset:13312
    s_waitcnt lgkmcnt(0)
    v_add_u32 v15, 147712, v13
    s_cmp_lg_u32 s3, 0
    s_cbranch_scc1 F_np1
    s_mov_b32 m0, 147712
    s_mov_b32 s46, 128
    buffer_load_dword v13, s[24:27], s46 offen sc1 lds
F_np1:
    s_add_u32 m0, s45, 8192
    s_mov_b32 s46, 458752
    buffer_load_dwordx4 v5, s[12:15], s46 offen offset:0 nt lds
    buffer_load_dwordx4 v6, s[12:15], s46 offen offset:1024 nt lds
    buffer_load_dwordx4 v7, s[12:15], s46 offen offset:2048 nt lds
    buffer_load_dwordx4 v8, s[12:15], s46 offen offset:3072 nt lds
    s_add_u32 m0, s45, 12288
    s_mov_b32 s46, 688128
    buffer_load_dwordx4 v5, s[12:15], s46 offen offset:0 nt lds
    buffer_load_dwordx4 v6, s[12:15], s46 offen offset:1024 nt lds
    buffer_load_dwordx4 v7, s[12:15], s46 offen offset:2048 nt lds
    buffer_load_dwordx4 v8, s[12:15], s46 offen offset:3072 nt lds
    s_waitcnt vmcnt(8)
    ds_read_b64_tr_b16 v[192:193], v1 offset:0
    ds_read_b64_tr_b16 v[194:195], v1 offset:1024
    ds_read_b64_tr_b16 v[196:197], v2 offset:0
    ds_read_b64_tr_b16 v[198:199], v2 offset:1024
    ds_read_b64_tr_b16 v[200:201], v3 offset:0
    ds_read_b64_tr_b16 v[202:203], v3 offset:1024
    ds_read_b64_tr_b16 v[204:205], v4 offset:0
    ds_read_b64_tr_b16 v[206:207], v4 offset:1024
    ds_read_b64_tr_b16 v[208:209], v1 offset:4096
    ds_read_b64_tr_b16 v[210:211], v1 offset:5120
    ds_read_b64_tr_b16 v[212:213], v2 offset:4096
    ds_read_b64_tr_b16 v[214:215], v2 offset:5120
    s_waitcnt lgkmcnt(8)
    ds_read_b64_tr_b16 v[216:217], v3 offset:4096
    ds_read_b64_tr_b16 v[218:219], v3 offset:5120
    ds_read_b64_tr_b16 v[220:221], v4 offset:4096
    ds_read_b64_tr_b16 v[222:223], v4 offset:5120
    s_waitcnt lgkmcnt(0)
    s_mov_b32 s47, 0
F_sl1:
    ds_read_b32 v24, v15
    s_waitcnt lgkmcnt(0)
    v_cmp_ne_u32 vcc, 0, v24
    s_nop 0
    s_cmp_eq_u64 vcc, -1
    s_cbranch_scc1 F_sl2
    s_add_u32 s47, s47, 1
    s_cmp_lt_u32 s47, 0x8000
    s_cbranch_scc0 F_sl2
    s_sleep 8
    s_cmp_lg_u32 s3, 0
    s_cbranch_scc1 F_sl1
    s_waitcnt vmcnt(40)
    s_mov_b32 m0, 147712
    s_mov_b32 s46, 128
    buffer_load_dword v13, s[24:27], s46 offen sc1 lds
    s_branch F_sl1
F_sl2:
    v_or_b32 v12, 0x800, v24
    v_add_u32 v15, 147712, v13
    v_and_b32 v25, 0x7ff, v24
    v_sub_u32 v25, 0x7ff, v25
    v_lshrrev_b32 v13, 4, v0
    v_lshlrev_b32 v13, 4, v13
    v_lshl_add_u32 v13, v25, 11, v13
    v_bfe_u32 v14, v0, 3, 1
    v_lshl_add_u32 v13, v14, 7, v13
    s_lshl_b32 s36, s3, 8
    v_lshlrev_b32 v14, 3, v25
    s_mov_b32 s46, 0x4000
    buffer_load_dwordx2 v[6:7], v14, s[20:23], s46 offen sc1
    buffer_load_dwordx4 v[16:19], v13, s[76:79], s36 offen offset:0
    buffer_load_dwordx4 v[20:23], v13, s[76:79], s36 offen offset:64
    s_waitcnt vmcnt(3)
    ds_read_b64_tr_b16 v[224:225], v1 offset:8192
    ds_read_b64_tr_b16 v[226:227], v1 offset:9216
    ds_read_b64_tr_b16 v[228:229], v2 offset:8192
    ds_read_b64_tr_b16 v[230:231], v2 offset:9216
    ds_read_b64_tr_b16 v[232:233], v3 offset:8192
    ds_read_b64_tr_b16 v[234:235], v3 offset:9216
    ds_read_b64_tr_b16 v[236:237], v4 offset:8192
    ds_read_b64_tr_b16 v[238:239], v4 offset:9216
    ds_read_b64_tr_b16 v[240:241], v1 offset:12288
    ds_read_b64_tr_b16 v[242:243], v1 offset:13312
    ds_read_b64_tr_b16 v[244:245], v2 offset:12288
    ds_read_b64_tr_b16 v[246:247], v2 offset:13312
    s_waitcnt lgkmcnt(8)
    ds_read_b64_tr_b16 v[248:249], v3 offset:12288
    ds_read_b64_tr_b16 v[250:251], v3 offset:13312
    ds_read_b64_tr_b16 v[252:253], v4 offset:12288
    ds_read_b64_tr_b16 v[254:255], v4 offset:13312
    s_waitcnt lgkmcnt(0)
    v_lshl_add_u32 v13, v0, 4, s45
    s_and_b32 s36, s3, 3
    s_lshl_b32 s37, s36, 10
    v_lshl_add_u32 v14, v0, 4, s37
    s_lshl_b32 s37, s36, 9
    s_add_u32 s37, s37, 131328
    v_lshl_add_u32 v8, v0, 3, s37
    v_and_b32 v9, 0x37, v0
    v_lshlrev_b32 v9, 3, v9
    v_add_u32 v9, 131328, v9
    v_and_b32 v10, 7, v0
    v_lshlrev_b32 v10, 12, v10
    v_bfe_u32 v11, v0, 3, 1
    v_lshl_add_u32 v10, v11, 6, v10
    v_lshrrev_b32 v11, 4, v0
    v_lshl_add_u32 v10, v11, 4, v10
    s_lshl_b32 s36, s30, 15
    s_lshl_b32 s37, s3, 9
    s_add_u32 s36, s36, s37
    s_add_u32 s36, s36, 0x600000
    v_add_u32 v10, s36, v10
    s_mov_b32 s50, 0xff00ff00
    s_mov_b32 s51, 0xff00ff00
    s_waitcnt vmcnt(1)
    v_mov_b32 v4, v7
    v_mov_b32 v5, v7
    v_mov_b32 v7, v6
    v_lshlrev_b32 v24, 16, v16
    v_and_b32 v25, s39, v16
    v_lshlrev_b32 v26, 16, v17
    v_and_b32 v27, s39, v17
    v_lshlrev_b32 v28, 16, v18
    v_and_b32 v29, s39, v18
    v_lshlrev_b32 v30, 16, v19
    v_and_b32 v31, s39, v19
    v_pk_add_f32 v[24:25], v[24:25], v[6:7] neg_lo:[0,1] neg_hi:[0,1]
    v_pk_add_f32 v[26:27], v[26:27], v[6:7] neg_lo:[0,1] neg_hi:[0,1]
    v_pk_add_f32 v[28:29], v[28:29], v[6:7] neg_lo:[0,1] neg_hi:[0,1]
    v_pk_add_f32 v[30:31], v[30:31], v[6:7] neg_lo:[0,1] neg_hi:[0,1]
    v_cvt_pk_bf16_f32 v16, v24, v25
    v_cvt_pk_bf16_f32 v17, v26, v27
    v_cvt_pk_bf16_f32 v18, v28, v29
    v_cvt_pk_bf16_f32 v19, v30, v31
    v_lshlrev_b32 v24, 16, v16
    v_and_b32 v25, s39, v16
    v_lshlrev_b32 v26, 16, v17
    v_and_b32 v27, s39, v17
    v_lshlrev_b32 v28, 16, v18
    v_and_b32 v29, s39, v18
    v_lshlrev_b32 v30, 16, v19
    v_and_b32 v31, s39, v19
    v_pk_mul_f32 v[24:25], v[24:25], v[4:5]
    v_pk_mul_f32 v[26:27], v[26:27], v[4:5]
    v_pk_mul_f32 v[28:29], v[28:29], v[4:5]
    v_pk_mul_f32 v[30:31], v[30:31], v[4:5]
    v_cvt_pk_bf16_f32 v16, v24, v25
    v_cvt_pk_bf16_f32 v17, v26, v27
    v_cvt_pk_bf16_f32 v18, v28, v29
    v_cvt_pk_bf16_f32 v19, v30, v31
    s_nop 1
    v_mfma_f32_16x16x32_bf16 v[32:35], v[128:131], v[16:19], 0
    v_mfma_f32_16x16x32_bf16 v[36:39], v[132:135], v[16:19], 0
    v_mfma_f32_16x16x32_bf16 v[40:43], v[136:139], v[16:19], 0
    v_mfma_f32_16x16x32_bf16 v[44:47], v[140:143], v[16:19], 0
    v_mfma_f32_16x16x32_bf16 v[48:51], v[192:195], v[16:19], 0
    v_mfma_f32_16x16x32_bf16 v[52:55], v[196:199], v[16:19], 0
    v_mfma_f32_16x16x32_bf16 v[56:59], v[200:203], v[16:19], 0
    v_mfma_f32_16x16x32_bf16 v[60:63], v[204:207], v[16:19], 0
    s_waitcnt vmcnt(0)
    v_lshlrev_b32 v24, 16, v20
    v_and_b32 v25, s39, v20
    v_lshlrev_b32 v26, 16, v21
    v_and_b32 v27, s39, v21
    v_lshlrev_b32 v28, 16, v22
    v_and_b32 v29, s39, v22
    v_lshlrev_b32 v30, 16, v23
    v_and_b32 v31, s39, v23
    v_pk_add_f32 v[24:25], v[24:25], v[6:7] neg_lo:[0,1] neg_hi:[0,1]
    v_pk_add_f32 v[26:27], v[26:27], v[6:7] neg_lo:[0,1] neg_hi:[0,1]
    v_pk_add_f32 v[28:29], v[28:29], v[6:7] neg_lo:[0,1] neg_hi:[0,1]
    v_pk_add_f32 v[30:31], v[30:31], v[6:7] neg_lo:[0,1] neg_hi:[0,1]
    v_cvt_pk_bf16_f32 v20, v24, v25
    v_cvt_pk_bf16_f32 v21, v26, v27
    v_cvt_pk_bf16_f32 v22, v28, v29
    v_cvt_pk_bf16_f32 v23, v30, v31
    v_lshlrev_b32 v24, 16, v20
    v_and_b32 v25, s39, v20
    v_lshlrev_b32 v26, 16, v21
    v_and_b32 v27, s39, v21
    v_lshlrev_b32 v28, 16, v22
    v_and_b32 v29, s39, v22
    v_lshlrev_b32 v30, 16, v23
    v_and_b32 v31, s39, v23
    v_pk_mul_f32 v[24:25], v[24:25], v[4:5]
    v_pk_mul_f32 v[26:27], v[26:27], v[4:5]
    v_pk_mul_f32 v[28:29], v[28:29], v[4:5]
    v_pk_mul_f32 v[30:31], v[30:31], v[4:5]
    v_cvt_pk_bf16_f32 v20, v24, v25
    v_cvt_pk_bf16_f32 v21, v26, v27
    v_cvt_pk_bf16_f32 v22, v28, v29
    v_cvt_pk_bf16_f32 v23, v30, v31
    v_mov_b32_dpp v24, v16 row_ror:8 row_mask:0xf bank_mask:0xf
    v_mov_b32_dpp v25, v17 row_ror:8 row_mask:0xf bank_mask:0xf
    v_mov_b32_dpp v26, v18 row_ror:8 row_mask:0xf bank_mask:0xf
    v_mov_b32_dpp v27, v19 row_ror:8 row_mask:0xf bank_mask:0xf
    v_mov_b32_dpp v28, v20 row_ror:8 row_mask:0xf bank_mask:0xf
    v_mov_b32_dpp v29, v21 row_ror:8 row_mask:0xf bank_mask:0xf
    v_mov_b32_dpp v30, v22 row_ror:8 row_mask:0xf bank_mask:0xf
    v_mov_b32_dpp v31, v23 row_ror:8 row_mask:0xf bank_mask:0xf
    v_mfma_f32_16x16x32_bf16 v[32:35], v[144:147], v[20:23], v[32:35]
    v_mfma_f32_16x16x32_bf16 v[36:39], v[148:151], v[20:23], v[36:39]
    v_mfma_f32_16x16x32_bf16 v[40:43], v[152:155], v[20:23], v[40:43]
    v_mfma_f32_16x16x32_bf16 v[44:47], v[156:159], v[20:23], v[44:47]
    v_mfma_f32_16x16x32_bf16 v[48:51], v[208:211], v[20:23], v[48:51]
    v_mfma_f32_16x16x32_bf16 v[52:55], v[212:215], v[20:23], v[52:55]
    v_mfma_f32_16x16x32_bf16 v[56:59], v[216:219], v[20:23], v[56:59]
    v_mfma_f32_16x16x32_bf16 v[60:63], v[220:223], v[20:23], v[60:63]
    v_mfma_f32_16x16x32_bf16 v[32:35], v[160:163], v[24:27], v[32:35]
    v_mfma_f32_16x16x32_bf16 v[36:39], v[164:167], v[24:27], v[36:39]
    v_mfma_f32_16x16x32_bf16 v[40:43], v[168:171], v[24:27], v[40:43]
    v_mfma_f32_16x16x32_bf16 v[44:47], v[172:175], v[24:27], v[44:47]
    v_mfma_f32_16x16x32_bf16 v[48:51], v[224:227], v[24:27], v[48:51]
    v_mfma_f32_16x16x32_bf16 v[52:55], v[228:231], v[24:27], v[52:55]
    v_mfma_f32_16x16x32_bf16 v[56:59], v[232:235], v[24:27], v[56:59]
    v_mfma_f32_16x16x32_bf16 v[60:63], v[236:239], v[24:27], v[60:63]
    v_mfma_f32_16x16x32_bf16 v[32:35], v[176:179], v[28:31], v[32:35]
    v_mfma_f32_16x16x32_bf16 v[36:39], v[180:183], v[28:31], v[36:39]
    v_mfma_f32_16x16x32_bf16 v[40:43], v[184:187], v[28:31], v[40:43]
    v_mfma_f32_16x16x32_bf16 v[44:47], v[188:191], v[28:31], v[44:47]
    v_mfma_f32_16x16x32_bf16 v[48:51], v[240:243], v[28:31], v[48:51]
    v_mfma_f32_16x16x32_bf16 v[52:55], v[244:247], v[28:31], v[52:55]
    v_mfma_f32_16x16x32_bf16 v[56:59], v[248:251], v[28:31], v[56:59]
    v_mfma_f32_16x16x32_bf16 v[60:63], v[252:255], v[28:31], v[60:63]
    ds_write_b32 v15, v12
    ds_write_b128 v13, v[32:35] offset:0
    ds_write_b128 v13, v[36:39] offset:1024
    ds_write_b128 v13, v[40:43] offset:2048
    ds_write_b128 v13, v[44:47] offset:3072
    ds_write_b128 v13, v[48:51] offset:4096
    ds_write_b128 v13, v[52:55] offset:5120
    ds_write_b128 v13, v[56:59] offset:6144
    ds_write_b128 v13, v[60:63] offset:7168
    s_waitcnt lgkmcnt(0)
    s_barrier
    s_lshl_b32 s56, s30, 7
    s_add_u32 s56, s56, 0x16000
    s_mov_b32 s59, 0
    s_cmp_ge_u32 s3, 4
    s_cbranch_scc1 F_nored
    v_add_u32 v15, 0x10000, v14
    ds_read_b128 v[128:131], v14 offset:0
    ds_read_b128 v[132:135], v14 offset:16384
    ds_read_b128 v[136:139], v14 offset:32768
    ds_read_b128 v[140:143], v14 offset:49152
    ds_read_b128 v[144:147], v15 offset:0
    ds_read_b128 v[148:151], v15 offset:16384
    ds_read_b128 v[152:155], v15 offset:32768
    ds_read_b128 v[156:159], v15 offset:49152
    s_waitcnt lgkmcnt(4)
    ds_read_b128 v[160:163], v14 offset:4096
    ds_read_b128 v[164:167], v14 offset:20480
    ds_read_b128 v[168:171], v14 offset:36864
    ds_read_b128 v[172:175], v14 offset:53248
    ds_read_b128 v[176:179], v15 offset:4096
    ds_read_b128 v[180:183], v15 offset:20480
    ds_read_b128 v[184:187], v15 offset:36864
    ds_read_b128 v[188:191], v15 offset:53248
    s_waitcnt lgkmcnt(8)
    v_pk_add_f32 v[128:129], v[128:129], v[144:145]
    v_pk_add_f32 v[130:131], v[130:131], v[146:147]
    v_pk_add_f32 v[132:133], v[132:133], v[148:149]
    v_pk_add_f32 v[134:135], v[134:135], v[150:151]
    v_pk_add_f32 v[136:137], v[136:137], v[152:153]
    v_pk_add_f32 v[138:139], v[138:139], v[154:155]
    v_pk_add_f32 v[140:141], v[140:141], v[156:157]
    v_pk_add_f32 v[142:143], v[142:143], v[158:159]
    v_pk_add_f32 v[128:129], v[128:129], v[136:137]
    v_pk_add_f32 v[130:131], v[130:131], v[138:139]
    v_pk_add_f32 v[132:133], v[132:133], v[140:141]
    v_pk_add_f32 v[134:135], v[134:135], v[142:143]
    v_pk_add_f32 v[128:129], v[128:129], v[132:133]
    v_pk_add_f32 v[130:131], v[130:131], v[134:135]
    s_waitcnt lgkmcnt(0)
    v_pk_add_f32 v[160:161], v[160:161], v[176:177]
    v_pk_add_f32 v[162:163], v[162:163], v[178:179]
    v_pk_add_f32 v[164:165], v[164:165], v[180:181]
    v_pk_add_f32 v[166:167], v[166:167], v[182:183]
    v_pk_add_f32 v[168:169], v[168:169], v[184:185]
    v_pk_add_f32 v[170:171], v[170:171], v[186:187]
    v_pk_add_f32 v[172:173], v[172:173], v[188:189]
    v_pk_add_f32 v[174:175], v[174:175], v[190:191]
    v_pk_add_f32 v[160:161], v[160:161], v[168:169]
    v_pk_add_f32 v[162:163], v[162:163], v[170:171]
    v_pk_add_f32 v[164:165], v[164:165], v[172:173]
    v_pk_add_f32 v[166:167], v[166:167], v[174:175]
    v_pk_add_f32 v[160:161], v[160:161], v[164:165]
    v_pk_add_f32 v[162:163], v[162:163], v[166:167]
    v_cvt_pk_bf16_f32 v136, v128, v129
    v_cvt_pk_bf16_f32 v137, v130, v131
    v_lshlrev_b32 v128, 16, v136
    v_and_b32 v129, s39, v136
    v_lshlrev_b32 v130, 16, v137
    v_and_b32 v131, s39, v137
    v_cvt_pk_bf16_f32 v168, v160, v161
    v_cvt_pk_bf16_f32 v169, v162, v163
    v_lshlrev_b32 v160, 16, v168
    v_and_b32 v161, s39, v168
    v_lshlrev_b32 v162, 16, v169
    v_and_b32 v163, s39, v169
    v_mul_f32 v132, 0xbfb8aa3b, v128
    v_mul_f32 v133, 0xbfb8aa3b, v129
    v_mul_f32 v134, 0xbfb8aa3b, v130
    v_mul_f32 v135, 0xbfb8aa3b, v131
    v_exp_f32 v132, v132
    v_exp_f32 v133, v133
    v_exp_f32 v134, v134
    v_exp_f32 v135, v135
    v_add_f32 v132, 1.0, v132
    v_add_f32 v133, 1.0, v133
    v_add_f32 v134, 1.0, v134
    v_add_f32 v135, 1.0, v135
    v_rcp_f32 v132, v132
    v_rcp_f32 v133, v133
    v_rcp_f32 v134, v134
    v_rcp_f32 v135, v135
    v_mul_f32 v128, v128, v132
    v_mul_f32 v129, v129, v133
    v_mul_f32 v130, v130, v134
    v_mul_f32 v131, v131, v135
    v_cvt_pk_bf16_f32 v136, v128, v129
    v_cvt_pk_bf16_f32 v137, v130, v131
    v_lshlrev_b32 v128, 16, v136
    v_and_b32 v129, s39, v136
    v_lshlrev_b32 v130, 16, v137
    v_and_b32 v131, s39, v137
    v_pk_mul_f32 v[128:129], v[128:129], v[160:161]
    v_pk_mul_f32 v[130:131], v[130:131], v[162:163]
    v_cvt_pk_bf16_f32 v136, v128, v129
    v_cvt_pk_bf16_f32 v137, v130, v131
    ds_write_b64 v8, v[136:137]
    s_waitcnt lgkmcnt(0)
    s_branch F_hb
F_nored:
    s_sub_u32 s3, s3, 4
    s_mov_b32 s59, 1
    s_and_b32 s30, s28, 1
    s_lshl_b32 s30, s30, 3
    s_and_b32 s31, s28, 2
    s_lshl_b32 s31, s31, 1
    s_add_u32 s30, s30, s31
    s_lshr_b32 s31, s29, 3
    s_add_u32 s30, s30, s31
    s_and_b32 s34, s29, 7
    s_add_u32 s32, s28, 3
    s_and_b32 s32, s32, 7
    s_cmp_eq_u32 s29, 27
    s_cselect_b32 s34, s32, s34
    s_add_u32 s32, s32, 24
    s_cmp_eq_u32 s29, s32
    s_cselect_b32 s34, 3, s34
    s_and_b32 s32, s28, 4
    s_lshl_b32 s32, s32, 1
    s_add_u32 s32, s32, s34
    s_mov_b32 s8, s4
    s_mov_b32 s9, s5
    s_mov_b32 s10, 0x400000
    s_mov_b32 s11, 0x20000
    s_mov_b32 s16, s86
    s_mov_b32 s17, s87
    s_mov_b32 s18, 0x400000
    s_mov_b32 s19, 0x20000
    s_mov_b32 s20, s74
    s_mov_b32 s21, s75
    s_mov_b32 s22, 0x1000000
    s_mov_b32 s23, 0x20000
    s_lshl_b32 s35, s30, 7
    s_lshl_b32 s36, s3, 5
    s_add_u32 s35, s35, s36
    v_and_b32 v14, 15, v0
    v_add_u32 v14, s35, v14
    v_lshlrev_b32 v7, 3, v14
    v_add_u32 v7, 0x4000, v7
    v_lshlrev_b32 v6, 11, v14
    v_bfe_u32 v15, v0, 4, 1
    v_lshl_add_u32 v6, v15, 5, v6
    v_lshrrev_b32 v15, 5, v0
    v_lshl_add_u32 v6, v15, 4, v6
    s_lshl_b32 s36, s32, 7
    v_add_u32 v6, s36, v6
    s_lshl_b32 s36, s35, 11
    s_add_u32 s36, s36, 0x100000
    v_lshl_add_u32 v4, v0, 4, s36
    v_add_u32 v5, 0x8000, v4
    s_mov_b32 s37, 0x8000
    buffer_load_dwordx2 v[216:217], v7, s[20:23], 0 offen offset:0 sc1
    buffer_load_dwordx4 v[200:203], v6, s[8:11], 0 offen offset:0
    buffer_load_dwordx4 v[204:207], v6, s[8:11], 0 offen offset:64
    buffer_load_dwordx2 v[218:219], v7, s[20:23], 0 offen offset:128 sc1
    buffer_load_dwordx4 v[208:211], v6, s[8:11], s37 offen offset:0
    buffer_load_dwordx4 v[212:215], v6, s[8:11], s37 offen offset:64
    s_mov_b32 s36, 2048
    v_lshrrev_b32 v14, 3, v0
    v_and_b32 v15, 6, v14
    v_and_b32 v220, 7, v0
    v_xor_b32 v220, v220, v15
    v_lshlrev_b32 v220, 4, v220
    v_mul_lo_u32 v14, v14, s36
    v_add_u32 v220, v220, v14
    s_lshl_b32 s36, s32, 7
    v_add_u32 v220, s36, v220
    v_add_u32 v221, 15360, v220
    v_add_u32 v222, 30720, v220
    v_add_u32 v223, 46080, v220
    s_mov_b32 s12, s84
    s_mov_b32 s13, s85
    s_mov_b32 s14, 0x200000
    s_mov_b32 s15, 0x20000
F_hb:
    s_barrier
F_hb2:
    ds_read_b64 v[16:17], v9 offset:0
    ds_read_b64 v[18:19], v9 offset:512
    ds_read_b64 v[20:21], v9 offset:1024
    ds_read_b64 v[22:23], v9 offset:1536
    s_waitcnt lgkmcnt(0)
    v_mfma_f32_16x16x32_bf16 v[32:35], v[64:67], v[16:19], 0
    v_mfma_f32_16x16x32_bf16 v[36:39], v[68:71], v[16:19], 0
    v_mfma_f32_16x16x32_bf16 v[40:43], v[72:75], v[16:19], 0
    v_mfma_f32_16x16x32_bf16 v[44:47], v[76:79], v[16:19], 0
    v_mfma_f32_16x16x32_bf16 v[48:51], v[80:83], v[16:19], 0
    v_mfma_f32_16x16x32_bf16 v[52:55], v[84:87], v[16:19], 0
    v_mfma_f32_16x16x32_bf16 v[56:59], v[88:91], v[16:19], 0
    v_mfma_f32_16x16x32_bf16 v[60:63], v[92:95], v[16:19], 0
    v_mfma_f32_16x16x32_bf16 v[32:35], v[96:99], v[20:23], v[32:35]
    v_mfma_f32_16x16x32_bf16 v[36:39], v[100:103], v[20:23], v[36:39]
    v_mfma_f32_16x16x32_bf16 v[40:43], v[104:107], v[20:23], v[40:43]
    v_mfma_f32_16x16x32_bf16 v[44:47], v[108:111], v[20:23], v[44:47]
    v_mfma_f32_16x16x32_bf16 v[48:51], v[112:115], v[20:23], v[48:51]
    v_mfma_f32_16x16x32_bf16 v[52:55], v[116:119], v[20:23], v[52:55]
    v_mfma_f32_16x16x32_bf16 v[56:59], v[120:123], v[20:23], v[56:59]
    v_mfma_f32_16x16x32_bf16 v[60:63], v[124:127], v[20:23], v[60:63]
    s_nop 1
    v_cndmask_b32 v32, v32, v36, s[50:51]
    v_cndmask_b32 v33, v33, v37, s[50:51]
    v_cndmask_b32 v34, v34, v38, s[50:51]
    v_cndmask_b32 v35, v35, v39, s[50:51]
    buffer_store_dwordx4 v[32:35], v10, s[20:23], 0 offen offset:0 sc1
    v_cndmask_b32 v40, v40, v44, s[50:51]
    v_cndmask_b32 v41, v41, v45, s[50:51]
    v_cndmask_b32 v42, v42, v46, s[50:51]
    v_cndmask_b32 v43, v43, v47, s[50:51]
    buffer_store_dwordx4 v[40:43], v10, s[20:23], 0 offen offset:128 sc1
    v_cndmask_b32 v48, v48, v52, s[50:51]
    v_cndmask_b32 v49, v49, v53, s[50:51]
    v_cndmask_b32 v50, v50, v54, s[50:51]
    v_cndmask_b32 v51, v51, v55, s[50:51]
    buffer_store_dwordx4 v[48:51], v10, s[20:23], 0 offen offset:256 sc1
    v_cndmask_b32 v56, v56, v60, s[50:51]
    v_cndmask_b32 v57, v57, v61, s[50:51]
    v_cndmask_b32 v58, v58, v62, s[50:51]
    v_cndmask_b32 v59, v59, v63, s[50:51]
    buffer_store_dwordx4 v[56:59], v10, s[20:23], 0 offen offset:384 sc1
    v_mov_b32 v1, 147456
    s_cmp_lg_u32 s59, 0
    s_cbranch_scc1 F_p2d
F_mlo:
    v_mov_b32 v2, s56
    v_mov_b32 v3, 1
    s_waitcnt vmcnt(0)
    s_barrier
    s_cmp_lg_u32 s3, 0
    s_cbranch_scc1 F_help2
    s_mov_b64 exec, 1
    buffer_store_dword v3, v2, s[20:23], 0 offen sc1
    s_mov_b64 exec, -1
    s_branch F_help2
F_spare:
    v_add_u32 v29, 147712, v13
    v_mov_b32 v28, v13
    s_cmp_eq_u32 s2, 252
    s_cbranch_scc1 F_top8
    s_cmp_lg_u32 s3, 0
    s_cbranch_scc1 F_sdone
    s_mov_b32 s47, 0
F_pl_39:
    buffer_load_dword v24, v13, s[24:27], 0 offen offset:128 sc1
    s_waitcnt vmcnt(0)
F_pc_40:
    v_cmp_ne_u32 vcc, 0, v24
    s_nop 0
    s_cmp_eq_u64 vcc, -1
    s_cbranch_scc1 F_pd_41
    s_add_u32 s47, s47, 1
    s_cmp_lt_u32 s47, 0x8000
    s_cbranch_scc0 F_pd_41
    s_sleep 32
    s_branch F_pl_39
F_pd_41:
    s_branch F_swr
F_top8:
    v_and_b32 v13, 31, v0
    v_lshlrev_b32 v13, 2, v13
    s_mov_b32 s48, 0x10001
    s_lshl_b32 s36, s3, 10
    v_lshl_add_u32 v14, v0, 4, s36
    s_lshl_b32 s36, s3, 5
    v_add_u32 v26, s36, v28
    v_add_u32 v26, 131072, v26
    v_lshlrev_b32 v27, 2, v0
    v_add_u32 v27, 131072, v27
    v_mov_b32 v30, 0
    ds_write_b32 v27, v30 offset:1024
    ds_write_b32 v27, v30 offset:1536
    v_lshrrev_b32 v30, 4, v0
    s_lshl_b32 s36, s3, 2
    v_add_u32 v30, s36, v30
    v_lshlrev_b32 v30, 2, v30
    v_add_u32 v30, 131584, v30
    v_add_u32 v31, 131584, v13
    v_lshrrev_b32 v32, 5, v0
    v_lshlrev_b32 v32, 6, v32
    v_add_u32 v32, 131584, v32
    v_mov_b32 v33, 132096
    v_mov_b32 v34, 1
    s_waitcnt lgkmcnt(0)
    s_cmp_lg_u32 s3, 0
    s_cbranch_scc1 F_spd
    v_lshlrev_b32 v35, 7, v0
    v_add_u32 v35, 0x18000, v35
    s_mov_b32 s47, 0
F_pl_42:
    buffer_load_dword v15, v35, s[20:23], 0 offen sc1
    s_waitcnt vmcnt(0)
F_pc_43:
    v_cmp_ne_u32 vcc, 0, v15
    s_nop 0
    s_cmp_eq_u64 vcc, -1
    s_cbranch_scc1 F_pd_44
    s_add_u32 s47, s47, 1
    s_cmp_lt_u32 s47, 0x8000
    s_cbranch_scc0 F_pd_44
    s_sleep 4
    s_branch F_pl_42
F_pd_44:
F_spd:
    s_barrier
    buffer_load_dwordx4 v[16:19], v14, s[20:23], 0 offen sc1
    s_mov_b32 s48, 0
    s_waitcnt vmcnt(0)
    v_max3_u32 v20, v16, v17, v18
    v_max_u32 v20, v20, v19
    s_nop 1
    v_max_u32_dpp v20, v20, v20 quad_perm:[1,0,3,2] row_mask:0xf bank_mask:0xf
    s_nop 1
    v_max_u32_dpp v20, v20, v20 quad_perm:[2,3,0,1] row_mask:0xf bank_mask:0xf
    s_nop 1
    v_max_u32_dpp v20, v20, v20 row_half_mirror row_mask:0xf bank_mask:0xf
    s_nop 1
    v_max_u32_dpp v20, v20, v20 row_mirror row_mask:0xf bank_mask:0xf
    ds_write_b32 v30, v20
    v_mov_b32 v21, 0
    s_waitcnt lgkmcnt(0)
    s_barrier
    ds_read_b32 v20, v31
    ds_read_b128 v[40:43], v32 offset:0
    ds_read_b128 v[44:47], v32 offset:16
    ds_read_b128 v[48:51], v32 offset:32
    ds_read_b128 v[52:55], v32 offset:48
    s_waitcnt lgkmcnt(0)
    v_cmp_gt_u32 s[52:53], v40, v20
    v_cmp_gt_u32 s[54:55], v41, v20
    v_cmp_gt_u32 s[56:57], v42, v20
    v_cmp_gt_u32 s[58:59], v43, v20
    v_addc_co_u32 v21, vcc, 0, v21, s[52:53]
    v_addc_co_u32 v21, vcc, 0, v21, s[54:55]
    v_addc_co_u32 v21, vcc, 0, v21, s[56:57]
    v_addc_co_u32 v21, vcc, 0, v21, s[58:59]
    v_cmp_gt_u32 s[52:53], v44, v20
    v_cmp_gt_u32 s[54:55], v45, v20
    v_cmp_gt_u32 s[56:57], v46, v20
    v_cmp_gt_u32 s[58:59], v47, v20
    v_addc_co_u32 v21, vcc, 0, v21, s[52:53]
    v_addc_co_u32 v21, vcc, 0, v21, s[54:55]
    v_addc_co_u32 v21, vcc, 0, v21, s[56:57]
    v_addc_co_u32 v21, vcc, 0, v21, s[58:59]
    v_cmp_gt_u32 s[52:53], v48, v20
    v_cmp_gt_u32 s[54:55], v49, v20
    v_cmp_gt_u32 s[56:57], v50, v20
    v_cmp_gt_u32 s[58:59], v51, v20
    v_addc_co_u32 v21, vcc, 0, v21, s[52:53]
    v_addc_co_u32 v21, vcc, 0, v21, s[54:55]
    v_addc_co_u32 v21, vcc, 0, v21, s[56:57]
    v_addc_co_u32 v21, vcc, 0, v21, s[58:59]
    v_cmp_gt_u32 s[52:53], v52, v20
    v_cmp_gt_u32 s[54:55], v53, v20
    v_cmp_gt_u32 s[56:57], v54, v20
    v_cmp_gt_u32 s[58:59], v55, v20
    v_addc_co_u32 v21, vcc, 0, v21, s[52:53]
    v_addc_co_u32 v21, vcc, 0, v21, s[54:55]
    v_addc_co_u32 v21, vcc, 0, v21, s[56:57]
    v_addc_co_u32 v21, vcc, 0, v21, s[58:59]
    v_mov_b32 v22, v21
    s_nop 1
    v_permlane32_swap_b32 v21, v22
    v_add_u32 v21, v21, v22
    v_cmp_eq_u32 vcc, 7, v21
    s_nop 0
    s_ff1_i32_b64 s46, vcc
    v_readlane_b32 s46, v20, s46
    s_nop 1
    v_cmp_le_u32 s[52:53], s46, v16
    v_cmp_le_u32 s[54:55], s46, v17
    v_cmp_le_u32 s[56:57], s46, v18
    v_cmp_le_u32 s[58:59], s46, v19
    s_mov_b64 exec, s[52:53]
    ds_add_rtn_u32 v20, v33, v34 offset:512
    s_mov_b64 exec, s[54:55]
    ds_add_rtn_u32 v21, v33, v34 offset:512
    s_mov_b64 exec, s[56:57]
    ds_add_rtn_u32 v22, v33, v34 offset:512
    s_mov_b64 exec, s[58:59]
    ds_add_rtn_u32 v23, v33, v34 offset:512
    s_mov_b64 exec, -1
    s_waitcnt lgkmcnt(0)
    v_min_u32 v20, 64, v20
    v_lshl_add_u32 v20, v20, 2, v33
    v_min_u32 v21, 64, v21
    v_lshl_add_u32 v21, v21, 2, v33
    v_min_u32 v22, 64, v22
    v_lshl_add_u32 v22, v22, 2, v33
    v_min_u32 v23, 64, v23
    v_lshl_add_u32 v23, v23, 2, v33
    s_mov_b64 exec, s[52:53]
    ds_write_b32 v20, v16
    s_mov_b64 exec, s[54:55]
    ds_write_b32 v21, v17
    s_mov_b64 exec, s[56:57]
    ds_write_b32 v22, v18
    s_mov_b64 exec, s[58:59]
    ds_write_b32 v23, v19
    s_mov_b64 exec, -1
    s_waitcnt lgkmcnt(0)
    s_barrier
    ds_read_b32 v21, v33 offset:512
    ds_read_b32 v24, v27 offset:1024
    ds_read_b128 v[40:43], v33 offset:0
    ds_read_b128 v[44:47], v33 offset:16
    ds_read_b128 v[48:51], v33 offset:32
    ds_read_b128 v[52:55], v33 offset:48
    s_waitcnt lgkmcnt(0)
    v_readfirstlane_b32 s47, v21
    v_mov_b32 v21, 0
    s_cmp_gt_u32 s47, 64
    s_cbranch_scc1 F_lv
    s_cmp_lg_u32 s3, 0
    s_cbranch_scc1 F_sd255
    s_mov_b32 s46, 16
F_rk:
    v_cmp_gt_u32 s[52:53], v40, v24
    v_cmp_gt_u32 s[54:55], v41, v24
    v_cmp_gt_u32 s[56:57], v42, v24
    v_cmp_gt_u32 s[58:59], v43, v24
    v_addc_co_u32 v21, vcc, 0, v21, s[52:53]
    v_addc_co_u32 v21, vcc, 0, v21, s[54:55]
    v_addc_co_u32 v21, vcc, 0, v21, s[56:57]
    v_addc_co_u32 v21, vcc, 0, v21, s[58:59]
    v_cmp_gt_u32 s[52:53], v44, v24
    v_cmp_gt_u32 s[54:55], v45, v24
    v_cmp_gt_u32 s[56:57], v46, v24
    v_cmp_gt_u32 s[58:59], v47, v24
    v_addc_co_u32 v21, vcc, 0, v21, s[52:53]
    v_addc_co_u32 v21, vcc, 0, v21, s[54:55]
    v_addc_co_u32 v21, vcc, 0, v21, s[56:57]
    v_addc_co_u32 v21, vcc, 0, v21, s[58:59]
    v_cmp_gt_u32 s[52:53], v48, v24
    v_cmp_gt_u32 s[54:55], v49, v24
    v_cmp_gt_u32 s[56:57], v50, v24
    v_cmp_gt_u32 s[58:59], v51, v24
    v_addc_co_u32 v21, vcc, 0, v21, s[52:53]
    v_addc_co_u32 v21, vcc, 0, v21, s[54:55]
    v_addc_co_u32 v21, vcc, 0, v21, s[56:57]
    v_addc_co_u32 v21, vcc, 0, v21, s[58:59]
    v_cmp_gt_u32 s[52:53], v52, v24
    v_cmp_gt_u32 s[54:55], v53, v24
    v_cmp_gt_u32 s[56:57], v54, v24
    v_cmp_gt_u32 s[58:59], v55, v24
    v_addc_co_u32 v21, vcc, 0, v21, s[52:53]
    v_addc_co_u32 v21, vcc, 0, v21, s[54:55]
    v_addc_co_u32 v21, vcc, 0, v21, s[56:57]
    v_addc_co_u32 v21, vcc, 0, v21, s[58:59]
    s_cmp_ge_u32 s46, s47
    s_cbranch_scc1 F_rkd
    v_add_u32 v33, 64, v33
    s_add_u32 s46, s46, 16
    ds_read_b128 v[40:43], v33 offset:0
    ds_read_b128 v[44:47], v33 offset:16
    ds_read_b128 v[48:51], v33 offset:32
    ds_read_b128 v[52:55], v33 offset:48
    s_waitcnt lgkmcnt(0)
    s_branch F_rk
F_rkd:
    v_cmp_gt_u32 vcc, 8, v21
    v_cmp_gt_u32 s[52:53], s47, v0
    v_lshlrev_b32 v28, 2, v21
    v_or_b32 v24, 0x800, v24
    v_add_u32 v29, 147712, v28
    s_and_b64 exec, vcc, s[52:53]
    s_branch F_tst
F_lv:
    s_mov_b32 s46, 0
    s_mov_b32 s50, 0x01010101
    s_mov_b32 s51, 0x01010101
    s_mov_b32 s47, 0
F_rd:
    v_subrev_u32 v20, s46, v16
    v_subrev_u32 v21, s46, v17
    v_subrev_u32 v22, s46, v18
    v_subrev_u32 v23, s46, v19
    v_max3_u32 v20, v20, v21, v22
    v_max_u32 v20, v20, v23
    s_nop 1
    v_max_u32_dpp v20, v20, v20 quad_perm:[1,0,3,2] row_mask:0xf bank_mask:0xf
    s_nop 1
    v_max_u32_dpp v20, v20, v20 quad_perm:[2,3,0,1] row_mask:0xf bank_mask:0xf
    s_nop 1
    v_max_u32_dpp v20, v20, v20 row_half_mirror row_mask:0xf bank_mask:0xf
    s_nop 1
    v_max_u32_dpp v20, v20, v20 row_mirror row_mask:0xf bank_mask:0xf
    s_nop 0
    v_readlane_b32 s52, v20, 0
    v_readlane_b32 s53, v20, 16
    v_readlane_b32 s54, v20, 32
    v_readlane_b32 s55, v20, 48
    s_max_u32 s52, s52, s53
    s_max_u32 s54, s54, s55
    s_max_u32 s52, s52, s54
    s_add_u32 s46, s46, s52
    s_mov_b64 exec, s[50:51]
    v_mov_b32 v24, s46
    s_mov_b64 exec, -1
    s_lshl_b64 s[50:51], s[50:51], 1
    s_add_u32 s47, s47, 1
    s_cmp_lt_u32 s47, 8
    s_cbranch_scc1 F_rd
    s_cmp_lg_u32 s48, 0
    s_cbranch_scc1 F_td
    ds_write_b32 v26, v24
    s_waitcnt lgkmcnt(0)
    s_barrier
    s_cmp_lg_u32 s3, 0
    s_cbranch_scc1 F_sd255
    ds_read_b32 v16, v27
    s_mov_b32 s48, 1
    s_waitcnt lgkmcnt(0)
    v_mov_b32 v17, v16
    v_mov_b32 v18, v16
    v_mov_b32 v19, v16
    s_branch F_lv
F_td:
    v_or_b32 v24, 0x800, v24
    s_mov_b64 exec, 0xff
F_tst:
    buffer_store_dword v24, v28, s[24:27], 0 offen offset:128 sc1
    s_waitcnt vmcnt(0)
    s_barrier
F_swr:
    ds_write_b32 v29, v24
    s_mov_b64 exec, 1
    v_mov_b32 v1, 147456
    v_mov_b32 v24, 0x800
    ds_or_b32 v1, v24 offset:256
    s_mov_b64 exec, -1
    s_waitcnt lgkmcnt(0)
    s_branch F_sbar
F_sd255:
    s_barrier
F_sdone:
    v_mov_b32 v1, 147456
    s_mov_b32 s59, 2
    s_cmp_ge_u32 s3, 4
    s_cbranch_scc1 F_p2
    s_cmp_eq_u32 s2, 252
    s_mov_b32 s36, 63
    s_cselect_b32 s36, 77, s36
    s_add_u32 s36, s3, s36
F_st1:
    s_mov_b32 s80, s6
    s_mov_b32 s81, s7
    s_mov_b32 s82, 0x600000
    s_mov_b32 s83, 0x20000
    s_lshl_b32 s37, s36, 1
    s_and_b32 s38, s28, 1
    s_add_u32 s37, s37, s38
    s_lshl_b32 s37, s37, 15
    s_lshr_b32 s38, s28, 1
    s_lshl_b32 s38, s38, 9
    s_add_u32 s37, s37, s38
    s_add_u32 s37, s37, 393216
    v_lshrrev_b32 v16, 2, v0
    v_lshlrev_b32 v16, 11, v16
    v_and_b32 v14, 3, v0
    v_lshl_add_u32 v16, v14, 7, v16
    buffer_load_dword v17, v16, s[80:83], s37 offen
    s_add_u32 s36, s36, 3
    s_cmp_lt_u32 s36, 90
    s_cbranch_scc1 F_st1
F_st2:
    s_mov_b32 s8, s84
    s_mov_b32 s9, s85
    s_mov_b32 s10, 0x200000
    s_mov_b32 s11, 0x20000
    v_lshrrev_b32 v16, 3, v0
    v_lshlrev_b32 v16, 11, v16
    v_and_b32 v18, 7, v0
    v_lshl_add_u32 v16, v18, 7, v16
    s_and_b32 s36, s28, 4
    s_lshl_b32 s36, s36, 8
    v_add_u32 v16, s36, v16
    s_add_u32 s36, s3, 23
    s_and_b32 s38, s28, 3
F_stl:
    s_lshl_b32 s37, s36, 2
    s_add_u32 s37, s37, s38
    s_lshl_b32 s37, s37, 14
    buffer_load_dword v17, v16, s[8:11], s37 offen
    s_add_u32 s36, s36, 3
    s_cmp_lt_u32 s36, 32
    s_cbranch_scc1 F_stl
F_sbar:
    v_mov_b32 v1, 147456
    s_barrier
    s_waitcnt vmcnt(0)
    s_cmp_lg_u32 s2, 255
    s_cbranch_scc1 F_help2
    s_cmp_lg_u32 s3, 1
    s_cbranch_scc1 F_help2
    s_branch F_sp_45_e
F_sp_45:
    s_sleep 4
F_sp_45_e:
    ds_read_b32 v16, v1 offset:24
    s_waitcnt lgkmcnt(0)
    v_readfirstlane_b32 s49, v16
    s_nop 0
    s_cmp_ge_u32 s49, 4
    s_cbranch_scc0 F_sp_45
    v_min_u32 v7, 55, v0
    v_lshlrev_b32 v7, 7, v7
    v_add_u32 v7, 0x16000, v7
    s_mov_b32 s49, 0
F_ap:
    buffer_load_dword v8, v7, s[20:23], 0 offen sc1
    s_waitcnt vmcnt(0)
    v_cmp_eq_u32 vcc, 0, v8
    s_add_u32 s49, s49, 1
    s_cmp_eq_u64 vcc, 0
    s_cbranch_scc1 F_aq
    s_cmp_lt_u32 s49, 0x8000
    s_cbranch_scc0 F_aq
    s_mov_b64 exec, vcc
    s_sleep 8
    s_branch F_ap
F_aq:
    s_mov_b64 exec, 1
    v_mov_b32 v7, 64
    v_mov_b32 v8, 1
    buffer_store_dword v8, v7, s[24:27], 0 offen sc1
    s_mov_b64 exec, -1
    s_branch F_help2
F_end:
    s_endpgm
.section .rodata,"a"
.p2align 6
.amdhsa_kernel parallel_sum__sliding_local_dilated__moe_arch_mod__prompt_kernel
  .amdhsa_next_free_vgpr 256
  .amdhsa_next_free_sgpr 102
  .amdhsa_accum_offset 256
  .amdhsa_group_segment_fixed_size 0
  .amdhsa_kernarg_size 88
  .amdhsa_user_sgpr_count 2
  .amdhsa_user_sgpr_kernarg_segment_ptr 1
  .amdhsa_system_sgpr_workgroup_id_x 1
  .amdhsa_float_denorm_mode_32 3
  .amdhsa_float_denorm_mode_16_64 3
.end_amdhsa_kernel
```
